```python
import torch

def _softmax(x, axis=-1):
    return torch.softmax(x, dim=axis)
def _gelu(x):
    return torch.nn.functional.gelu(x, approximate="tanh")
def _silu(x):
    return torch.nn.functional.silu(x)
def _sigmoid(x):
    return torch.sigmoid(x)
def _layernorm(x, axis=-1, eps=1e-5):
    m = x.mean(dim=axis, keepdim=True)
    v = x.var(dim=axis, keepdim=True, unbiased=False)
    return (x - m) / torch.sqrt(v + eps)
def _scatter_add(tgt, idx, src, axis=0):
    return tgt.clone().index_add_(axis, idx, src)
def _segment_sum(src, seg, n):
    out = torch.zeros((n,) + src.shape[1:], dtype=src.dtype)
    return out.index_add_(0, seg, src)
def _pad(x, pw):
    flat = tuple(v for pair in reversed(pw) for v in pair)
    return torch.nn.functional.pad(x, flat)

kernel_name = 'interleave_layers__sliding_local_dilated__grouped_kv_mqa__prompt'

def setup_inputs():

    _w = (lambda a: (lambda t: t.to(torch.bfloat16) if t.is_floating_point() else t)(torch.as_tensor(a)))
    def _A_setup():
        B, S, D = 1, 2048, 576
        return {
            "x": _w((lambda *s: torch.randn(*s, dtype=torch.bfloat16) * 0.05)(B, S, D)),
            "wqkv": _w((lambda *s: torch.randn(*s, dtype=torch.bfloat16) * 0.05)(D, 3 * D)),
            "wo": _w((lambda *s: torch.randn(*s, dtype=torch.bfloat16) * 0.05)(D, D)),
        }
    _A_in = _A_setup()

    def _B_setup():
        B, S, D, H = 1, 2048, 576, 32
        Dh = D // H
        return {
            "x": _w((lambda *s: torch.randn(*s, dtype=torch.bfloat16) * 0.05)(B, S, D)),
            "wq": _w((lambda *s: torch.randn(*s, dtype=torch.bfloat16) * 0.05)(D, H * Dh)),
            "wk": _w((lambda *s: torch.randn(*s, dtype=torch.bfloat16) * 0.05)(D, Dh)),
            "wv": _w((lambda *s: torch.randn(*s, dtype=torch.bfloat16) * 0.05)(D, Dh)),
            "wo": _w((lambda *s: torch.randn(*s, dtype=torch.bfloat16) * 0.05)(H * Dh, D)),
        }
    _B_in = _B_setup()

    return {
        "A_x": _A_in["x"],
        "A_wqkv": _A_in["wqkv"],
        "A_wo": _A_in["wo"],
        "B_x": _B_in["x"],
        "B_wq": _B_in["wq"],
        "B_wk": _B_in["wk"],
        "B_wv": _B_in["wv"],
        "B_wo": _B_in["wo"],
    }

def reference(A_x, A_wqkv, A_wo, B_x, B_wq, B_wk, B_wv, B_wo):
    def _A_ref(x, wqkv, wo):
        B, S, D = x.shape
        H = 32; Dh = D // H
        W, dil = 8, 2
        qkv = (lambda x, *d: x.permute(*d))((x @ wqkv).reshape(B, S, 3, H, Dh), 2, 0, 3, 1, 4)
        q, k, v = qkv[0], qkv[1], qkv[2]
        scale = Dh ** -0.5
        pos = torch.arange(S)
        off = torch.arange(W) * dil
        idx = pos[:, None] - off[None, :]
        mask = idx >= 0
        idx_c = torch.where(mask, idx, 0).reshape(-1)
        kg = k[:, :, idx_c, :].reshape(B, H, S, W, Dh)
        vg = v[:, :, idx_c, :].reshape(B, H, S, W, Dh)
        logits = torch.einsum("bhsd,bhswd->bhsw", q, kg) * scale
        logits = torch.where(mask[None, None, :, :], logits, -1e9)
        attn = _softmax(logits, axis=-1)
        o = torch.einsum("bhsw,bhswd->bhsd", attn, vg)
        return (lambda x, *d: x.permute(*d))(o, 0, 2, 1, 3).reshape(B, S, D) @ wo

    def _B_ref(x, wq, wk, wv, wo):
        B, S, D = x.shape
        H = 32
        Dh = D // H
        q = (lambda x, *d: x.permute(*d))((x @ wq).reshape(B, S, H, Dh), 0, 2, 1, 3)
        k = x @ wk
        v = x @ wv
        scores = torch.einsum("bhqd,bkd->bhqk", q, k) * (Dh ** -0.5)
        p = _softmax(scores, axis=-1)
        o = torch.einsum("bhqk,bkd->bhqd", p, v)
        return (lambda x, *d: x.permute(*d))(o, 0, 2, 1, 3).reshape(B, S, H * Dh) @ wo

    x = A_x
    x = x + _A_ref(_layernorm(x, axis=-1), A_wqkv, A_wo)
    x = x + _B_ref(_layernorm(x, axis=-1), B_wq, B_wk, B_wv, B_wo)
    x = x + _A_ref(_layernorm(x, axis=-1), A_wqkv, A_wo)
    x = x + _B_ref(_layernorm(x, axis=-1), B_wq, B_wk, B_wv, B_wo)
    return x
```

```asm
; @launch grid=(256,1,1) block=(512,1,1) lds=163840
.amdgcn_target "amdgcn-amd-amdhsa--gfx950"
.text
.globl interleave_layers__sliding_local_dilated__grouped_kv_mqa__prompt_kernel
.p2align 8
.type interleave_layers__sliding_local_dilated__grouped_kv_mqa__prompt_kernel,@function
interleave_layers__sliding_local_dilated__grouped_kv_mqa__prompt_kernel:
    s_cmp_ge_u32 s2, 256
    s_cbranch_scc1 L_EXIT
    s_load_dwordx16 s[48:63], s[0:1], 0
    s_load_dwordx2 s[12:13], s[0:1], 64
    s_load_dwordx2 s[4:5], s[0:1], 80
    s_getpc_b64 s[8:9]
L_PC:
    s_mov_b32 s10, L_CODE_END-L_PC
    s_mov_b32 s11, 0x20000
    s_lshl_b32 s37, s2, 8
    s_and_b32 s37, s37, 0xf800
    v_lshlrev_b32 v31, 2, v0
    buffer_load_dword v251, v31, s[8:11], s37 offen
    v_lshrrev_b32 v14, 6, v0
    v_and_b32 v3, 63, v0
    v_lshlrev_b32 v0, 4, v3
    v_readfirstlane_b32 s69, v14
    v_lshlrev_b32 v1, 3, v3
    v_and_b32 v20, 15, v3
    v_lshrrev_b32 v21, 4, v3
    v_lshlrev_b32 v2, 8, v21
    v_lshl_add_u32 v2, v20, 3, v2
    s_and_b32 s17, s69, 3
    s_and_b32 s28, s2, 7
    s_lshr_b32 s29, s2, 3
    s_lshl_b32 s16, s28, 5
    s_add_u32 s16, s16, s29
    s_lshr_b32 s20, s16, 3
    s_and_b32 s21, s16, 7
    s_lshr_b32 s22, s16, 4
    s_and_b32 s23, s16, 15
    s_lshl_b32 s27, s16, 8
    s_add_u32 s27, s27, 4096
    s_mov_b32 s19, 0
    s_getreg_b32 s84, hwreg(HW_REG_XCC_ID)
    s_lshl_b32 s100, s17, 12
    s_mov_b32 s24, 6291456
    s_mov_b32 s25, 524288
    s_mov_b32 s40, 0x00f0000f
    s_mov_b32 s41, 0xf0000f00
    s_mov_b32 s42, 0xaaaaaaaa
    s_mov_b32 s43, 0xaaaaaaaa
    s_mov_b32 s44, 0xcccccccc
    s_mov_b32 s45, 0xcccccccc
    v_mov_b32 v16, 0x3f803f80
    v_mov_b32 v17, 0x3f803f80
    v_mov_b32 v18, 0x3f803f80
    v_mov_b32 v19, 0x3f803f80
    v_mov_b32 v22, 0
    s_mov_b32 s6, 26476544
    s_mov_b32 s7, 0x20000
    s_mov_b32 s14, 2359296
    s_mov_b32 s15, 0x20000
    s_mov_b32 s67, 0x20000
    s_waitcnt lgkmcnt(0)
    buffer_load_dword v23, v22, s[4:7], 0 offen sc1
    s_cmp_lt_u32 s69, 4
    s_cbranch_scc1 L_COMPUTE
    s_mul_i32 s80, s22, 9
    s_add_u32 s80, s80, s23
    s_and_b32 s81, s80, 7
    s_lshr_b32 s80, s80, 3
    s_cmp_ge_u32 s23, 9
    s_cbranch_scc1 NOWA_1
    s_mov_b32 s8, s50
    s_mov_b32 s9, s51
    s_mov_b32 s10, 1990656
    s_lshr_b32 s32, s80, 1
    s_mul_i32 s32, s32, 72
    s_and_b32 s33, s80, 1
    s_lshl_b32 s34, s33, 5
    s_add_u32 s32, s32, s34
    s_mul_i32 s33, s33, 288
    s_add_u32 s33, s33, 64
    s_cmp_lt_u32 s80, 16
    s_cselect_b32 s32, s32, s33
    s_cselect_b32 s34, 8, 72
    s_mul_i32 s34, s34, s17
    s_add_u32 s32, s32, s34
    s_mul_i32 s32, s32, 3456
    s_lshl_b32 s33, s81, 7
    s_add_u32 s32, s32, s33
    v_mul_u32_u24 v24, 3456, v21
    v_lshl_add_u32 v24, v20, 4, v24
    s_lshl_b32 s33, s17, 11
    s_add_u32 s34, s32, 0
    s_add_u32 m0, s33, 0
    s_nop 0
    buffer_load_dwordx4 v24, s[8:11], s34 offen lds
    s_add_u32 s34, s32, 13824
    s_add_u32 m0, s33, 1024
    s_nop 0
    buffer_load_dwordx4 v24, s[8:11], s34 offen lds
    s_add_u32 s34, s32, 1152
    s_add_u32 m0, s33, 8192
    s_nop 0
    buffer_load_dwordx4 v24, s[8:11], s34 offen lds
    s_add_u32 s34, s32, 14976
    s_add_u32 m0, s33, 9216
    s_nop 0
    buffer_load_dwordx4 v24, s[8:11], s34 offen lds
    s_add_u32 s34, s32, 2304
    s_add_u32 m0, s33, 16384
    s_nop 0
    buffer_load_dwordx4 v24, s[8:11], s34 offen lds
    s_add_u32 s34, s32, 16128
    s_add_u32 m0, s33, 17408
    s_nop 0
    buffer_load_dwordx4 v24, s[8:11], s34 offen lds
NOWA_1:
    s_branch L_HELPER
L_COMPUTE:
    s_mov_b32 s8, s48
    s_mov_b32 s9, s49
    s_mov_b32 s10, 2359296
    s_lshl_b32 s28, s23, 2
    s_add_u32 s28, s28, s17
    s_mul_i32 s28, s28, 2688
    s_mul_i32 s29, s22, 147456
    s_add_u32 s28, s28, s29
    s_sub_u32 s28, s28, 18432
    s_max_i32 s28, s28, 0
    v_min_u32 v24, 20, v3
    v_lshlrev_b32 v24, 7, v24
    buffer_load_dword v29, v24, s[8:11], s28 offen
    v_lshrrev_b32 v24, 2, v3
    v_lshrrev_b32 v25, 4, v3
    v_and_b32 v25, 2, v25
    v_and_b32 v26, 3, v3
    v_xor_b32 v25, v25, v26
    v_mul_u32_u24 v24, 1152, v24
    v_lshl_add_u32 v24, v25, 4, v24
    s_lshl_b32 s28, s22, 2
    s_add_u32 s28, s28, s17
    s_mul_i32 s96, s28, 36864
    s_and_b32 s97, s23, 1
    s_mul_i32 s98, s97, 576
    s_add_u32 s98, s98, s96
    s_mul_i32 s99, s17, 18432
    s_add_u32 s99, s99, 55296
    v_lshrrev_b32 v25, 2, v20
    v_and_b32 v25, 2, v25
    v_lshl_add_u32 v26, v20, 6, s99
    v_add_u32 v27, 0, v21
    v_lshrrev_b32 v28, 2, v27
    v_and_b32 v27, 3, v27
    v_xor_b32 v27, v27, v25
    v_lshl_add_u32 v27, v27, 4, v26
    v_lshl_add_u32 v30, v28, 10, v27
    v_add_u32 v27, 1, v21
    v_lshrrev_b32 v28, 2, v27
    v_and_b32 v27, 3, v27
    v_xor_b32 v27, v27, v25
    v_lshl_add_u32 v27, v27, 4, v26
    v_lshl_add_u32 v31, v28, 10, v27
    v_add_u32 v27, 2, v21
    v_lshrrev_b32 v28, 2, v27
    v_and_b32 v27, 3, v27
    v_xor_b32 v27, v27, v25
    v_lshl_add_u32 v27, v27, 4, v26
    v_lshl_add_u32 v32, v28, 10, v27
    v_add_u32 v27, 3, v21
    v_lshrrev_b32 v28, 2, v27
    v_and_b32 v27, 3, v27
    v_xor_b32 v27, v27, v25
    v_lshl_add_u32 v27, v27, 4, v26
    v_lshl_add_u32 v33, v28, 10, v27
    v_lshl_add_u32 v34, v21, 11, v30
    v_mov_b32 v40, 0
    v_mov_b32 v41, 0
    v_mov_b32 v42, 0
    v_mov_b32 v43, 0
    v_mov_b32 v44, 0
    v_mov_b32 v45, 0
    v_mov_b32 v46, 0
    v_mov_b32 v47, 0
    v_mov_b32 v48, 0
    v_mov_b32 v49, 0
    v_mov_b32 v50, 0
    v_mov_b32 v51, 0
    v_mov_b32 v52, 0
    v_mov_b32 v53, 0
    v_mov_b32 v54, 0
    v_mov_b32 v55, 0
    s_lshl_b32 s89, s20, 2
    s_add_u32 s89, s89, s17
    s_mul_i32 s88, s89, 18432
    s_lshl_b32 s89, s89, 10
    s_mov_b32 s68, 0
    s_lshl_b32 s81, s16, 2
    s_add_u32 s81, s81, s17
    s_lshl_b32 s81, s81, 7
    s_add_u32 s81, s81, 25165824
    s_lshl_b32 s83, s21, 9
    s_sub_u32 s83, s81, s83
    s_waitcnt vmcnt(2)
    v_and_b32 v249, 15, v3
    v_lshrrev_b32 v250, 4, v3
    v_mov_b32 v248, v0
    v_mov_b32 v242, 163632
    s_lshl_b32 s28, s22, 3
    s_lshl_b32 s29, s17, 1
    s_add_u32 s29, s29, s28
    s_mul_i32 s48, s29, 18432
    s_add_u32 s48, s48, s24
    s_add_u32 s53, s48, 18432
    s_lshl_b32 s58, s29, 10
    s_add_u32 s58, s58, s25
    s_mul_i32 s59, s22, 20480
    s_add_u32 s59, s59, 5588992
    s_add_u32 s49, s48, 4096
    s_add_u32 s50, s48, 8192
    s_add_u32 s51, s48, 12288
    s_add_u32 s52, s48, 16384
    s_add_u32 s54, s53, 4096
    s_add_u32 s55, s53, 8192
    s_add_u32 s56, s53, 12288
    s_add_u32 s57, s53, 16384
    s_lshl_b32 s60, s17, 9
    s_add_u32 s60, s60, 161536
    v_lshl_add_u32 v240, v249, 2, s60
    v_lshl_add_u32 v241, v250, 4, s60
    s_mov_b32 s76, -1
    s_mov_b32 s77, 0
    s_lshr_b32 s28, s17, 1
    s_and_b32 s29, s17, 1
    s_lshl_b32 s86, s28, 2
    s_add_u32 s86, s86, s29
    s_add_u32 s86, s86, 2
    s_min_u32 s86, s86, 6
    s_xor_b32 s28, s28, 1
    s_lshl_b32 s87, s28, 2
    s_add_u32 s87, s87, s29
    s_lshl_b32 s34, s23, 10
    s_add_u32 s34, s34, s48
    s_add_u32 s34, s34, 2359296
    s_add_u32 s35, s34, 18432
    s_lshl_b32 s36, s23, 7
    s_add_u32 s36, s36, s48
    s_add_u32 s36, s36, 2375680
    s_add_u32 s37, s36, 18432
    s_mov_b32 s72, 0xffff
    s_mov_b32 s73, 0
    s_mov_b32 s74, 0xffff0000
    s_mov_b32 s75, 0
    s_or_b32 s28, s22, s17
    v_mov_b32 v251, s28
    v_cmp_eq_u32 s[62:63], 0, v251
    s_mul_i32 s32, s17, 2304
    s_add_u32 s32, s32, 147456
    s_lshl_b32 s33, s17, 9
    s_add_u32 s33, s33, 156672
    s_cmp_lt_u32 s17, 2
    s_cselect_b64 s[64:65], -1, 0
    s_cselect_b32 s66, 0, 0xffff
    s_cmp_lt_u32 s17, 3
    s_cselect_b64 s[78:79], -1, 0
    s_lshl_b32 s38, s86, 6
    s_add_u32 s38, s38, 160512
    s_lshl_b32 s39, s87, 6
    s_add_u32 s39, s39, 160512
    v_mov_b32 v35, 1
    s_waitcnt vmcnt(0)
    s_add_u32 s101, s98, 0
    s_add_u32 m0, s99, 0
    s_nop 0
    buffer_load_dwordx4 v24, s[8:11], s101 offen lds
    s_add_u32 s101, s98, 64
    s_add_u32 m0, s99, 1024
    s_nop 0
    buffer_load_dwordx4 v24, s[8:11], s101 offen lds
    s_add_u32 s101, s98, 128
    s_add_u32 m0, s99, 2048
    s_nop 0
    buffer_load_dwordx4 v24, s[8:11], s101 offen lds
    s_add_u32 s101, s98, 192
    s_add_u32 m0, s99, 3072
    s_nop 0
    buffer_load_dwordx4 v24, s[8:11], s101 offen lds
    s_add_u32 s101, s98, 256
    s_add_u32 m0, s99, 4096
    s_nop 0
    buffer_load_dwordx4 v24, s[8:11], s101 offen lds
    s_add_u32 s101, s98, 320
    s_add_u32 m0, s99, 5120
    s_nop 0
    buffer_load_dwordx4 v24, s[8:11], s101 offen lds
    s_add_u32 s101, s98, 384
    s_add_u32 m0, s99, 6144
    s_nop 0
    buffer_load_dwordx4 v24, s[8:11], s101 offen lds
    s_add_u32 s101, s98, 448
    s_add_u32 m0, s99, 7168
    s_nop 0
    buffer_load_dwordx4 v24, s[8:11], s101 offen lds
    s_add_u32 s101, s98, 512
    s_add_u32 m0, s99, 8192
    s_nop 0
    buffer_load_dwordx4 v24, s[8:11], s101 offen lds
    s_barrier
    s_add_u32 s101, s98, 18432
    s_add_u32 m0, s99, 9216
    s_nop 0
    buffer_load_dwordx4 v24, s[8:11], s101 offen lds
    s_add_u32 s101, s98, 18496
    s_add_u32 m0, s99, 10240
    s_nop 0
    buffer_load_dwordx4 v24, s[8:11], s101 offen lds
    s_add_u32 s101, s98, 18560
    s_add_u32 m0, s99, 11264
    s_nop 0
    buffer_load_dwordx4 v24, s[8:11], s101 offen lds
    s_add_u32 s101, s98, 18624
    s_add_u32 m0, s99, 12288
    s_nop 0
    buffer_load_dwordx4 v24, s[8:11], s101 offen lds
    s_add_u32 s101, s98, 18688
    s_add_u32 m0, s99, 13312
    s_nop 0
    buffer_load_dwordx4 v24, s[8:11], s101 offen lds
    s_add_u32 s101, s98, 18752
    s_add_u32 m0, s99, 14336
    s_nop 0
    buffer_load_dwordx4 v24, s[8:11], s101 offen lds
    s_add_u32 s101, s98, 18816
    s_add_u32 m0, s99, 15360
    s_nop 0
    buffer_load_dwordx4 v24, s[8:11], s101 offen lds
    s_add_u32 s101, s98, 18880
    s_add_u32 m0, s99, 16384
    s_nop 0
    buffer_load_dwordx4 v24, s[8:11], s101 offen lds
    s_add_u32 s101, s98, 18944
    s_add_u32 m0, s99, 17408
    s_nop 0
    buffer_load_dwordx4 v24, s[8:11], s101 offen lds
    s_barrier
    s_xor_b32 s98, s97, 1
    s_mul_i32 s98, s98, 576
    s_add_u32 s98, s98, s96
    s_cmp_eq_u32 s97, 1
    s_cbranch_scc1 ODD_2
    s_waitcnt vmcnt(9)
    ds_read_b128 v[140:143], v30 offset:0
    ds_read_b128 v[148:151], v30 offset:1024
    ds_read_b128 v[156:159], v31 offset:2048
    ds_read_b128 v[76:79], v31 offset:3072
    ds_read_b128 v[244:247], v32 offset:4096
    ds_read_b128 v[4:7], v32 offset:5120
    ds_read_b128 v[84:87], v33 offset:6144
    ds_read_b128 v[92:95], v33 offset:7168
    ds_read_b128 v[164:167], v34 offset:2048
    s_waitcnt lgkmcnt(0)
    s_add_u32 s101, s98, 0
    s_add_u32 m0, s99, 0
    s_nop 0
    buffer_load_dwordx4 v24, s[8:11], s101 offen lds
    s_add_u32 s101, s98, 64
    s_add_u32 m0, s99, 1024
    s_nop 0
    buffer_load_dwordx4 v24, s[8:11], s101 offen lds
    s_add_u32 s101, s98, 128
    s_add_u32 m0, s99, 2048
    s_nop 0
    buffer_load_dwordx4 v24, s[8:11], s101 offen lds
    s_add_u32 s101, s98, 192
    s_add_u32 m0, s99, 3072
    s_nop 0
    buffer_load_dwordx4 v24, s[8:11], s101 offen lds
    s_add_u32 s101, s98, 256
    s_add_u32 m0, s99, 4096
    s_nop 0
    buffer_load_dwordx4 v24, s[8:11], s101 offen lds
    s_add_u32 s101, s98, 320
    s_add_u32 m0, s99, 5120
    s_nop 0
    buffer_load_dwordx4 v24, s[8:11], s101 offen lds
    s_add_u32 s101, s98, 384
    s_add_u32 m0, s99, 6144
    s_nop 0
    buffer_load_dwordx4 v24, s[8:11], s101 offen lds
    s_add_u32 s101, s98, 448
    s_add_u32 m0, s99, 7168
    s_nop 0
    buffer_load_dwordx4 v24, s[8:11], s101 offen lds
    s_add_u32 s101, s98, 512
    s_add_u32 m0, s99, 8192
    s_nop 0
    buffer_load_dwordx4 v24, s[8:11], s101 offen lds
    v_mfma_f32_16x16x32_bf16 v[40:43], v[140:143], v[140:143], v[40:43]
    v_mfma_f32_16x16x32_bf16 v[44:47], v[16:19], v[140:143], v[44:47]
    v_mfma_f32_16x16x32_bf16 v[40:43], v[148:151], v[148:151], v[40:43]
    v_mfma_f32_16x16x32_bf16 v[44:47], v[16:19], v[148:151], v[44:47]
    v_mfma_f32_16x16x32_bf16 v[40:43], v[156:159], v[156:159], v[40:43]
    v_mfma_f32_16x16x32_bf16 v[44:47], v[16:19], v[156:159], v[44:47]
    v_mfma_f32_16x16x32_bf16 v[40:43], v[76:79], v[76:79], v[40:43]
    v_mfma_f32_16x16x32_bf16 v[44:47], v[16:19], v[76:79], v[44:47]
    v_mfma_f32_16x16x32_bf16 v[40:43], v[244:247], v[244:247], v[40:43]
    v_mfma_f32_16x16x32_bf16 v[44:47], v[16:19], v[244:247], v[44:47]
    v_mfma_f32_16x16x32_bf16 v[40:43], v[4:7], v[4:7], v[40:43]
    v_mfma_f32_16x16x32_bf16 v[44:47], v[16:19], v[4:7], v[44:47]
    v_mfma_f32_16x16x32_bf16 v[40:43], v[84:87], v[84:87], v[40:43]
    v_mfma_f32_16x16x32_bf16 v[44:47], v[16:19], v[84:87], v[44:47]
    v_mfma_f32_16x16x32_bf16 v[40:43], v[92:95], v[92:95], v[40:43]
    v_mfma_f32_16x16x32_bf16 v[44:47], v[16:19], v[92:95], v[44:47]
    v_mfma_f32_16x16x32_bf16 v[40:43], v[164:167], v[164:167], v[40:43]
    v_mfma_f32_16x16x32_bf16 v[44:47], v[16:19], v[164:167], v[44:47]
    s_waitcnt vmcnt(9)
    ds_read_b128 v[144:147], v30 offset:9216
    ds_read_b128 v[152:155], v30 offset:10240
    ds_read_b128 v[160:163], v31 offset:11264
    ds_read_b128 v[80:83], v31 offset:12288
    ds_read_b128 v[236:239], v32 offset:13312
    ds_read_b128 v[8:11], v32 offset:14336
    ds_read_b128 v[88:91], v33 offset:15360
    ds_read_b128 v[96:99], v33 offset:16384
    ds_read_b128 v[168:171], v34 offset:11264
    s_waitcnt lgkmcnt(0)
    s_add_u32 s101, s98, 18432
    s_add_u32 m0, s99, 9216
    s_nop 0
    buffer_load_dwordx4 v24, s[8:11], s101 offen lds
    s_add_u32 s101, s98, 18496
    s_add_u32 m0, s99, 10240
    s_nop 0
    buffer_load_dwordx4 v24, s[8:11], s101 offen lds
    s_add_u32 s101, s98, 18560
    s_add_u32 m0, s99, 11264
    s_nop 0
    buffer_load_dwordx4 v24, s[8:11], s101 offen lds
    s_add_u32 s101, s98, 18624
    s_add_u32 m0, s99, 12288
    s_nop 0
    buffer_load_dwordx4 v24, s[8:11], s101 offen lds
    s_add_u32 s101, s98, 18688
    s_add_u32 m0, s99, 13312
    s_nop 0
    buffer_load_dwordx4 v24, s[8:11], s101 offen lds
    s_add_u32 s101, s98, 18752
    s_add_u32 m0, s99, 14336
    s_nop 0
    buffer_load_dwordx4 v24, s[8:11], s101 offen lds
    s_add_u32 s101, s98, 18816
    s_add_u32 m0, s99, 15360
    s_nop 0
    buffer_load_dwordx4 v24, s[8:11], s101 offen lds
    s_add_u32 s101, s98, 18880
    s_add_u32 m0, s99, 16384
    s_nop 0
    buffer_load_dwordx4 v24, s[8:11], s101 offen lds
    s_add_u32 s101, s98, 18944
    s_add_u32 m0, s99, 17408
    s_nop 0
    buffer_load_dwordx4 v24, s[8:11], s101 offen lds
    v_mfma_f32_16x16x32_bf16 v[48:51], v[144:147], v[144:147], v[48:51]
    v_mfma_f32_16x16x32_bf16 v[52:55], v[16:19], v[144:147], v[52:55]
    v_mfma_f32_16x16x32_bf16 v[48:51], v[152:155], v[152:155], v[48:51]
    v_mfma_f32_16x16x32_bf16 v[52:55], v[16:19], v[152:155], v[52:55]
    v_mfma_f32_16x16x32_bf16 v[48:51], v[160:163], v[160:163], v[48:51]
    v_mfma_f32_16x16x32_bf16 v[52:55], v[16:19], v[160:163], v[52:55]
    v_mfma_f32_16x16x32_bf16 v[48:51], v[80:83], v[80:83], v[48:51]
    v_mfma_f32_16x16x32_bf16 v[52:55], v[16:19], v[80:83], v[52:55]
    v_mfma_f32_16x16x32_bf16 v[48:51], v[236:239], v[236:239], v[48:51]
    v_mfma_f32_16x16x32_bf16 v[52:55], v[16:19], v[236:239], v[52:55]
    v_mfma_f32_16x16x32_bf16 v[48:51], v[8:11], v[8:11], v[48:51]
    v_mfma_f32_16x16x32_bf16 v[52:55], v[16:19], v[8:11], v[52:55]
    v_mfma_f32_16x16x32_bf16 v[48:51], v[88:91], v[88:91], v[48:51]
    v_mfma_f32_16x16x32_bf16 v[52:55], v[16:19], v[88:91], v[52:55]
    v_mfma_f32_16x16x32_bf16 v[48:51], v[96:99], v[96:99], v[48:51]
    v_mfma_f32_16x16x32_bf16 v[52:55], v[16:19], v[96:99], v[52:55]
    v_mfma_f32_16x16x32_bf16 v[48:51], v[168:171], v[168:171], v[48:51]
    v_mfma_f32_16x16x32_bf16 v[52:55], v[16:19], v[168:171], v[52:55]
    s_waitcnt vmcnt(9)
    ds_read_b128 v[100:103], v30 offset:0
    ds_read_b128 v[108:111], v30 offset:1024
    ds_read_b128 v[180:183], v31 offset:2048
    ds_read_b128 v[188:191], v31 offset:3072
    ds_read_b128 v[196:199], v32 offset:4096
    ds_read_b128 v[204:207], v32 offset:5120
    ds_read_b128 v[212:215], v33 offset:6144
    ds_read_b128 v[220:223], v33 offset:7168
    ds_read_b128 v[172:175], v34 offset:2048
    s_waitcnt lgkmcnt(0)
    v_mfma_f32_16x16x32_bf16 v[40:43], v[100:103], v[100:103], v[40:43]
    v_mfma_f32_16x16x32_bf16 v[44:47], v[16:19], v[100:103], v[44:47]
    v_mfma_f32_16x16x32_bf16 v[40:43], v[108:111], v[108:111], v[40:43]
    v_mfma_f32_16x16x32_bf16 v[44:47], v[16:19], v[108:111], v[44:47]
    v_mfma_f32_16x16x32_bf16 v[40:43], v[180:183], v[180:183], v[40:43]
    v_mfma_f32_16x16x32_bf16 v[44:47], v[16:19], v[180:183], v[44:47]
    v_mfma_f32_16x16x32_bf16 v[40:43], v[188:191], v[188:191], v[40:43]
    v_mfma_f32_16x16x32_bf16 v[44:47], v[16:19], v[188:191], v[44:47]
    v_mfma_f32_16x16x32_bf16 v[40:43], v[196:199], v[196:199], v[40:43]
    v_mfma_f32_16x16x32_bf16 v[44:47], v[16:19], v[196:199], v[44:47]
    v_mfma_f32_16x16x32_bf16 v[40:43], v[204:207], v[204:207], v[40:43]
    v_mfma_f32_16x16x32_bf16 v[44:47], v[16:19], v[204:207], v[44:47]
    v_mfma_f32_16x16x32_bf16 v[40:43], v[212:215], v[212:215], v[40:43]
    v_mfma_f32_16x16x32_bf16 v[44:47], v[16:19], v[212:215], v[44:47]
    v_mfma_f32_16x16x32_bf16 v[40:43], v[220:223], v[220:223], v[40:43]
    v_mfma_f32_16x16x32_bf16 v[44:47], v[16:19], v[220:223], v[44:47]
    v_mfma_f32_16x16x32_bf16 v[40:43], v[172:175], v[172:175], v[40:43]
    v_mfma_f32_16x16x32_bf16 v[44:47], v[16:19], v[172:175], v[44:47]
    s_waitcnt vmcnt(0)
    ds_read_b128 v[104:107], v30 offset:9216
    ds_read_b128 v[252:255], v30 offset:10240
    ds_read_b128 v[184:187], v31 offset:11264
    ds_read_b128 v[192:195], v31 offset:12288
    ds_read_b128 v[200:203], v32 offset:13312
    ds_read_b128 v[208:211], v32 offset:14336
    ds_read_b128 v[216:219], v33 offset:15360
    ds_read_b128 v[224:227], v33 offset:16384
    ds_read_b128 v[176:179], v34 offset:11264
    s_waitcnt lgkmcnt(0)
    s_mov_b64 exec, 1
    ds_add_u32 v242, v35 offset:16
    s_mov_b64 exec, -1
    v_mfma_f32_16x16x32_bf16 v[48:51], v[104:107], v[104:107], v[48:51]
    v_mfma_f32_16x16x32_bf16 v[52:55], v[16:19], v[104:107], v[52:55]
    v_mfma_f32_16x16x32_bf16 v[48:51], v[252:255], v[252:255], v[48:51]
    v_mfma_f32_16x16x32_bf16 v[52:55], v[16:19], v[252:255], v[52:55]
    v_mfma_f32_16x16x32_bf16 v[48:51], v[184:187], v[184:187], v[48:51]
    v_mfma_f32_16x16x32_bf16 v[52:55], v[16:19], v[184:187], v[52:55]
    v_mfma_f32_16x16x32_bf16 v[48:51], v[192:195], v[192:195], v[48:51]
    v_mfma_f32_16x16x32_bf16 v[52:55], v[16:19], v[192:195], v[52:55]
    v_mfma_f32_16x16x32_bf16 v[48:51], v[200:203], v[200:203], v[48:51]
    v_mfma_f32_16x16x32_bf16 v[52:55], v[16:19], v[200:203], v[52:55]
    v_mfma_f32_16x16x32_bf16 v[48:51], v[208:211], v[208:211], v[48:51]
    v_mfma_f32_16x16x32_bf16 v[52:55], v[16:19], v[208:211], v[52:55]
    v_mfma_f32_16x16x32_bf16 v[48:51], v[216:219], v[216:219], v[48:51]
    v_mfma_f32_16x16x32_bf16 v[52:55], v[16:19], v[216:219], v[52:55]
    v_mfma_f32_16x16x32_bf16 v[48:51], v[224:227], v[224:227], v[48:51]
    v_mfma_f32_16x16x32_bf16 v[52:55], v[16:19], v[224:227], v[52:55]
    v_mfma_f32_16x16x32_bf16 v[48:51], v[176:179], v[176:179], v[48:51]
    v_mfma_f32_16x16x32_bf16 v[52:55], v[16:19], v[176:179], v[52:55]
    s_branch XE_3
ODD_2:
    s_waitcnt vmcnt(9)
    ds_read_b128 v[100:103], v30 offset:0
    ds_read_b128 v[108:111], v30 offset:1024
    ds_read_b128 v[180:183], v31 offset:2048
    ds_read_b128 v[188:191], v31 offset:3072
    ds_read_b128 v[196:199], v32 offset:4096
    ds_read_b128 v[204:207], v32 offset:5120
    ds_read_b128 v[212:215], v33 offset:6144
    ds_read_b128 v[220:223], v33 offset:7168
    ds_read_b128 v[172:175], v34 offset:2048
    s_waitcnt lgkmcnt(0)
    s_add_u32 s101, s98, 0
    s_add_u32 m0, s99, 0
    s_nop 0
    buffer_load_dwordx4 v24, s[8:11], s101 offen lds
    s_add_u32 s101, s98, 64
    s_add_u32 m0, s99, 1024
    s_nop 0
    buffer_load_dwordx4 v24, s[8:11], s101 offen lds
    s_add_u32 s101, s98, 128
    s_add_u32 m0, s99, 2048
    s_nop 0
    buffer_load_dwordx4 v24, s[8:11], s101 offen lds
    s_add_u32 s101, s98, 192
    s_add_u32 m0, s99, 3072
    s_nop 0
    buffer_load_dwordx4 v24, s[8:11], s101 offen lds
    s_add_u32 s101, s98, 256
    s_add_u32 m0, s99, 4096
    s_nop 0
    buffer_load_dwordx4 v24, s[8:11], s101 offen lds
    s_add_u32 s101, s98, 320
    s_add_u32 m0, s99, 5120
    s_nop 0
    buffer_load_dwordx4 v24, s[8:11], s101 offen lds
    s_add_u32 s101, s98, 384
    s_add_u32 m0, s99, 6144
    s_nop 0
    buffer_load_dwordx4 v24, s[8:11], s101 offen lds
    s_add_u32 s101, s98, 448
    s_add_u32 m0, s99, 7168
    s_nop 0
    buffer_load_dwordx4 v24, s[8:11], s101 offen lds
    s_add_u32 s101, s98, 512
    s_add_u32 m0, s99, 8192
    s_nop 0
    buffer_load_dwordx4 v24, s[8:11], s101 offen lds
    v_mfma_f32_16x16x32_bf16 v[40:43], v[100:103], v[100:103], v[40:43]
    v_mfma_f32_16x16x32_bf16 v[44:47], v[16:19], v[100:103], v[44:47]
    v_mfma_f32_16x16x32_bf16 v[40:43], v[108:111], v[108:111], v[40:43]
    v_mfma_f32_16x16x32_bf16 v[44:47], v[16:19], v[108:111], v[44:47]
    v_mfma_f32_16x16x32_bf16 v[40:43], v[180:183], v[180:183], v[40:43]
    v_mfma_f32_16x16x32_bf16 v[44:47], v[16:19], v[180:183], v[44:47]
    v_mfma_f32_16x16x32_bf16 v[40:43], v[188:191], v[188:191], v[40:43]
    v_mfma_f32_16x16x32_bf16 v[44:47], v[16:19], v[188:191], v[44:47]
    v_mfma_f32_16x16x32_bf16 v[40:43], v[196:199], v[196:199], v[40:43]
    v_mfma_f32_16x16x32_bf16 v[44:47], v[16:19], v[196:199], v[44:47]
    v_mfma_f32_16x16x32_bf16 v[40:43], v[204:207], v[204:207], v[40:43]
    v_mfma_f32_16x16x32_bf16 v[44:47], v[16:19], v[204:207], v[44:47]
    v_mfma_f32_16x16x32_bf16 v[40:43], v[212:215], v[212:215], v[40:43]
    v_mfma_f32_16x16x32_bf16 v[44:47], v[16:19], v[212:215], v[44:47]
    v_mfma_f32_16x16x32_bf16 v[40:43], v[220:223], v[220:223], v[40:43]
    v_mfma_f32_16x16x32_bf16 v[44:47], v[16:19], v[220:223], v[44:47]
    v_mfma_f32_16x16x32_bf16 v[40:43], v[172:175], v[172:175], v[40:43]
    v_mfma_f32_16x16x32_bf16 v[44:47], v[16:19], v[172:175], v[44:47]
    s_waitcnt vmcnt(9)
    ds_read_b128 v[104:107], v30 offset:9216
    ds_read_b128 v[252:255], v30 offset:10240
    ds_read_b128 v[184:187], v31 offset:11264
    ds_read_b128 v[192:195], v31 offset:12288
    ds_read_b128 v[200:203], v32 offset:13312
    ds_read_b128 v[208:211], v32 offset:14336
    ds_read_b128 v[216:219], v33 offset:15360
    ds_read_b128 v[224:227], v33 offset:16384
    ds_read_b128 v[176:179], v34 offset:11264
    s_waitcnt lgkmcnt(0)
    s_add_u32 s101, s98, 18432
    s_add_u32 m0, s99, 9216
    s_nop 0
    buffer_load_dwordx4 v24, s[8:11], s101 offen lds
    s_add_u32 s101, s98, 18496
    s_add_u32 m0, s99, 10240
    s_nop 0
    buffer_load_dwordx4 v24, s[8:11], s101 offen lds
    s_add_u32 s101, s98, 18560
    s_add_u32 m0, s99, 11264
    s_nop 0
    buffer_load_dwordx4 v24, s[8:11], s101 offen lds
    s_add_u32 s101, s98, 18624
    s_add_u32 m0, s99, 12288
    s_nop 0
    buffer_load_dwordx4 v24, s[8:11], s101 offen lds
    s_add_u32 s101, s98, 18688
    s_add_u32 m0, s99, 13312
    s_nop 0
    buffer_load_dwordx4 v24, s[8:11], s101 offen lds
    s_add_u32 s101, s98, 18752
    s_add_u32 m0, s99, 14336
    s_nop 0
    buffer_load_dwordx4 v24, s[8:11], s101 offen lds
    s_add_u32 s101, s98, 18816
    s_add_u32 m0, s99, 15360
    s_nop 0
    buffer_load_dwordx4 v24, s[8:11], s101 offen lds
    s_add_u32 s101, s98, 18880
    s_add_u32 m0, s99, 16384
    s_nop 0
    buffer_load_dwordx4 v24, s[8:11], s101 offen lds
    s_add_u32 s101, s98, 18944
    s_add_u32 m0, s99, 17408
    s_nop 0
    buffer_load_dwordx4 v24, s[8:11], s101 offen lds
    v_mfma_f32_16x16x32_bf16 v[48:51], v[104:107], v[104:107], v[48:51]
    v_mfma_f32_16x16x32_bf16 v[52:55], v[16:19], v[104:107], v[52:55]
    v_mfma_f32_16x16x32_bf16 v[48:51], v[252:255], v[252:255], v[48:51]
    v_mfma_f32_16x16x32_bf16 v[52:55], v[16:19], v[252:255], v[52:55]
    v_mfma_f32_16x16x32_bf16 v[48:51], v[184:187], v[184:187], v[48:51]
    v_mfma_f32_16x16x32_bf16 v[52:55], v[16:19], v[184:187], v[52:55]
    v_mfma_f32_16x16x32_bf16 v[48:51], v[192:195], v[192:195], v[48:51]
    v_mfma_f32_16x16x32_bf16 v[52:55], v[16:19], v[192:195], v[52:55]
    v_mfma_f32_16x16x32_bf16 v[48:51], v[200:203], v[200:203], v[48:51]
    v_mfma_f32_16x16x32_bf16 v[52:55], v[16:19], v[200:203], v[52:55]
    v_mfma_f32_16x16x32_bf16 v[48:51], v[208:211], v[208:211], v[48:51]
    v_mfma_f32_16x16x32_bf16 v[52:55], v[16:19], v[208:211], v[52:55]
    v_mfma_f32_16x16x32_bf16 v[48:51], v[216:219], v[216:219], v[48:51]
    v_mfma_f32_16x16x32_bf16 v[52:55], v[16:19], v[216:219], v[52:55]
    v_mfma_f32_16x16x32_bf16 v[48:51], v[224:227], v[224:227], v[48:51]
    v_mfma_f32_16x16x32_bf16 v[52:55], v[16:19], v[224:227], v[52:55]
    v_mfma_f32_16x16x32_bf16 v[48:51], v[176:179], v[176:179], v[48:51]
    v_mfma_f32_16x16x32_bf16 v[52:55], v[16:19], v[176:179], v[52:55]
    s_waitcnt vmcnt(9)
    ds_read_b128 v[140:143], v30 offset:0
    ds_read_b128 v[148:151], v30 offset:1024
    ds_read_b128 v[156:159], v31 offset:2048
    ds_read_b128 v[76:79], v31 offset:3072
    ds_read_b128 v[244:247], v32 offset:4096
    ds_read_b128 v[4:7], v32 offset:5120
    ds_read_b128 v[84:87], v33 offset:6144
    ds_read_b128 v[92:95], v33 offset:7168
    ds_read_b128 v[164:167], v34 offset:2048
    s_waitcnt lgkmcnt(0)
    v_mfma_f32_16x16x32_bf16 v[40:43], v[140:143], v[140:143], v[40:43]
    v_mfma_f32_16x16x32_bf16 v[44:47], v[16:19], v[140:143], v[44:47]
    v_mfma_f32_16x16x32_bf16 v[40:43], v[148:151], v[148:151], v[40:43]
    v_mfma_f32_16x16x32_bf16 v[44:47], v[16:19], v[148:151], v[44:47]
    v_mfma_f32_16x16x32_bf16 v[40:43], v[156:159], v[156:159], v[40:43]
    v_mfma_f32_16x16x32_bf16 v[44:47], v[16:19], v[156:159], v[44:47]
    v_mfma_f32_16x16x32_bf16 v[40:43], v[76:79], v[76:79], v[40:43]
    v_mfma_f32_16x16x32_bf16 v[44:47], v[16:19], v[76:79], v[44:47]
    v_mfma_f32_16x16x32_bf16 v[40:43], v[244:247], v[244:247], v[40:43]
    v_mfma_f32_16x16x32_bf16 v[44:47], v[16:19], v[244:247], v[44:47]
    v_mfma_f32_16x16x32_bf16 v[40:43], v[4:7], v[4:7], v[40:43]
    v_mfma_f32_16x16x32_bf16 v[44:47], v[16:19], v[4:7], v[44:47]
    v_mfma_f32_16x16x32_bf16 v[40:43], v[84:87], v[84:87], v[40:43]
    v_mfma_f32_16x16x32_bf16 v[44:47], v[16:19], v[84:87], v[44:47]
    v_mfma_f32_16x16x32_bf16 v[40:43], v[92:95], v[92:95], v[40:43]
    v_mfma_f32_16x16x32_bf16 v[44:47], v[16:19], v[92:95], v[44:47]
    v_mfma_f32_16x16x32_bf16 v[40:43], v[164:167], v[164:167], v[40:43]
    v_mfma_f32_16x16x32_bf16 v[44:47], v[16:19], v[164:167], v[44:47]
    s_waitcnt vmcnt(0)
    ds_read_b128 v[144:147], v30 offset:9216
    ds_read_b128 v[152:155], v30 offset:10240
    ds_read_b128 v[160:163], v31 offset:11264
    ds_read_b128 v[80:83], v31 offset:12288
    ds_read_b128 v[236:239], v32 offset:13312
    ds_read_b128 v[8:11], v32 offset:14336
    ds_read_b128 v[88:91], v33 offset:15360
    ds_read_b128 v[96:99], v33 offset:16384
    ds_read_b128 v[168:171], v34 offset:11264
    s_waitcnt lgkmcnt(0)
    s_mov_b64 exec, 1
    ds_add_u32 v242, v35 offset:16
    s_mov_b64 exec, -1
    v_mfma_f32_16x16x32_bf16 v[48:51], v[144:147], v[144:147], v[48:51]
    v_mfma_f32_16x16x32_bf16 v[52:55], v[16:19], v[144:147], v[52:55]
    v_mfma_f32_16x16x32_bf16 v[48:51], v[152:155], v[152:155], v[48:51]
    v_mfma_f32_16x16x32_bf16 v[52:55], v[16:19], v[152:155], v[52:55]
    v_mfma_f32_16x16x32_bf16 v[48:51], v[160:163], v[160:163], v[48:51]
    v_mfma_f32_16x16x32_bf16 v[52:55], v[16:19], v[160:163], v[52:55]
    v_mfma_f32_16x16x32_bf16 v[48:51], v[80:83], v[80:83], v[48:51]
    v_mfma_f32_16x16x32_bf16 v[52:55], v[16:19], v[80:83], v[52:55]
    v_mfma_f32_16x16x32_bf16 v[48:51], v[236:239], v[236:239], v[48:51]
    v_mfma_f32_16x16x32_bf16 v[52:55], v[16:19], v[236:239], v[52:55]
    v_mfma_f32_16x16x32_bf16 v[48:51], v[8:11], v[8:11], v[48:51]
    v_mfma_f32_16x16x32_bf16 v[52:55], v[16:19], v[8:11], v[52:55]
    v_mfma_f32_16x16x32_bf16 v[48:51], v[88:91], v[88:91], v[48:51]
    v_mfma_f32_16x16x32_bf16 v[52:55], v[16:19], v[88:91], v[52:55]
    v_mfma_f32_16x16x32_bf16 v[48:51], v[96:99], v[96:99], v[48:51]
    v_mfma_f32_16x16x32_bf16 v[52:55], v[16:19], v[96:99], v[52:55]
    v_mfma_f32_16x16x32_bf16 v[48:51], v[168:171], v[168:171], v[48:51]
    v_mfma_f32_16x16x32_bf16 v[52:55], v[16:19], v[168:171], v[52:55]
XE_3:
    v_readfirstlane_b32 s18, v23
    s_nop 0
    s_add_u32 s18, s18, 16
    s_add_u32 s26, s18, 3
    s_add_u32 s85, s18, 1
    s_nop 7
    v_cndmask_b32 v40, v40, v41, s[42:43]
    v_cndmask_b32 v42, v42, v43, s[42:43]
    v_cndmask_b32 v40, v40, v42, s[44:45]
    v_cndmask_b32 v229, 0, v40, s[40:41]
    v_cndmask_b32 v228, 0, v44, s[40:41]
    v_mov_b32 v230, 0
    v_mov_b32 v231, 0
    v_cndmask_b32 v48, v48, v49, s[42:43]
    v_cndmask_b32 v50, v50, v51, s[42:43]
    v_cndmask_b32 v48, v48, v50, s[44:45]
    v_cndmask_b32 v233, 0, v48, s[40:41]
    v_cndmask_b32 v232, 0, v52, s[40:41]
    v_mov_b32 v234, 0
    v_mov_b32 v235, 0
    v_add_f32 v228, v228, v230
    v_add_f32 v229, v229, v231
    v_mov_b32 v230, v228
    v_mov_b32 v231, v229
    s_nop 0
    v_permlane32_swap_b32 v228, v230
    v_permlane32_swap_b32 v229, v231
    v_add_f32 v228, v228, v230
    v_add_f32 v229, v229, v231
    v_mov_b32 v230, v228
    v_mov_b32 v231, v229
    s_nop 0
    v_permlane16_swap_b32 v228, v230
    v_permlane16_swap_b32 v229, v231
    v_add_f32 v228, v228, v230
    v_add_f32 v229, v229, v231
    v_mul_f32 v230, 0xbae38e39, v228
    v_mul_f32 v229, 0x3ae38e39, v229
    v_fma_f32 v229, -v230, v230, v229
    v_max_f32 v229, 0, v229
    v_add_f32 v229, 0x3727c5ac, v229
    v_rsq_f32 v231, v229
    v_add_f32 v232, v232, v234
    v_add_f32 v233, v233, v235
    v_mov_b32 v234, v232
    v_mov_b32 v235, v233
    s_nop 0
    v_permlane32_swap_b32 v232, v234
    v_permlane32_swap_b32 v233, v235
    v_add_f32 v232, v232, v234
    v_add_f32 v233, v233, v235
    v_mov_b32 v234, v232
    v_mov_b32 v235, v233
    s_nop 0
    v_permlane16_swap_b32 v232, v234
    v_permlane16_swap_b32 v233, v235
    v_add_f32 v232, v232, v234
    v_add_f32 v233, v233, v235
    v_mul_f32 v234, 0xbae38e39, v232
    v_mul_f32 v233, 0x3ae38e39, v233
    v_fma_f32 v233, -v234, v234, v233
    v_max_f32 v233, 0, v233
    v_add_f32 v233, 0x3727c5ac, v233
    v_rsq_f32 v235, v233
    ds_write_b32 v240, v230 offset:0
    ds_write_b32 v240, v231 offset:64
    v_cndmask_b32 v228, v231, 1.0, s[76:77]
    v_mul_f32 v229, 0x3eae1a93, v231
    ds_write_b32 v240, v234 offset:128
    ds_write_b32 v240, v235 offset:192
    v_cndmask_b32 v232, v235, 1.0, s[76:77]
    v_mul_f32 v233, 0x3eae1a93, v235
    ds_read_b32 v243, v242 offset:20
    s_waitcnt lgkmcnt(0)
    v_cmp_gt_u32 vcc, 2, v243
    s_nop 0
    s_cbranch_vccnz SPINC_6
SPIND_5:
    ds_read_b128 v[112:115], v248 offset:0
    ds_read_b128 v[116:119], v248 offset:1024
    ds_read_b128 v[120:123], v248 offset:2048
    ds_read_b128 v[124:127], v248 offset:3072
    ds_read_b128 v[128:131], v248 offset:4096
    ds_read_b128 v[132:135], v248 offset:5120
    ds_read_b128 v[136:139], v248 offset:6144
    s_waitcnt lgkmcnt(4)
    v_mfma_f32_16x16x32_bf16 v[48:51], v[112:115], v[144:147], 0
    v_mfma_f32_16x16x32_bf16 v[20:23], v[112:115], v[140:143], 0
    ds_read_b128 v[112:115], v248 offset:7168
    v_mfma_f32_16x16x32_bf16 v[52:55], v[116:119], v[144:147], 0
    v_mfma_f32_16x16x32_bf16 v[24:27], v[116:119], v[140:143], 0
    ds_read_b128 v[116:119], v248 offset:8192
    v_mfma_f32_16x16x32_bf16 v[56:59], v[120:123], v[144:147], 0
    ds_read_b32 v243, v242 offset:28
    v_mfma_f32_16x16x32_bf16 v[28:31], v[120:123], v[140:143], 0
    ds_read_b128 v[120:123], v248 offset:9216
    s_waitcnt lgkmcnt(5)
    v_mfma_f32_16x16x32_bf16 v[60:63], v[124:127], v[144:147], 0
    v_mfma_f32_16x16x32_bf16 v[32:35], v[124:127], v[140:143], 0
    ds_read_b128 v[124:127], v248 offset:10240
    v_mfma_f32_16x16x32_bf16 v[64:67], v[144:147], v[128:131], 0
    v_mfma_f32_16x16x32_bf16 v[36:39], v[140:143], v[128:131], 0
    ds_read_b128 v[128:131], v248 offset:11264
    v_mfma_f32_16x16x32_bf16 v[68:71], v[144:147], v[132:135], 0
    v_mfma_f32_16x16x32_bf16 v[40:43], v[140:143], v[132:135], 0
    ds_read_b128 v[132:135], v248 offset:12288
    s_waitcnt lgkmcnt(7)
    v_mfma_f32_16x16x32_bf16 v[72:75], v[136:139], v[144:147], 0
    v_mfma_f32_16x16x32_bf16 v[44:47], v[136:139], v[140:143], 0
    ds_read_b128 v[136:139], v248 offset:13312
    s_waitcnt lgkmcnt(5)
    v_cmp_gt_u32 vcc, 4, v243
    s_nop 0
    s_cbranch_vccnz SPINC_9
SPIND_8:
    s_waitcnt lgkmcnt(4)
    v_mfma_f32_16x16x32_bf16 v[48:51], v[112:115], v[152:155], v[48:51]
    v_mfma_f32_16x16x32_bf16 v[20:23], v[112:115], v[148:151], v[20:23]
    ds_read_b128 v[112:115], v248 offset:14336
    v_mfma_f32_16x16x32_bf16 v[52:55], v[116:119], v[152:155], v[52:55]
    v_mfma_f32_16x16x32_bf16 v[24:27], v[116:119], v[148:151], v[24:27]
    ds_read_b128 v[116:119], v248 offset:15360
    v_mfma_f32_16x16x32_bf16 v[56:59], v[120:123], v[152:155], v[56:59]
    v_mfma_f32_16x16x32_bf16 v[28:31], v[120:123], v[148:151], v[28:31]
    ds_read_b128 v[120:123], v248 offset:16384
    s_waitcnt lgkmcnt(4)
    v_mfma_f32_16x16x32_bf16 v[60:63], v[124:127], v[152:155], v[60:63]
    v_mfma_f32_16x16x32_bf16 v[32:35], v[124:127], v[148:151], v[32:35]
    ds_read_b128 v[124:127], v248 offset:17408
    v_mfma_f32_16x16x32_bf16 v[64:67], v[152:155], v[128:131], v[64:67]
    v_mfma_f32_16x16x32_bf16 v[36:39], v[148:151], v[128:131], v[36:39]
    ds_read_b128 v[128:131], v248 offset:18432
    v_mfma_f32_16x16x32_bf16 v[68:71], v[152:155], v[132:135], v[68:71]
    v_mfma_f32_16x16x32_bf16 v[40:43], v[148:151], v[132:135], v[40:43]
    ds_read_b128 v[132:135], v248 offset:19456
    s_waitcnt lgkmcnt(6)
    v_mfma_f32_16x16x32_bf16 v[72:75], v[136:139], v[152:155], v[72:75]
    v_mfma_f32_16x16x32_bf16 v[44:47], v[136:139], v[148:151], v[44:47]
    ds_read_b128 v[136:139], v248 offset:20480
    s_waitcnt lgkmcnt(4)
    v_mfma_f32_16x16x32_bf16 v[48:51], v[112:115], v[160:163], v[48:51]
    v_mfma_f32_16x16x32_bf16 v[20:23], v[112:115], v[156:159], v[20:23]
    ds_read_b128 v[112:115], v248 offset:21504
    v_mfma_f32_16x16x32_bf16 v[52:55], v[116:119], v[160:163], v[52:55]
    v_mfma_f32_16x16x32_bf16 v[24:27], v[116:119], v[156:159], v[24:27]
    ds_read_b128 v[116:119], v248 offset:22528
    v_mfma_f32_16x16x32_bf16 v[56:59], v[120:123], v[160:163], v[56:59]
    ds_read_b32 v243, v242 offset:0
    v_mfma_f32_16x16x32_bf16 v[28:31], v[120:123], v[156:159], v[28:31]
    ds_read_b128 v[120:123], v248 offset:23552
    s_waitcnt lgkmcnt(5)
    v_mfma_f32_16x16x32_bf16 v[60:63], v[124:127], v[160:163], v[60:63]
    v_mfma_f32_16x16x32_bf16 v[32:35], v[124:127], v[156:159], v[32:35]
    ds_read_b128 v[124:127], v248 offset:24576
    v_mfma_f32_16x16x32_bf16 v[64:67], v[160:163], v[128:131], v[64:67]
    v_mfma_f32_16x16x32_bf16 v[36:39], v[156:159], v[128:131], v[36:39]
    ds_read_b128 v[128:131], v248 offset:25600
    v_mfma_f32_16x16x32_bf16 v[68:71], v[160:163], v[132:135], v[68:71]
    v_mfma_f32_16x16x32_bf16 v[40:43], v[156:159], v[132:135], v[40:43]
    ds_read_b128 v[132:135], v248 offset:26624
    s_waitcnt lgkmcnt(7)
    v_mfma_f32_16x16x32_bf16 v[72:75], v[136:139], v[160:163], v[72:75]
    v_mfma_f32_16x16x32_bf16 v[44:47], v[136:139], v[156:159], v[44:47]
    ds_read_b128 v[136:139], v248 offset:27648
    s_waitcnt lgkmcnt(5)
    v_cmp_gt_u32 vcc, 4, v243
    s_nop 0
    s_cbranch_vccnz SPINC_12
SPIND_11:
    s_waitcnt lgkmcnt(4)
    v_mfma_f32_16x16x32_bf16 v[48:51], v[112:115], v[80:83], v[48:51]
    v_mfma_f32_16x16x32_bf16 v[20:23], v[112:115], v[76:79], v[20:23]
    ds_read_b128 v[112:115], v248 offset:28672
    v_mfma_f32_16x16x32_bf16 v[52:55], v[116:119], v[80:83], v[52:55]
    v_mfma_f32_16x16x32_bf16 v[24:27], v[116:119], v[76:79], v[24:27]
    ds_read_b128 v[116:119], v248 offset:29696
    v_mfma_f32_16x16x32_bf16 v[56:59], v[120:123], v[80:83], v[56:59]
    v_mfma_f32_16x16x32_bf16 v[28:31], v[120:123], v[76:79], v[28:31]
    ds_read_b128 v[120:123], v248 offset:30720
    s_waitcnt lgkmcnt(4)
    v_mfma_f32_16x16x32_bf16 v[60:63], v[124:127], v[80:83], v[60:63]
    v_mfma_f32_16x16x32_bf16 v[32:35], v[124:127], v[76:79], v[32:35]
    ds_read_b128 v[124:127], v248 offset:31744
    v_mfma_f32_16x16x32_bf16 v[64:67], v[80:83], v[128:131], v[64:67]
    v_mfma_f32_16x16x32_bf16 v[36:39], v[76:79], v[128:131], v[36:39]
    ds_read_b128 v[128:131], v248 offset:32768
    v_mfma_f32_16x16x32_bf16 v[68:71], v[80:83], v[132:135], v[68:71]
    v_mfma_f32_16x16x32_bf16 v[40:43], v[76:79], v[132:135], v[40:43]
    ds_read_b128 v[132:135], v248 offset:33792
    s_waitcnt lgkmcnt(6)
    v_mfma_f32_16x16x32_bf16 v[72:75], v[136:139], v[80:83], v[72:75]
    v_mfma_f32_16x16x32_bf16 v[44:47], v[136:139], v[76:79], v[44:47]
    ds_read_b128 v[136:139], v248 offset:34816
    s_waitcnt lgkmcnt(4)
    v_mfma_f32_16x16x32_bf16 v[48:51], v[112:115], v[236:239], v[48:51]
    v_mfma_f32_16x16x32_bf16 v[20:23], v[112:115], v[244:247], v[20:23]
    ds_read_b128 v[112:115], v248 offset:35840
    v_mfma_f32_16x16x32_bf16 v[52:55], v[116:119], v[236:239], v[52:55]
    v_mfma_f32_16x16x32_bf16 v[24:27], v[116:119], v[244:247], v[24:27]
    ds_read_b128 v[116:119], v248 offset:36864
    v_mfma_f32_16x16x32_bf16 v[56:59], v[120:123], v[236:239], v[56:59]
    ds_read_b32 v243, v242 offset:4
    v_mfma_f32_16x16x32_bf16 v[28:31], v[120:123], v[244:247], v[28:31]
    ds_read_b128 v[120:123], v248 offset:37888
    s_waitcnt lgkmcnt(5)
    v_mfma_f32_16x16x32_bf16 v[60:63], v[124:127], v[236:239], v[60:63]
    v_mfma_f32_16x16x32_bf16 v[32:35], v[124:127], v[244:247], v[32:35]
    ds_read_b128 v[124:127], v248 offset:38912
    v_mfma_f32_16x16x32_bf16 v[64:67], v[236:239], v[128:131], v[64:67]
    v_mfma_f32_16x16x32_bf16 v[36:39], v[244:247], v[128:131], v[36:39]
    ds_read_b128 v[128:131], v248 offset:39936
    v_mfma_f32_16x16x32_bf16 v[68:71], v[236:239], v[132:135], v[68:71]
    v_mfma_f32_16x16x32_bf16 v[40:43], v[244:247], v[132:135], v[40:43]
    ds_read_b128 v[132:135], v248 offset:40960
    s_waitcnt lgkmcnt(7)
    v_mfma_f32_16x16x32_bf16 v[72:75], v[136:139], v[236:239], v[72:75]
    v_mfma_f32_16x16x32_bf16 v[44:47], v[136:139], v[244:247], v[44:47]
    ds_read_b128 v[136:139], v248 offset:41984
    s_waitcnt lgkmcnt(5)
    v_cmp_gt_u32 vcc, 4, v243
    s_nop 0
    s_cbranch_vccnz SPINC_15
SPIND_14:
    s_waitcnt lgkmcnt(4)
    v_mfma_f32_16x16x32_bf16 v[48:51], v[112:115], v[8:11], v[48:51]
    v_mfma_f32_16x16x32_bf16 v[20:23], v[112:115], v[4:7], v[20:23]
    ds_read_b128 v[112:115], v248 offset:43008
    v_mfma_f32_16x16x32_bf16 v[52:55], v[116:119], v[8:11], v[52:55]
    v_mfma_f32_16x16x32_bf16 v[24:27], v[116:119], v[4:7], v[24:27]
    ds_read_b128 v[116:119], v248 offset:44032
    v_mfma_f32_16x16x32_bf16 v[56:59], v[120:123], v[8:11], v[56:59]
    v_mfma_f32_16x16x32_bf16 v[28:31], v[120:123], v[4:7], v[28:31]
    ds_read_b128 v[120:123], v248 offset:45056
    s_waitcnt lgkmcnt(4)
    v_mfma_f32_16x16x32_bf16 v[60:63], v[124:127], v[8:11], v[60:63]
    v_mfma_f32_16x16x32_bf16 v[32:35], v[124:127], v[4:7], v[32:35]
    ds_read_b128 v[124:127], v248 offset:46080
    v_mfma_f32_16x16x32_bf16 v[64:67], v[8:11], v[128:131], v[64:67]
    v_mfma_f32_16x16x32_bf16 v[36:39], v[4:7], v[128:131], v[36:39]
    ds_read_b128 v[128:131], v248 offset:47104
    v_mfma_f32_16x16x32_bf16 v[68:71], v[8:11], v[132:135], v[68:71]
    v_mfma_f32_16x16x32_bf16 v[40:43], v[4:7], v[132:135], v[40:43]
    ds_read_b128 v[132:135], v248 offset:48128
    s_waitcnt lgkmcnt(6)
    v_mfma_f32_16x16x32_bf16 v[72:75], v[136:139], v[8:11], v[72:75]
    v_mfma_f32_16x16x32_bf16 v[44:47], v[136:139], v[4:7], v[44:47]
    ds_read_b128 v[136:139], v248 offset:49152
    s_waitcnt lgkmcnt(4)
    v_mfma_f32_16x16x32_bf16 v[48:51], v[112:115], v[88:91], v[48:51]
    s_lshl_b32 s28, s86, 10
    s_lshl_b32 s29, s87, 10
    v_mfma_f32_16x16x32_bf16 v[20:23], v[112:115], v[84:87], v[20:23]
    ds_read_b128 v[112:115], v248 offset:50176
    v_add_u32 v244, s28, v0
    v_mfma_f32_16x16x32_bf16 v[52:55], v[116:119], v[88:91], v[52:55]
    v_add_u32 v245, s29, v0
    v_add_u32 v246, 129024, v0
    v_mfma_f32_16x16x32_bf16 v[24:27], v[116:119], v[84:87], v[24:27]
    ds_read_b128 v[116:119], v248 offset:51200
    v_add_u32 v247, 145408, v2
    v_mfma_f32_16x16x32_bf16 v[56:59], v[120:123], v[88:91], v[56:59]
    v_mul_u32_u24 v251, 1152, v249
    v_lshl_add_u32 v14, v250, 4, v251
    v_mfma_f32_16x16x32_bf16 v[28:31], v[120:123], v[84:87], v[28:31]
    ds_read_b128 v[120:123], v248 offset:52224
    v_lshl_add_u32 v15, v250, 3, v251
    s_waitcnt lgkmcnt(4)
    v_mfma_f32_16x16x32_bf16 v[60:63], v[124:127], v[88:91], v[60:63]
    s_mul_i32 s28, s21, 144
    s_add_u32 s28, s28, s88
    v_mfma_f32_16x16x32_bf16 v[32:35], v[124:127], v[84:87], v[32:35]
    ds_read_b128 v[124:127], v248 offset:53248
    v_mov_b32 v12, 0
    v_mfma_f32_16x16x32_bf16 v[64:67], v[88:91], v[128:131], v[64:67]
    v_mov_b32 v13, 0
    buffer_load_dwordx4 v[4:7], v14, s[8:11], s28 offen
    v_mfma_f32_16x16x32_bf16 v[36:39], v[84:87], v[128:131], v[36:39]
    ds_read_b128 v[128:131], v248 offset:54272
    buffer_load_dwordx4 v[8:11], v14, s[8:11], s28 offen offset:64
    v_mfma_f32_16x16x32_bf16 v[68:71], v[88:91], v[132:135], v[68:71]
    s_mov_b32 exec_hi, 0
    buffer_load_dwordx2 v[12:13], v15, s[8:11], s28 offen offset:128
    s_mov_b64 exec, -1
    v_mfma_f32_16x16x32_bf16 v[40:43], v[84:87], v[132:135], v[40:43]
    ds_read_b128 v[132:135], v248 offset:55296
    s_waitcnt lgkmcnt(6)
    v_mfma_f32_16x16x32_bf16 v[72:75], v[136:139], v[88:91], v[72:75]
    v_mfma_f32_16x16x32_bf16 v[44:47], v[136:139], v[84:87], v[44:47]
    ds_read_b128 v[136:139], v248 offset:56320
    s_waitcnt lgkmcnt(4)
    v_mfma_f32_16x16x32_bf16 v[48:51], v[112:115], v[96:99], v[48:51]
    v_mfma_f32_16x16x32_bf16 v[20:23], v[112:115], v[92:95], v[20:23]
    ds_read_b128 v[112:115], v248 offset:57344
    v_mfma_f32_16x16x32_bf16 v[52:55], v[116:119], v[96:99], v[52:55]
    v_mfma_f32_16x16x32_bf16 v[24:27], v[116:119], v[92:95], v[24:27]
    ds_read_b128 v[116:119], v248 offset:58368
    v_mfma_f32_16x16x32_bf16 v[56:59], v[120:123], v[96:99], v[56:59]
    ds_read_b32 v243, v242 offset:8
    v_mfma_f32_16x16x32_bf16 v[28:31], v[120:123], v[92:95], v[28:31]
    ds_read_b128 v[120:123], v248 offset:59392
    s_waitcnt lgkmcnt(5)
    v_mfma_f32_16x16x32_bf16 v[60:63], v[124:127], v[96:99], v[60:63]
    v_mfma_f32_16x16x32_bf16 v[32:35], v[124:127], v[92:95], v[32:35]
    ds_read_b128 v[124:127], v248 offset:60416
    v_mfma_f32_16x16x32_bf16 v[64:67], v[96:99], v[128:131], v[64:67]
    v_mfma_f32_16x16x32_bf16 v[36:39], v[92:95], v[128:131], v[36:39]
    ds_read_b128 v[128:131], v248 offset:61440
    v_mfma_f32_16x16x32_bf16 v[68:71], v[96:99], v[132:135], v[68:71]
    v_mfma_f32_16x16x32_bf16 v[40:43], v[92:95], v[132:135], v[40:43]
    ds_read_b128 v[132:135], v248 offset:62464
    s_waitcnt lgkmcnt(7)
    v_mfma_f32_16x16x32_bf16 v[72:75], v[136:139], v[96:99], v[72:75]
    v_mfma_f32_16x16x32_bf16 v[44:47], v[136:139], v[92:95], v[44:47]
    ds_read_b128 v[136:139], v248 offset:63488
    s_waitcnt lgkmcnt(5)
    v_cmp_gt_u32 vcc, 4, v243
    s_nop 0
    s_cbranch_vccnz SPINC_18
SPIND_17:
    s_waitcnt lgkmcnt(4)
    v_mfma_f32_16x16x32_bf16 v[48:51], v[112:115], v[104:107], v[48:51]
    v_add_u32 v248, 64512, v248
    v_mfma_f32_16x16x32_bf16 v[20:23], v[112:115], v[100:103], v[20:23]
    ds_read_b128 v[112:115], v248 offset:0
    v_mfma_f32_16x16x32_bf16 v[52:55], v[116:119], v[104:107], v[52:55]
    ds_read_b128 v[140:143], v246 offset:0
    v_mfma_f32_16x16x32_bf16 v[24:27], v[116:119], v[100:103], v[24:27]
    ds_read_b128 v[116:119], v248 offset:1024
    v_mfma_f32_16x16x32_bf16 v[56:59], v[120:123], v[104:107], v[56:59]
    ds_read_b128 v[144:147], v244 offset:0
    v_mfma_f32_16x16x32_bf16 v[28:31], v[120:123], v[100:103], v[28:31]
    ds_read_b128 v[120:123], v248 offset:2048
    s_waitcnt lgkmcnt(6)
    v_mfma_f32_16x16x32_bf16 v[60:63], v[124:127], v[104:107], v[60:63]
    ds_read_b128 v[148:151], v245 offset:0
    v_mfma_f32_16x16x32_bf16 v[32:35], v[124:127], v[100:103], v[32:35]
    ds_read_b128 v[124:127], v248 offset:3072
    v_mfma_f32_16x16x32_bf16 v[64:67], v[104:107], v[128:131], v[64:67]
    ds_read_b128 v[152:155], v246 offset:1024
    v_mfma_f32_16x16x32_bf16 v[36:39], v[100:103], v[128:131], v[36:39]
    ds_read_b128 v[128:131], v248 offset:4096
    v_mfma_f32_16x16x32_bf16 v[68:71], v[104:107], v[132:135], v[68:71]
    ds_read_b128 v[156:159], v244 offset:7168
    v_mfma_f32_16x16x32_bf16 v[40:43], v[100:103], v[132:135], v[40:43]
    ds_read_b128 v[132:135], v248 offset:5120
    s_waitcnt lgkmcnt(11)
    v_mfma_f32_16x16x32_bf16 v[72:75], v[136:139], v[104:107], v[72:75]
    ds_read_b128 v[160:163], v245 offset:7168
    v_mfma_f32_16x16x32_bf16 v[44:47], v[136:139], v[100:103], v[44:47]
    ds_read_b128 v[136:139], v248 offset:6144
    s_waitcnt lgkmcnt(7)
    v_mfma_f32_16x16x32_bf16 v[48:51], v[112:115], v[252:255], v[48:51]
    v_mfma_f32_16x16x32_bf16 v[20:23], v[112:115], v[108:111], v[20:23]
    ds_read_b128 v[112:115], v248 offset:7168
    v_mfma_f32_16x16x32_bf16 v[52:55], v[116:119], v[252:255], v[52:55]
    v_mfma_f32_16x16x32_bf16 v[24:27], v[116:119], v[108:111], v[24:27]
    ds_read_b128 v[116:119], v248 offset:8192
    v_mfma_f32_16x16x32_bf16 v[76:79], v[144:147], v[140:143], 0
    v_mfma_f32_16x16x32_bf16 v[80:83], v[140:143], v[148:151], 0
    ds_read_b128 v[140:143], v246 offset:2048
    v_mfma_f32_16x16x32_bf16 v[56:59], v[120:123], v[252:255], v[56:59]
    ds_read_b128 v[144:147], v244 offset:14336
    v_mfma_f32_16x16x32_bf16 v[28:31], v[120:123], v[108:111], v[28:31]
    ds_read_b128 v[120:123], v248 offset:9216
    s_waitcnt lgkmcnt(6)
    v_mfma_f32_16x16x32_bf16 v[60:63], v[124:127], v[252:255], v[60:63]
    ds_read_b128 v[148:151], v245 offset:14336
    v_mfma_f32_16x16x32_bf16 v[32:35], v[124:127], v[108:111], v[32:35]
    ds_read_b128 v[124:127], v248 offset:10240
    v_mfma_f32_16x16x32_bf16 v[64:67], v[252:255], v[128:131], v[64:67]
    v_mfma_f32_16x16x32_bf16 v[36:39], v[108:111], v[128:131], v[36:39]
    ds_read_b128 v[128:131], v248 offset:11264
    v_mfma_f32_16x16x32_bf16 v[76:79], v[156:159], v[152:155], v[76:79]
    v_mfma_f32_16x16x32_bf16 v[80:83], v[152:155], v[160:163], v[80:83]
    ds_read_b128 v[152:155], v246 offset:3072
    v_mfma_f32_16x16x32_bf16 v[68:71], v[252:255], v[132:135], v[68:71]
    ds_read_b128 v[156:159], v244 offset:21504
    v_mfma_f32_16x16x32_bf16 v[40:43], v[108:111], v[132:135], v[40:43]
    ds_read_b128 v[132:135], v248 offset:12288
    s_waitcnt lgkmcnt(11)
    v_mfma_f32_16x16x32_bf16 v[72:75], v[136:139], v[252:255], v[72:75]
    ds_read_b128 v[160:163], v245 offset:21504
    v_mfma_f32_16x16x32_bf16 v[44:47], v[136:139], v[108:111], v[44:47]
    ds_read_b128 v[136:139], v248 offset:13312
    s_waitcnt lgkmcnt(7)
    v_mfma_f32_16x16x32_bf16 v[48:51], v[112:115], v[184:187], v[48:51]
    v_mfma_f32_16x16x32_bf16 v[20:23], v[112:115], v[180:183], v[20:23]
    ds_read_b128 v[112:115], v248 offset:14336
    v_mfma_f32_16x16x32_bf16 v[52:55], v[116:119], v[184:187], v[52:55]
    v_mfma_f32_16x16x32_bf16 v[24:27], v[116:119], v[180:183], v[24:27]
    ds_read_b128 v[116:119], v248 offset:15360
    v_mfma_f32_16x16x32_bf16 v[76:79], v[144:147], v[140:143], v[76:79]
    v_mfma_f32_16x16x32_bf16 v[80:83], v[140:143], v[148:151], v[80:83]
    ds_read_b128 v[140:143], v246 offset:4096
    v_mfma_f32_16x16x32_bf16 v[56:59], v[120:123], v[184:187], v[56:59]
    ds_read_b128 v[144:147], v244 offset:28672
    v_mfma_f32_16x16x32_bf16 v[28:31], v[120:123], v[180:183], v[28:31]
    ds_read_b128 v[120:123], v248 offset:16384
    s_waitcnt lgkmcnt(6)
    v_mfma_f32_16x16x32_bf16 v[60:63], v[124:127], v[184:187], v[60:63]
    ds_read_b128 v[148:151], v245 offset:28672
    v_mfma_f32_16x16x32_bf16 v[32:35], v[124:127], v[180:183], v[32:35]
    ds_read_b128 v[124:127], v248 offset:17408
    v_mfma_f32_16x16x32_bf16 v[64:67], v[184:187], v[128:131], v[64:67]
    v_mfma_f32_16x16x32_bf16 v[36:39], v[180:183], v[128:131], v[36:39]
    ds_read_b128 v[128:131], v248 offset:18432
    v_mfma_f32_16x16x32_bf16 v[76:79], v[156:159], v[152:155], v[76:79]
    v_mfma_f32_16x16x32_bf16 v[80:83], v[152:155], v[160:163], v[80:83]
    ds_read_b128 v[152:155], v246 offset:5120
    v_mfma_f32_16x16x32_bf16 v[68:71], v[184:187], v[132:135], v[68:71]
    ds_read_b128 v[156:159], v244 offset:35840
    v_mfma_f32_16x16x32_bf16 v[40:43], v[180:183], v[132:135], v[40:43]
    ds_read_b128 v[132:135], v248 offset:19456
    s_waitcnt lgkmcnt(11)
    v_mfma_f32_16x16x32_bf16 v[72:75], v[136:139], v[184:187], v[72:75]
    ds_read_b128 v[160:163], v245 offset:35840
    v_mfma_f32_16x16x32_bf16 v[44:47], v[136:139], v[180:183], v[44:47]
    ds_read_b128 v[136:139], v248 offset:20480
    v_and_b32 v14, 31, v3
    v_lshlrev_b32 v14, 8, v14
    s_and_b32 s28, s16, 0xe0
    s_lshl_b32 s28, s28, 8
    s_add_u32 s28, s28, 4228
    s_barrier
    buffer_load_dword v15, v14, s[4:7], s28 offen sc1
    s_waitcnt lgkmcnt(7)
    v_mfma_f32_16x16x32_bf16 v[48:51], v[112:115], v[192:195], v[48:51]
    v_mfma_f32_16x16x32_bf16 v[20:23], v[112:115], v[188:191], v[20:23]
    ds_read_b128 v[112:115], v248 offset:21504
    v_mfma_f32_16x16x32_bf16 v[52:55], v[116:119], v[192:195], v[52:55]
    v_mfma_f32_16x16x32_bf16 v[24:27], v[116:119], v[188:191], v[24:27]
    ds_read_b128 v[116:119], v248 offset:22528
    v_mfma_f32_16x16x32_bf16 v[76:79], v[144:147], v[140:143], v[76:79]
    v_mfma_f32_16x16x32_bf16 v[80:83], v[140:143], v[148:151], v[80:83]
    ds_read_b128 v[140:143], v246 offset:6144
    v_mfma_f32_16x16x32_bf16 v[56:59], v[120:123], v[192:195], v[56:59]
    ds_read_b128 v[144:147], v244 offset:43008
    v_mfma_f32_16x16x32_bf16 v[28:31], v[120:123], v[188:191], v[28:31]
    ds_read_b128 v[120:123], v248 offset:23552
    s_waitcnt lgkmcnt(6)
    v_mfma_f32_16x16x32_bf16 v[60:63], v[124:127], v[192:195], v[60:63]
    ds_read_b128 v[148:151], v245 offset:43008
    v_mfma_f32_16x16x32_bf16 v[32:35], v[124:127], v[188:191], v[32:35]
    ds_read_b128 v[124:127], v248 offset:24576
    v_mfma_f32_16x16x32_bf16 v[64:67], v[192:195], v[128:131], v[64:67]
    v_mfma_f32_16x16x32_bf16 v[36:39], v[188:191], v[128:131], v[36:39]
    ds_read_b128 v[128:131], v248 offset:25600
    v_mfma_f32_16x16x32_bf16 v[76:79], v[156:159], v[152:155], v[76:79]
    v_mfma_f32_16x16x32_bf16 v[80:83], v[152:155], v[160:163], v[80:83]
    ds_read_b128 v[152:155], v246 offset:7168
    v_mfma_f32_16x16x32_bf16 v[68:71], v[192:195], v[132:135], v[68:71]
    ds_read_b128 v[156:159], v244 offset:50176
    v_mfma_f32_16x16x32_bf16 v[40:43], v[188:191], v[132:135], v[40:43]
    ds_read_b128 v[132:135], v248 offset:26624
    s_waitcnt lgkmcnt(11)
    v_mfma_f32_16x16x32_bf16 v[72:75], v[136:139], v[192:195], v[72:75]
    ds_read_b128 v[160:163], v245 offset:50176
    v_mfma_f32_16x16x32_bf16 v[44:47], v[136:139], v[188:191], v[44:47]
    ds_read_b128 v[136:139], v248 offset:27648
    s_waitcnt lgkmcnt(7)
    v_mfma_f32_16x16x32_bf16 v[48:51], v[112:115], v[200:203], v[48:51]
    ds_read2_b32 v[238:239], v240 offset0:64 offset1:80
    v_mov_b32 v243, 0xf149f2ca
    v_mfma_f32_16x16x32_bf16 v[20:23], v[112:115], v[196:199], v[20:23]
    ds_read_b128 v[112:115], v248 offset:28672
    v_and_b32 v242, 1, v249
    v_mfma_f32_16x16x32_bf16 v[52:55], v[116:119], v[200:203], v[52:55]
    v_lshlrev_b32 v242, 4, v242
    v_lshlrev_b32 v240, v242, s72
    v_mfma_f32_16x16x32_bf16 v[24:27], v[116:119], v[196:199], v[24:27]
    ds_read_b128 v[116:119], v248 offset:29696
    v_lshl_add_u32 v251, v250, 2, 0
    v_mfma_f32_16x16x32_bf16 v[76:79], v[144:147], v[140:143], v[76:79]
    v_sub_u32 v251, v249, v251
    v_cmp_le_i32 vcc, 0, v251
    v_mfma_f32_16x16x32_bf16 v[80:83], v[140:143], v[148:151], v[80:83]
    ds_read_b128 v[140:143], v246 offset:8192
    v_cndmask_b32 v194, 0, v240, vcc
    v_mfma_f32_16x16x32_bf16 v[56:59], v[120:123], v[200:203], v[56:59]
    ds_read_b128 v[144:147], v244 offset:57344
    v_cndmask_b32 v192, v240, 0, vcc
    v_mfma_f32_16x16x32_bf16 v[28:31], v[120:123], v[196:199], v[28:31]
    ds_read_b128 v[120:123], v248 offset:30720
    v_and_b32 v251, 0x80000001, v251
    s_waitcnt lgkmcnt(7)
    v_mfma_f32_16x16x32_bf16 v[60:63], v[124:127], v[200:203], v[60:63]
    ds_read_b128 v[148:151], v245 offset:57344
    v_cmp_eq_u32 vcc, 0, v251
    v_mfma_f32_16x16x32_bf16 v[32:35], v[124:127], v[196:199], v[32:35]
    ds_read_b128 v[124:127], v248 offset:31744
    v_cndmask_b32 v184, v243, 0, vcc
    v_mfma_f32_16x16x32_bf16 v[64:67], v[200:203], v[128:131], v[64:67]
    v_cmp_eq_u32 vcc, 0x80000000, v251
    s_nop 1
    v_cndmask_b32 v180, v243, 0, vcc
    v_mfma_f32_16x16x32_bf16 v[36:39], v[196:199], v[128:131], v[36:39]
    ds_read_b128 v[128:131], v248 offset:32768
    v_cndmask_b32 v188, v180, v243, s[62:63]
    v_mfma_f32_16x16x32_bf16 v[76:79], v[156:159], v[152:155], v[76:79]
    v_lshl_add_u32 v251, v250, 2, 1
    v_sub_u32 v251, v249, v251
    v_mfma_f32_16x16x32_bf16 v[80:83], v[152:155], v[160:163], v[80:83]
    v_add_u32 v244, 64512, v244
    v_and_b32 v251, 0x80000001, v251
    v_mfma_f32_16x16x32_bf16 v[68:71], v[200:203], v[132:135], v[68:71]
    v_add_u32 v245, 64512, v245
    v_cmp_eq_u32 vcc, 0, v251
    v_mfma_f32_16x16x32_bf16 v[40:43], v[196:199], v[132:135], v[40:43]
    ds_read_b128 v[132:135], v248 offset:33792
    v_cndmask_b32 v185, v243, 0, vcc
    s_waitcnt lgkmcnt(10)
    v_mfma_f32_16x16x32_bf16 v[72:75], v[136:139], v[200:203], v[72:75]
    ds_read_b128 v[152:155], v246 offset:9216
    v_cmp_eq_u32 vcc, 0x80000000, v251
    v_mfma_f32_16x16x32_bf16 v[44:47], v[136:139], v[196:199], v[44:47]
    ds_read_b128 v[136:139], v248 offset:34816
    v_cndmask_b32 v181, v243, 0, vcc
    ds_read_b128 v[156:159], v244 offset:0
    ds_read_b128 v[160:163], v245 offset:0
    s_waitcnt lgkmcnt(7)
    v_mfma_f32_16x16x32_bf16 v[48:51], v[112:115], v[208:211], v[48:51]
    v_cndmask_b32 v189, v181, v243, s[62:63]
    v_lshl_add_u32 v251, v250, 2, 2
    v_mfma_f32_16x16x32_bf16 v[20:23], v[112:115], v[204:207], v[20:23]
    ds_read_b128 v[112:115], v248 offset:35840
    v_sub_u32 v251, v249, v251
    v_mfma_f32_16x16x32_bf16 v[52:55], v[116:119], v[208:211], v[52:55]
    v_cmp_le_i32 vcc, 0, v251
    s_nop 1
    v_cndmask_b32 v195, 0, v240, vcc
    v_mfma_f32_16x16x32_bf16 v[24:27], v[116:119], v[204:207], v[24:27]
    ds_read_b128 v[116:119], v248 offset:36864
    v_cndmask_b32 v193, v240, 0, vcc
    v_mfma_f32_16x16x32_bf16 v[76:79], v[144:147], v[140:143], v[76:79]
    v_and_b32 v251, 0x80000001, v251
    v_cmp_eq_u32 vcc, 0, v251
    v_mfma_f32_16x16x32_bf16 v[80:83], v[140:143], v[148:151], v[80:83]
    ds_read_b128 v[140:143], v246 offset:10240
    v_cndmask_b32 v186, v243, 0, vcc
    v_mfma_f32_16x16x32_bf16 v[56:59], v[120:123], v[208:211], v[56:59]
    ds_read_b128 v[144:147], v244 offset:7168
    v_cmp_eq_u32 vcc, 0x80000000, v251
    v_mfma_f32_16x16x32_bf16 v[28:31], v[120:123], v[204:207], v[28:31]
    ds_read_b128 v[120:123], v248 offset:37888
    v_cndmask_b32 v182, v243, 0, vcc
    s_waitcnt lgkmcnt(5)
    v_mfma_f32_16x16x32_bf16 v[60:63], v[124:127], v[208:211], v[60:63]
    ds_read_b128 v[148:151], v245 offset:7168
    v_cndmask_b32 v190, v182, v243, s[62:63]
    v_mfma_f32_16x16x32_bf16 v[32:35], v[124:127], v[204:207], v[32:35]
    ds_read_b128 v[124:127], v248 offset:38912
    v_lshl_add_u32 v251, v250, 2, 3
    v_mfma_f32_16x16x32_bf16 v[64:67], v[208:211], v[128:131], v[64:67]
    v_sub_u32 v251, v249, v251
    v_and_b32 v251, 0x80000001, v251
    v_mfma_f32_16x16x32_bf16 v[36:39], v[204:207], v[128:131], v[36:39]
    ds_read_b128 v[128:131], v248 offset:39936
    v_cmp_eq_u32 vcc, 0, v251
    v_mfma_f32_16x16x32_bf16 v[76:79], v[156:159], v[152:155], v[76:79]
    s_nop 0
    v_cndmask_b32 v187, v243, 0, vcc
    v_cmp_eq_u32 vcc, 0x80000000, v251
    v_mfma_f32_16x16x32_bf16 v[80:83], v[152:155], v[160:163], v[80:83]
    ds_read_b128 v[152:155], v246 offset:11264
    v_cndmask_b32 v183, v243, 0, vcc
    v_mfma_f32_16x16x32_bf16 v[68:71], v[208:211], v[132:135], v[68:71]
    ds_read_b128 v[156:159], v244 offset:14336
    v_cndmask_b32 v191, v183, v243, s[62:63]
    v_mfma_f32_16x16x32_bf16 v[40:43], v[204:207], v[132:135], v[40:43]
    ds_read_b128 v[132:135], v248 offset:40960
    v_add_u32 v196, s32, v1
    v_mfma_f32_16x16x32_bf16 v[72:75], v[136:139], v[208:211], v[72:75]
    ds_read_b128 v[160:163], v245 offset:14336
    v_lshl_add_u32 v197, v3, 2, s32
    v_mfma_f32_16x16x32_bf16 v[44:47], v[136:139], v[204:207], v[44:47]
    ds_read_b128 v[136:139], v248 offset:41984
    v_lshl_add_u32 v198, v249, 4, s33
    s_waitcnt lgkmcnt(7)
    v_mfma_f32_16x16x32_bf16 v[48:51], v[112:115], v[216:219], v[48:51]
    v_lshlrev_b32 v199, 4, v250
    v_lshlrev_b32 v200, 2, v249
    v_mfma_f32_16x16x32_bf16 v[20:23], v[112:115], v[212:215], v[20:23]
    ds_read_b128 v[112:115], v248 offset:43008
    v_add_u32 v202, s38, v199
    v_mfma_f32_16x16x32_bf16 v[52:55], v[116:119], v[216:219], v[52:55]
    v_add_u32 v203, s39, v200
    v_add_u32 v199, 160512, v199
    v_mfma_f32_16x16x32_bf16 v[24:27], v[116:119], v[212:215], v[24:27]
    ds_read_b128 v[116:119], v248 offset:44032
    v_add_u32 v200, 160512, v200
    v_mfma_f32_16x16x32_bf16 v[76:79], v[144:147], v[140:143], v[76:79]
    v_and_b32 v201, 60, v3
    v_lshl_add_u32 v201, v201, 2, s33
    v_mfma_f32_16x16x32_bf16 v[80:83], v[140:143], v[148:151], v[80:83]
    ds_read_b128 v[140:143], v246 offset:12288
    v_mov_b32 v207, 0
    v_mfma_f32_16x16x32_bf16 v[56:59], v[120:123], v[216:219], v[56:59]
    ds_read_b128 v[144:147], v244 offset:21504
    v_mov_b32 v211, 0
    v_mfma_f32_16x16x32_bf16 v[28:31], v[120:123], v[212:215], v[28:31]
    ds_read_b128 v[120:123], v248 offset:45056
    s_waitcnt lgkmcnt(6)
    v_mfma_f32_16x16x32_bf16 v[60:63], v[124:127], v[216:219], v[60:63]
    ds_read_b128 v[148:151], v245 offset:21504
    v_mfma_f32_16x16x32_bf16 v[32:35], v[124:127], v[212:215], v[32:35]
    ds_read_b128 v[124:127], v248 offset:46080
    v_mfma_f32_16x16x32_bf16 v[64:67], v[216:219], v[128:131], v[64:67]
    v_mfma_f32_16x16x32_bf16 v[36:39], v[212:215], v[128:131], v[36:39]
    ds_read_b128 v[128:131], v248 offset:47104
    v_mfma_f32_16x16x32_bf16 v[76:79], v[156:159], v[152:155], v[76:79]
    v_mfma_f32_16x16x32_bf16 v[80:83], v[152:155], v[160:163], v[80:83]
    ds_read_b128 v[152:155], v246 offset:13312
    v_mfma_f32_16x16x32_bf16 v[68:71], v[216:219], v[132:135], v[68:71]
    ds_read_b128 v[156:159], v244 offset:28672
    v_mfma_f32_16x16x32_bf16 v[40:43], v[212:215], v[132:135], v[40:43]
    ds_read_b128 v[132:135], v248 offset:48128
    s_waitcnt lgkmcnt(11)
    v_mfma_f32_16x16x32_bf16 v[72:75], v[136:139], v[216:219], v[72:75]
    ds_read_b128 v[160:163], v245 offset:28672
    v_mfma_f32_16x16x32_bf16 v[44:47], v[136:139], v[212:215], v[44:47]
    ds_read_b128 v[136:139], v248 offset:49152
    s_waitcnt lgkmcnt(7)
    v_mfma_f32_16x16x32_bf16 v[48:51], v[112:115], v[224:227], v[48:51]
    v_mov_b32 v215, 0
    v_mov_b32 v219, 0
    v_mfma_f32_16x16x32_bf16 v[20:23], v[112:115], v[220:223], v[20:23]
    ds_read_b128 v[112:115], v248 offset:50176
    s_mul_i32 s28, s17, -1792
    v_mfma_f32_16x16x32_bf16 v[76:79], v[144:147], v[140:143], v[76:79]
    v_mfma_f32_16x16x32_bf16 v[80:83], v[140:143], v[148:151], v[80:83]
    ds_read_b128 v[140:143], v246 offset:14336
    v_mfma_f32_16x16x32_bf16 v[52:55], v[116:119], v[224:227], v[52:55]
    ds_read_b128 v[144:147], v244 offset:35840
    v_mfma_f32_16x16x32_bf16 v[24:27], v[116:119], v[220:223], v[24:27]
    ds_read_b128 v[116:119], v248 offset:51200
    v_mfma_f32_16x16x32_bf16 v[56:59], v[120:123], v[224:227], v[56:59]
    ds_read_b128 v[148:151], v245 offset:35840
    v_mfma_f32_16x16x32_bf16 v[28:31], v[120:123], v[220:223], v[28:31]
    ds_read_b128 v[120:123], v248 offset:52224
    s_waitcnt lgkmcnt(7)
    v_mfma_f32_16x16x32_bf16 v[76:79], v[156:159], v[152:155], v[76:79]
    v_mfma_f32_16x16x32_bf16 v[80:83], v[152:155], v[160:163], v[80:83]
    ds_read_b128 v[152:155], v246 offset:15360
    v_mfma_f32_16x16x32_bf16 v[60:63], v[124:127], v[224:227], v[60:63]
    ds_read_b128 v[156:159], v244 offset:43008
    v_mfma_f32_16x16x32_bf16 v[32:35], v[124:127], v[220:223], v[32:35]
    ds_read_b128 v[124:127], v248 offset:53248
    v_mfma_f32_16x16x32_bf16 v[64:67], v[224:227], v[128:131], v[64:67]
    ds_read_b128 v[160:163], v245 offset:43008
    v_mfma_f32_16x16x32_bf16 v[36:39], v[220:223], v[128:131], v[36:39]
    ds_read_b128 v[128:131], v248 offset:54272
    v_mfma_f32_16x16x32_bf16 v[68:71], v[224:227], v[132:135], v[68:71]
    v_mfma_f32_16x16x32_bf16 v[40:43], v[220:223], v[132:135], v[40:43]
    ds_read_b128 v[132:135], v248 offset:55296
    s_waitcnt lgkmcnt(7)
    v_mfma_f32_16x16x32_bf16 v[76:79], v[144:147], v[140:143], v[76:79]
    v_mfma_f32_16x16x32_bf16 v[80:83], v[140:143], v[148:151], v[80:83]
    ds_read_b128 v[140:143], v246 offset:16384
    v_mfma_f32_16x16x32_bf16 v[72:75], v[136:139], v[224:227], v[72:75]
    ds_read_b128 v[144:147], v244 offset:50176
    v_mfma_f32_16x16x32_bf16 v[44:47], v[136:139], v[220:223], v[44:47]
    ds_read_b128 v[136:139], v248 offset:56320
    ds_read_b128 v[148:151], v245 offset:50176
    s_waitcnt lgkmcnt(6)
    v_mfma_f32_16x16x32_bf16 v[48:51], v[112:115], v[168:171], v[48:51]
    v_add_u32 v225, s28, v196
    v_lshlrev_b32 v226, 2, v3
    v_mfma_f32_16x16x32_bf16 v[20:23], v[112:115], v[164:167], v[20:23]
    ds_read_b128 v[112:115], v248 offset:57344
    v_lshlrev_b32 v227, 4, v249
    v_mfma_f32_16x16x32_bf16 v[76:79], v[156:159], v[152:155], v[76:79]
    v_add_u32 v226, 149504, v226
    v_add_u32 v227, 156672, v227
    v_mfma_f32_16x16x32_bf16 v[80:83], v[152:155], v[160:163], v[80:83]
    ds_read_b128 v[152:155], v246 offset:17408
    v_mfma_f32_16x16x32_bf16 v[52:55], v[116:119], v[168:171], v[52:55]
    ds_read_b128 v[156:159], v244 offset:57344
    v_mfma_f32_16x16x32_bf16 v[24:27], v[116:119], v[164:167], v[24:27]
    ds_read_b128 v[116:119], v248 offset:58368
    v_mfma_f32_16x16x32_bf16 v[56:59], v[120:123], v[168:171], v[56:59]
    ds_read_b128 v[160:163], v245 offset:57344
    v_mfma_f32_16x16x32_bf16 v[28:31], v[120:123], v[164:167], v[28:31]
    ds_read_b128 v[120:123], v248 offset:59392
    s_waitcnt lgkmcnt(6)
    v_mfma_f32_16x16x32_bf16 v[76:79], v[144:147], v[140:143], v[76:79]
    v_mfma_f32_16x16x32_bf16 v[80:83], v[140:143], v[148:151], v[80:83]
    v_mfma_f32_16x16x32_bf16 v[60:63], v[124:127], v[168:171], v[60:63]
    v_mfma_f32_16x16x32_bf16 v[32:35], v[124:127], v[164:167], v[32:35]
    ds_read_b128 v[124:127], v248 offset:60416
    v_mfma_f32_16x16x32_bf16 v[64:67], v[168:171], v[128:131], v[64:67]
    v_mfma_f32_16x16x32_bf16 v[36:39], v[164:167], v[128:131], v[36:39]
    ds_read_b128 v[128:131], v248 offset:61440
    v_mfma_f32_16x16x32_bf16 v[68:71], v[168:171], v[132:135], v[68:71]
    v_mfma_f32_16x16x32_bf16 v[40:43], v[164:167], v[132:135], v[40:43]
    ds_read_b128 v[132:135], v248 offset:62464
    s_waitcnt lgkmcnt(4)
    v_mfma_f32_16x16x32_bf16 v[76:79], v[156:159], v[152:155], v[76:79]
    v_mfma_f32_16x16x32_bf16 v[80:83], v[152:155], v[160:163], v[80:83]
    v_mfma_f32_16x16x32_bf16 v[72:75], v[136:139], v[168:171], v[72:75]
    v_mfma_f32_16x16x32_bf16 v[44:47], v[136:139], v[164:167], v[44:47]
    ds_read_b128 v[136:139], v248 offset:63488
    s_waitcnt lgkmcnt(2)
    v_mfma_f32_16x16x32_bf16 v[56:59], v[120:123], v[176:179], v[56:59]
    v_mfma_f32_16x16x32_bf16 v[28:31], v[120:123], v[172:175], v[28:31]
    v_mfma_f32_16x16x32_bf16 v[64:67], v[176:179], v[128:131], v[64:67]
    v_mfma_f32_16x16x32_bf16 v[36:39], v[172:175], v[128:131], v[36:39]
    s_mov_b32 exec_lo, 0x10001
    s_mov_b32 exec_hi, 0x10001
    ds_write_b128 v202, v[76:79]
    s_mov_b64 exec, 0xffff
    ds_write_b32 v203, v80
    s_mov_b64 exec, -1
    ds_read_b128 v[220:223], v202
    ds_read_b32 v224, v203
    ds_read_b128 v[156:159], v241 offset:256
    ds_read_b128 v[160:163], v241 offset:320
    ds_read_b128 v[148:151], v241 offset:128
    ds_read_b128 v[152:155], v241 offset:192
    ds_read_b128 v[140:143], v241 offset:0
    ds_read_b128 v[144:147], v241 offset:64
    v_mfma_f32_16x16x32_bf16 v[60:63], v[124:127], v[176:179], v[60:63]
    v_mfma_f32_16x16x32_bf16 v[32:35], v[124:127], v[172:175], v[32:35]
    s_waitcnt lgkmcnt(10)
    v_mfma_f32_16x16x32_bf16 v[68:71], v[176:179], v[132:135], v[68:71]
    v_mfma_f32_16x16x32_bf16 v[40:43], v[172:175], v[132:135], v[40:43]
    s_waitcnt lgkmcnt(8)
    s_barrier
    ds_read_b128 v[92:95], v199 offset:128
    ds_read2_b32 v[104:105], v200 offset0:64 offset1:80
    ds_read_b128 v[96:99], v199 offset:192
    ds_read_b128 v[100:103], v199 offset:384
    ds_read_b128 v[84:87], v199 offset:0
    ds_read_b128 v[88:91], v199 offset:64
    v_mfma_f32_16x16x32_bf16 v[72:75], v[136:139], v[176:179], v[72:75]
    v_mfma_f32_16x16x32_bf16 v[44:47], v[136:139], v[172:175], v[44:47]
    v_mfma_f32_16x16x32_bf16 v[48:51], v[112:115], v[176:179], v[48:51]
    v_mfma_f32_16x16x32_bf16 v[20:23], v[112:115], v[172:175], v[20:23]
    v_mfma_f32_16x16x32_bf16 v[52:55], v[116:119], v[176:179], v[52:55]
    v_mfma_f32_16x16x32_bf16 v[24:27], v[116:119], v[172:175], v[24:27]
    s_branch L_TAIL
L_LAYER:
    buffer_load_dword v15, v14, s[4:7], s82 offen sc1
    v_and_b32 v249, 15, v3
    v_lshrrev_b32 v250, 4, v3
    v_mov_b32 v248, v0
    v_mov_b32 v242, 163632
    s_lshl_b32 s28, s22, 3
    s_lshl_b32 s29, s17, 1
    s_add_u32 s29, s29, s28
    s_mul_i32 s48, s29, 18432
    s_add_u32 s48, s48, s24
    s_add_u32 s53, s48, 18432
    s_lshl_b32 s58, s29, 10
    s_add_u32 s58, s58, s25
    s_mul_i32 s59, s22, 20480
    s_add_u32 s59, s59, 5588992
    s_add_u32 s49, s48, 4096
    s_add_u32 s50, s48, 8192
    s_add_u32 s51, s48, 12288
    s_add_u32 s52, s48, 16384
    s_add_u32 s54, s53, 4096
    s_add_u32 s55, s53, 8192
    s_add_u32 s56, s53, 12288
    s_add_u32 s57, s53, 16384
    s_lshl_b32 s60, s17, 9
    s_add_u32 s60, s60, 161536
    v_lshl_add_u32 v240, v249, 2, s60
    v_lshl_add_u32 v241, v250, 4, s60
    s_mov_b32 s76, -1
    s_mov_b32 s77, 0
    s_lshr_b32 s28, s17, 1
    s_and_b32 s29, s17, 1
    s_lshl_b32 s86, s28, 2
    s_add_u32 s86, s86, s29
    s_add_u32 s86, s86, 2
    s_min_u32 s86, s86, 6
    s_xor_b32 s28, s28, 1
    s_lshl_b32 s87, s28, 2
    s_add_u32 s87, s87, s29
    s_lshl_b32 s34, s23, 10
    s_add_u32 s34, s34, s48
    s_add_u32 s34, s34, 2359296
    s_add_u32 s35, s34, 18432
    s_lshl_b32 s36, s23, 7
    s_add_u32 s36, s36, s48
    s_add_u32 s36, s36, 2375680
    s_add_u32 s37, s36, 18432
    s_mov_b32 s72, 0xffff
    s_mov_b32 s73, 0
    s_mov_b32 s74, 0xffff0000
    s_mov_b32 s75, 0
    s_or_b32 s28, s22, s17
    v_mov_b32 v251, s28
    v_cmp_eq_u32 s[62:63], 0, v251
    s_mul_i32 s32, s17, 2304
    s_add_u32 s32, s32, 147456
    s_lshl_b32 s33, s17, 9
    s_add_u32 s33, s33, 156672
    s_cmp_lt_u32 s17, 2
    s_cselect_b64 s[64:65], -1, 0
    s_cselect_b32 s66, 0, 0xffff
    s_cmp_lt_u32 s17, 3
    s_cselect_b64 s[78:79], -1, 0
    s_lshl_b32 s38, s86, 6
    s_add_u32 s38, s38, 160512
    s_lshl_b32 s39, s87, 6
    s_add_u32 s39, s39, 160512
    s_lshl_b32 s28, s86, 10
    s_lshl_b32 s29, s87, 10
    v_add_u32 v244, s28, v0
    v_add_u32 v245, s29, v0
    v_add_u32 v246, 129024, v0
    v_add_u32 v247, 145408, v2
    s_waitcnt vmcnt(0)
    v_subrev_u32 v15, s85, v15
    v_cmp_le_u32 vcc, 16, v15
    s_nop 0
    s_cbranch_vccnz POLLC_20
POLLE_19:
    buffer_load_dwordx4 v[164:167], v0, s[4:7], s48 offen offset:0 sc1
    buffer_load_dwordx4 v[168:171], v0, s[4:7], s53 offen offset:0 sc1
    buffer_load_dwordx4 v[172:175], v0, s[4:7], s48 offen offset:1024 sc1
    buffer_load_dwordx4 v[176:179], v0, s[4:7], s53 offen offset:1024 sc1
    buffer_load_dwordx4 v[180:183], v0, s[4:7], s48 offen offset:2048 sc1
    buffer_load_dwordx4 v[184:187], v0, s[4:7], s53 offen offset:2048 sc1
    buffer_load_dwordx4 v[188:191], v0, s[4:7], s48 offen offset:3072 sc1
    buffer_load_dwordx4 v[192:195], v0, s[4:7], s53 offen offset:3072 sc1
    s_barrier
    ds_read_b128 v[84:87], v248 offset:0
    ds_read_b128 v[88:91], v248 offset:1024
    ds_read_b128 v[92:95], v248 offset:2048
    ds_read_b128 v[96:99], v248 offset:3072
    ds_read_b128 v[100:103], v248 offset:4096
    ds_read_b128 v[104:107], v248 offset:5120
    ds_read_b128 v[108:111], v248 offset:6144
    s_waitcnt vmcnt(6)
    s_waitcnt lgkmcnt(4)
    v_mfma_f32_16x16x32_bf16 v[48:51], v[84:87], v[168:171], 0
    ds_read_b128 v[112:115], v248 offset:7168
    v_mfma_f32_16x16x32_bf16 v[20:23], v[84:87], v[164:167], 0
    ds_read_b128 v[116:119], v248 offset:8192
    v_mfma_f32_16x16x32_bf16 v[52:55], v[88:91], v[168:171], 0
    ds_read_b128 v[120:123], v248 offset:9216
    v_mfma_f32_16x16x32_bf16 v[24:27], v[88:91], v[164:167], 0
    ds_read_b128 v[124:127], v248 offset:10240
    v_mfma_f32_16x16x32_bf16 v[56:59], v[92:95], v[168:171], 0
    buffer_load_dwordx4 v[196:199], v0, s[4:7], s49 offen offset:0 sc1
    v_mfma_f32_16x16x32_bf16 v[28:31], v[92:95], v[164:167], 0
    ds_read_b128 v[128:131], v248 offset:11264
    s_waitcnt lgkmcnt(6)
    v_mfma_f32_16x16x32_bf16 v[60:63], v[96:99], v[168:171], 0
    ds_read_b128 v[132:135], v248 offset:12288
    v_mfma_f32_16x16x32_bf16 v[32:35], v[96:99], v[164:167], 0
    ds_read_b128 v[136:139], v248 offset:13312
    v_mfma_f32_16x16x32_bf16 v[64:67], v[168:171], v[100:103], 0
    v_mfma_f32_16x16x32_bf16 v[36:39], v[164:167], v[100:103], 0
    buffer_load_dwordx4 v[200:203], v0, s[4:7], s54 offen offset:0 sc1
    v_mfma_f32_16x16x32_bf16 v[68:71], v[168:171], v[104:107], 0
    v_mfma_f32_16x16x32_bf16 v[40:43], v[164:167], v[104:107], 0
    s_waitcnt lgkmcnt(7)
    v_mfma_f32_16x16x32_bf16 v[72:75], v[108:111], v[168:171], 0
    v_mfma_f32_16x16x32_bf16 v[44:47], v[108:111], v[164:167], 0
    s_waitcnt vmcnt(6)
    s_waitcnt lgkmcnt(4)
    v_mfma_f32_16x16x32_bf16 v[48:51], v[112:115], v[176:179], v[48:51]
    buffer_load_dwordx4 v[204:207], v0, s[4:7], s49 offen offset:1024 sc1
    v_mfma_f32_16x16x32_bf16 v[20:23], v[112:115], v[172:175], v[20:23]
    ds_read_b128 v[84:87], v248 offset:14336
    v_mfma_f32_16x16x32_bf16 v[52:55], v[116:119], v[176:179], v[52:55]
    ds_read_b128 v[88:91], v248 offset:15360
    v_mfma_f32_16x16x32_bf16 v[24:27], v[116:119], v[172:175], v[24:27]
    ds_read_b128 v[92:95], v248 offset:16384
    v_mfma_f32_16x16x32_bf16 v[56:59], v[120:123], v[176:179], v[56:59]
    ds_read_b128 v[96:99], v248 offset:17408
    v_mfma_f32_16x16x32_bf16 v[28:31], v[120:123], v[172:175], v[28:31]
    buffer_load_dwordx4 v[208:211], v0, s[4:7], s54 offen offset:1024 sc1
    s_waitcnt lgkmcnt(5)
    v_mfma_f32_16x16x32_bf16 v[60:63], v[124:127], v[176:179], v[60:63]
    ds_read_b128 v[100:103], v248 offset:18432
    v_mfma_f32_16x16x32_bf16 v[32:35], v[124:127], v[172:175], v[32:35]
    ds_read_b128 v[104:107], v248 offset:19456
    v_mfma_f32_16x16x32_bf16 v[64:67], v[176:179], v[128:131], v[64:67]
    ds_read_b128 v[108:111], v248 offset:20480
    v_mfma_f32_16x16x32_bf16 v[36:39], v[172:175], v[128:131], v[36:39]
    v_mfma_f32_16x16x32_bf16 v[68:71], v[176:179], v[132:135], v[68:71]
    buffer_load_dwordx2 v[228:229], v1, s[4:7], s58 offen offset:0 sc1
    v_mfma_f32_16x16x32_bf16 v[40:43], v[172:175], v[132:135], v[40:43]
    s_waitcnt lgkmcnt(7)
    v_mfma_f32_16x16x32_bf16 v[72:75], v[136:139], v[176:179], v[72:75]
    v_mfma_f32_16x16x32_bf16 v[44:47], v[136:139], v[172:175], v[44:47]
    buffer_load_dwordx2 v[230:231], v1, s[4:7], s58 offen offset:512 sc1
    s_waitcnt vmcnt(8)
    s_waitcnt lgkmcnt(4)
    v_mfma_f32_16x16x32_bf16 v[48:51], v[84:87], v[184:187], v[48:51]
    ds_read_b128 v[112:115], v248 offset:21504
    v_mfma_f32_16x16x32_bf16 v[20:23], v[84:87], v[180:183], v[20:23]
    ds_read_b128 v[116:119], v248 offset:22528
    v_mfma_f32_16x16x32_bf16 v[52:55], v[88:91], v[184:187], v[52:55]
    buffer_load_dwordx2 v[232:233], v1, s[4:7], s58 offen offset:1024 sc1
    v_mfma_f32_16x16x32_bf16 v[24:27], v[88:91], v[180:183], v[24:27]
    ds_read_b128 v[120:123], v248 offset:23552
    v_mfma_f32_16x16x32_bf16 v[56:59], v[92:95], v[184:187], v[56:59]
    ds_read_b128 v[124:127], v248 offset:24576
    v_mfma_f32_16x16x32_bf16 v[28:31], v[92:95], v[180:183], v[28:31]
    buffer_load_dwordx2 v[234:235], v1, s[4:7], s58 offen offset:1536 sc1
    s_waitcnt lgkmcnt(5)
    v_mfma_f32_16x16x32_bf16 v[60:63], v[96:99], v[184:187], v[60:63]
    ds_read_b128 v[128:131], v248 offset:25600
    v_mfma_f32_16x16x32_bf16 v[32:35], v[96:99], v[180:183], v[32:35]
    ds_read_b128 v[132:135], v248 offset:26624
    v_mfma_f32_16x16x32_bf16 v[64:67], v[184:187], v[100:103], v[64:67]
    buffer_load_dwordx4 v[212:215], v0, s[4:7], s49 offen offset:2048 sc1
    v_mfma_f32_16x16x32_bf16 v[36:39], v[180:183], v[100:103], v[36:39]
    ds_read_b128 v[136:139], v248 offset:27648
    v_mfma_f32_16x16x32_bf16 v[68:71], v[184:187], v[104:107], v[68:71]
    v_mfma_f32_16x16x32_bf16 v[40:43], v[180:183], v[104:107], v[40:43]
    s_waitcnt lgkmcnt(7)
    v_mfma_f32_16x16x32_bf16 v[72:75], v[108:111], v[184:187], v[72:75]
    v_mfma_f32_16x16x32_bf16 v[44:47], v[108:111], v[180:183], v[44:47]
    buffer_load_dwordx4 v[216:219], v0, s[4:7], s54 offen offset:2048 sc1
    s_waitcnt vmcnt(10)
    s_waitcnt lgkmcnt(4)
    v_mfma_f32_16x16x32_bf16 v[48:51], v[112:115], v[192:195], v[48:51]
    ds_read_b128 v[84:87], v248 offset:28672
    v_mfma_f32_16x16x32_bf16 v[20:23], v[112:115], v[188:191], v[20:23]
    ds_read_b128 v[88:91], v248 offset:29696
    v_mfma_f32_16x16x32_bf16 v[52:55], v[116:119], v[192:195], v[52:55]
    ds_read_b128 v[92:95], v248 offset:30720
    v_mfma_f32_16x16x32_bf16 v[24:27], v[116:119], v[188:191], v[24:27]
    ds_read_b128 v[96:99], v248 offset:31744
    v_mfma_f32_16x16x32_bf16 v[56:59], v[120:123], v[192:195], v[56:59]
    buffer_load_dwordx4 v[220:223], v0, s[4:7], s49 offen offset:3072 sc1
    v_mfma_f32_16x16x32_bf16 v[28:31], v[120:123], v[188:191], v[28:31]
    ds_read_b128 v[100:103], v248 offset:32768
    s_waitcnt lgkmcnt(6)
    v_mfma_f32_16x16x32_bf16 v[60:63], v[124:127], v[192:195], v[60:63]
    ds_read_b128 v[104:107], v248 offset:33792
    v_mfma_f32_16x16x32_bf16 v[32:35], v[124:127], v[188:191], v[32:35]
    ds_read_b128 v[108:111], v248 offset:34816
    v_mfma_f32_16x16x32_bf16 v[64:67], v[192:195], v[128:131], v[64:67]
    v_mfma_f32_16x16x32_bf16 v[36:39], v[188:191], v[128:131], v[36:39]
    buffer_load_dwordx4 v[224:227], v0, s[4:7], s54 offen offset:3072 sc1
    v_mfma_f32_16x16x32_bf16 v[68:71], v[192:195], v[132:135], v[68:71]
    v_mfma_f32_16x16x32_bf16 v[40:43], v[188:191], v[132:135], v[40:43]
    s_waitcnt lgkmcnt(7)
    v_mfma_f32_16x16x32_bf16 v[72:75], v[136:139], v[192:195], v[72:75]
    v_mfma_f32_16x16x32_bf16 v[44:47], v[136:139], v[188:191], v[44:47]
    s_waitcnt vmcnt(10)
    s_waitcnt lgkmcnt(4)
    v_mfma_f32_16x16x32_bf16 v[48:51], v[84:87], v[200:203], v[48:51]
    buffer_load_dwordx4 v[164:167], v0, s[4:7], s50 offen offset:0 sc1
    v_mfma_f32_16x16x32_bf16 v[20:23], v[84:87], v[196:199], v[20:23]
    ds_read_b128 v[112:115], v248 offset:35840
    v_mfma_f32_16x16x32_bf16 v[52:55], v[88:91], v[200:203], v[52:55]
    ds_read_b128 v[116:119], v248 offset:36864
    v_mfma_f32_16x16x32_bf16 v[24:27], v[88:91], v[196:199], v[24:27]
    ds_read_b128 v[120:123], v248 offset:37888
    v_mfma_f32_16x16x32_bf16 v[56:59], v[92:95], v[200:203], v[56:59]
    ds_read_b128 v[124:127], v248 offset:38912
    v_mfma_f32_16x16x32_bf16 v[28:31], v[92:95], v[196:199], v[28:31]
    buffer_load_dwordx4 v[168:171], v0, s[4:7], s55 offen offset:0 sc1
    s_waitcnt lgkmcnt(5)
    v_mfma_f32_16x16x32_bf16 v[60:63], v[96:99], v[200:203], v[60:63]
    ds_read_b128 v[128:131], v248 offset:39936
    v_mfma_f32_16x16x32_bf16 v[32:35], v[96:99], v[196:199], v[32:35]
    ds_read_b128 v[132:135], v248 offset:40960
    v_mfma_f32_16x16x32_bf16 v[64:67], v[200:203], v[100:103], v[64:67]
    ds_read_b128 v[136:139], v248 offset:41984
    v_mfma_f32_16x16x32_bf16 v[36:39], v[196:199], v[100:103], v[36:39]
    v_mfma_f32_16x16x32_bf16 v[68:71], v[200:203], v[104:107], v[68:71]
    buffer_load_dwordx4 v[172:175], v0, s[4:7], s50 offen offset:1024 sc1
    v_mfma_f32_16x16x32_bf16 v[40:43], v[196:199], v[104:107], v[40:43]
    s_waitcnt lgkmcnt(7)
    v_mfma_f32_16x16x32_bf16 v[72:75], v[108:111], v[200:203], v[72:75]
    v_mfma_f32_16x16x32_bf16 v[44:47], v[108:111], v[196:199], v[44:47]
    s_waitcnt vmcnt(11)
    s_waitcnt lgkmcnt(4)
    v_mfma_f32_16x16x32_bf16 v[48:51], v[112:115], v[208:211], v[48:51]
    ds_read_b128 v[84:87], v248 offset:43008
    s_waitcnt vmcnt(7)
    v_mfma_f32_16x16x32_bf16 v[20:23], v[112:115], v[204:207], v[20:23]
    buffer_load_dwordx4 v[176:179], v0, s[4:7], s55 offen offset:1024 sc1
    v_mfma_f32_16x16x32_bf16 v[52:55], v[116:119], v[208:211], v[52:55]
    ds_read_b128 v[88:91], v248 offset:44032
    v_add_f32 v228, v228, v230
    v_mfma_f32_16x16x32_bf16 v[24:27], v[116:119], v[204:207], v[24:27]
    ds_read_b128 v[92:95], v248 offset:45056
    v_add_f32 v229, v229, v231
    v_mfma_f32_16x16x32_bf16 v[56:59], v[120:123], v[208:211], v[56:59]
    ds_read_b128 v[96:99], v248 offset:46080
    v_mov_b32 v230, v228
    v_mfma_f32_16x16x32_bf16 v[28:31], v[120:123], v[204:207], v[28:31]
    ds_read_b128 v[100:103], v248 offset:47104
    v_mov_b32 v231, v229
    s_waitcnt lgkmcnt(6)
    v_mfma_f32_16x16x32_bf16 v[60:63], v[124:127], v[208:211], v[60:63]
    buffer_load_dwordx4 v[180:183], v0, s[4:7], s50 offen offset:2048 sc1
    v_mfma_f32_16x16x32_bf16 v[32:35], v[124:127], v[204:207], v[32:35]
    ds_read_b128 v[104:107], v248 offset:48128
    v_permlane32_swap_b32 v228, v230
    v_mfma_f32_16x16x32_bf16 v[64:67], v[208:211], v[128:131], v[64:67]
    ds_read_b128 v[108:111], v248 offset:49152
    v_permlane32_swap_b32 v229, v231
    v_mfma_f32_16x16x32_bf16 v[36:39], v[204:207], v[128:131], v[36:39]
    v_add_f32 v228, v228, v230
    v_add_f32 v229, v229, v231
    v_mfma_f32_16x16x32_bf16 v[68:71], v[208:211], v[132:135], v[68:71]
    v_mov_b32 v230, v228
    v_mov_b32 v231, v229
    v_mfma_f32_16x16x32_bf16 v[40:43], v[204:207], v[132:135], v[40:43]
    buffer_load_dwordx4 v[184:187], v0, s[4:7], s55 offen offset:2048 sc1
    s_waitcnt lgkmcnt(7)
    v_mfma_f32_16x16x32_bf16 v[72:75], v[136:139], v[208:211], v[72:75]
    v_permlane16_swap_b32 v228, v230
    v_permlane16_swap_b32 v229, v231
    v_mfma_f32_16x16x32_bf16 v[44:47], v[136:139], v[204:207], v[44:47]
    v_add_f32 v228, v228, v230
    v_add_f32 v229, v229, v231
    s_waitcnt vmcnt(8)
    s_waitcnt lgkmcnt(4)
    v_mfma_f32_16x16x32_bf16 v[48:51], v[84:87], v[216:219], v[48:51]
    ds_read_b128 v[112:115], v248 offset:50176
    v_mul_f32 v230, 0xbae38e39, v228
    v_mfma_f32_16x16x32_bf16 v[20:23], v[84:87], v[212:215], v[20:23]
    ds_read_b128 v[116:119], v248 offset:51200
    v_mul_f32 v229, 0x3ae38e39, v229
    v_mfma_f32_16x16x32_bf16 v[52:55], v[88:91], v[216:219], v[52:55]
    buffer_load_dwordx4 v[188:191], v0, s[4:7], s50 offen offset:3072 sc1
    v_mfma_f32_16x16x32_bf16 v[24:27], v[88:91], v[212:215], v[24:27]
    ds_read_b128 v[120:123], v248 offset:52224
    v_fma_f32 v229, -v230, v230, v229
    v_mfma_f32_16x16x32_bf16 v[56:59], v[92:95], v[216:219], v[56:59]
    ds_read_b128 v[124:127], v248 offset:53248
    v_max_f32 v229, 0, v229
    v_mfma_f32_16x16x32_bf16 v[28:31], v[92:95], v[212:215], v[28:31]
    ds_read_b128 v[128:131], v248 offset:54272
    v_add_f32 v229, 0x3727c5ac, v229
    s_waitcnt lgkmcnt(6)
    v_mfma_f32_16x16x32_bf16 v[60:63], v[96:99], v[216:219], v[60:63]
    ds_read_b128 v[132:135], v248 offset:55296
    v_rsq_f32 v231, v229
    v_mfma_f32_16x16x32_bf16 v[32:35], v[96:99], v[212:215], v[32:35]
    buffer_load_dwordx4 v[192:195], v0, s[4:7], s55 offen offset:3072 sc1
    v_mfma_f32_16x16x32_bf16 v[64:67], v[216:219], v[100:103], v[64:67]
    ds_read_b128 v[136:139], v248 offset:56320
    v_add_f32 v232, v232, v234
    v_mfma_f32_16x16x32_bf16 v[36:39], v[212:215], v[100:103], v[36:39]
    v_add_f32 v233, v233, v235
    v_mov_b32 v234, v232
    v_mfma_f32_16x16x32_bf16 v[68:71], v[216:219], v[104:107], v[68:71]
    v_mov_b32 v235, v233
    v_permlane32_swap_b32 v232, v234
    v_mfma_f32_16x16x32_bf16 v[40:43], v[212:215], v[104:107], v[40:43]
    v_permlane32_swap_b32 v233, v235
    v_add_f32 v232, v232, v234
    s_waitcnt lgkmcnt(7)
    v_mfma_f32_16x16x32_bf16 v[72:75], v[108:111], v[216:219], v[72:75]
    buffer_load_dwordx4 v[196:199], v0, s[4:7], s51 offen offset:0 sc1
    v_mfma_f32_16x16x32_bf16 v[44:47], v[108:111], v[212:215], v[44:47]
    v_add_f32 v233, v233, v235
    v_mov_b32 v234, v232
    s_waitcnt vmcnt(9)
    s_waitcnt lgkmcnt(4)
    v_mfma_f32_16x16x32_bf16 v[48:51], v[112:115], v[224:227], v[48:51]
    ds_read_b128 v[84:87], v248 offset:57344
    v_mov_b32 v235, v233
    v_mfma_f32_16x16x32_bf16 v[20:23], v[112:115], v[220:223], v[20:23]
    ds_read_b128 v[88:91], v248 offset:58368
    v_permlane16_swap_b32 v232, v234
    v_mfma_f32_16x16x32_bf16 v[52:55], v[116:119], v[224:227], v[52:55]
    ds_read_b128 v[92:95], v248 offset:59392
    v_permlane16_swap_b32 v233, v235
    v_mfma_f32_16x16x32_bf16 v[24:27], v[116:119], v[220:223], v[24:27]
    buffer_load_dwordx4 v[200:203], v0, s[4:7], s56 offen offset:0 sc1
    v_mfma_f32_16x16x32_bf16 v[56:59], v[120:123], v[224:227], v[56:59]
    ds_read_b128 v[96:99], v248 offset:60416
    v_add_f32 v232, v232, v234
    ds_read_b32 v243, v242 offset:8
    v_mfma_f32_16x16x32_bf16 v[28:31], v[120:123], v[220:223], v[28:31]
    ds_read_b128 v[100:103], v248 offset:61440
    v_add_f32 v233, v233, v235
    s_waitcnt lgkmcnt(7)
    v_mfma_f32_16x16x32_bf16 v[60:63], v[124:127], v[224:227], v[60:63]
    ds_read_b128 v[104:107], v248 offset:62464
    v_mul_f32 v234, 0xbae38e39, v232
    v_mfma_f32_16x16x32_bf16 v[32:35], v[124:127], v[220:223], v[32:35]
    ds_read_b128 v[108:111], v248 offset:63488
    v_mul_f32 v233, 0x3ae38e39, v233
    v_mfma_f32_16x16x32_bf16 v[64:67], v[224:227], v[128:131], v[64:67]
    buffer_load_dwordx4 v[204:207], v0, s[4:7], s51 offen offset:1024 sc1
    v_mfma_f32_16x16x32_bf16 v[36:39], v[220:223], v[128:131], v[36:39]
    v_fma_f32 v233, -v234, v234, v233
    v_max_f32 v233, 0, v233
    v_mfma_f32_16x16x32_bf16 v[68:71], v[224:227], v[132:135], v[68:71]
    v_add_f32 v233, 0x3727c5ac, v233
    v_rsq_f32 v235, v233
    v_mfma_f32_16x16x32_bf16 v[40:43], v[220:223], v[132:135], v[40:43]
    ds_write_b32 v240, v230 offset:0
    ds_write_b32 v240, v231 offset:64
    s_waitcnt lgkmcnt(10)
    v_mfma_f32_16x16x32_bf16 v[72:75], v[136:139], v[224:227], v[72:75]
    v_cndmask_b32 v228, v231, 1.0, s[76:77]
    v_mul_f32 v229, 0x3eae1a93, v231
    v_mfma_f32_16x16x32_bf16 v[44:47], v[136:139], v[220:223], v[44:47]
    buffer_load_dwordx4 v[208:211], v0, s[4:7], s56 offen offset:1024 sc1
    s_waitcnt lgkmcnt(5)
    v_cmp_gt_u32 vcc, 8, v243
    s_nop 0
    s_cbranch_vccnz SPINC_23
SPIND_22:
    s_waitcnt vmcnt(10)
    s_waitcnt lgkmcnt(7)
    v_mfma_f32_16x16x32_bf16 v[48:51], v[84:87], v[168:171], v[48:51]
    v_add_u32 v248, 64512, v248
    ds_write_b32 v240, v234 offset:128
    v_mfma_f32_16x16x32_bf16 v[20:23], v[84:87], v[164:167], v[20:23]
    ds_read_b128 v[112:115], v248 offset:0
    ds_write_b32 v240, v235 offset:192
    v_mfma_f32_16x16x32_bf16 v[52:55], v[88:91], v[168:171], v[52:55]
    ds_read_b128 v[116:119], v248 offset:1024
    v_cndmask_b32 v232, v235, 1.0, s[76:77]
    v_mfma_f32_16x16x32_bf16 v[24:27], v[88:91], v[164:167], v[24:27]
    ds_read_b128 v[120:123], v248 offset:2048
    v_mul_f32 v233, 0x3eae1a93, v235
    v_mfma_f32_16x16x32_bf16 v[56:59], v[92:95], v[168:171], v[56:59]
    buffer_load_dwordx4 v[212:215], v0, s[4:7], s51 offen offset:2048 sc1
    v_mfma_f32_16x16x32_bf16 v[28:31], v[92:95], v[164:167], v[28:31]
    ds_read_b128 v[124:127], v248 offset:3072
    s_waitcnt lgkmcnt(9)
    v_mfma_f32_16x16x32_bf16 v[60:63], v[96:99], v[168:171], v[60:63]
    ds_read_b128 v[128:131], v248 offset:4096
    v_mfma_f32_16x16x32_bf16 v[32:35], v[96:99], v[164:167], v[32:35]
    ds_read_b128 v[132:135], v248 offset:5120
    v_mfma_f32_16x16x32_bf16 v[64:67], v[168:171], v[100:103], v[64:67]
    ds_read_b128 v[136:139], v248 offset:6144
    v_mfma_f32_16x16x32_bf16 v[36:39], v[164:167], v[100:103], v[36:39]
    buffer_load_dwordx4 v[216:219], v0, s[4:7], s56 offen offset:2048 sc1
    v_mfma_f32_16x16x32_bf16 v[68:71], v[168:171], v[104:107], v[68:71]
    ds_read_b128 v[140:143], v246 offset:0
    v_mfma_f32_16x16x32_bf16 v[40:43], v[164:167], v[104:107], v[40:43]
    ds_read_b128 v[144:147], v244 offset:0
    s_waitcnt lgkmcnt(13)
    v_mfma_f32_16x16x32_bf16 v[72:75], v[108:111], v[168:171], v[72:75]
    ds_read_b128 v[148:151], v245 offset:0
    v_mfma_f32_16x16x32_bf16 v[44:47], v[108:111], v[164:167], v[44:47]
    ds_read_b128 v[152:155], v246 offset:1024
    ds_read_b128 v[156:159], v244 offset:7168
    ds_read_b128 v[160:163], v245 offset:7168
    s_waitcnt vmcnt(10)
    s_waitcnt lgkmcnt(3)
    v_mfma_f32_16x16x32_bf16 v[48:51], v[112:115], v[176:179], v[48:51]
    buffer_load_dwordx4 v[220:223], v0, s[4:7], s51 offen offset:3072 sc1
    v_mfma_f32_16x16x32_bf16 v[20:23], v[112:115], v[172:175], v[20:23]
    ds_read_b128 v[84:87], v248 offset:7168
    v_mfma_f32_16x16x32_bf16 v[52:55], v[116:119], v[176:179], v[52:55]
    ds_read_b128 v[88:91], v248 offset:8192
    v_mfma_f32_16x16x32_bf16 v[24:27], v[116:119], v[172:175], v[24:27]
    ds_read_b128 v[92:95], v248 offset:9216
    v_mfma_f32_16x16x32_bf16 v[76:79], v[144:147], v[140:143], 0
    ds_read_b128 v[96:99], v248 offset:10240
    v_mfma_f32_16x16x32_bf16 v[80:83], v[140:143], v[148:151], 0
    buffer_load_dwordx4 v[224:227], v0, s[4:7], s56 offen offset:3072 sc1
    v_mfma_f32_16x16x32_bf16 v[56:59], v[120:123], v[176:179], v[56:59]
    ds_read_b128 v[140:143], v246 offset:2048
    v_mfma_f32_16x16x32_bf16 v[28:31], v[120:123], v[172:175], v[28:31]
    ds_read_b128 v[144:147], v244 offset:14336
    v_mfma_f32_16x16x32_bf16 v[60:63], v[124:127], v[176:179], v[60:63]
    ds_read_b128 v[148:151], v245 offset:14336
    v_mfma_f32_16x16x32_bf16 v[32:35], v[124:127], v[172:175], v[32:35]
    ds_read_b128 v[100:103], v248 offset:11264
    v_mfma_f32_16x16x32_bf16 v[64:67], v[176:179], v[128:131], v[64:67]
    buffer_load_dwordx2 v[236:237], v1, s[4:7], s59 offen sc1
    v_mfma_f32_16x16x32_bf16 v[36:39], v[172:175], v[128:131], v[36:39]
    ds_read_b128 v[104:107], v248 offset:12288
    s_waitcnt lgkmcnt(9)
    v_mfma_f32_16x16x32_bf16 v[76:79], v[156:159], v[152:155], v[76:79]
    ds_read_b128 v[108:111], v248 offset:13312
    v_mfma_f32_16x16x32_bf16 v[80:83], v[152:155], v[160:163], v[80:83]
    buffer_load_dwordx2 v[238:239], v1, s[4:7], s59 offen offset:512 sc1
    v_mfma_f32_16x16x32_bf16 v[68:71], v[176:179], v[132:135], v[68:71]
    ds_read_b128 v[152:155], v246 offset:3072
    v_mfma_f32_16x16x32_bf16 v[40:43], v[172:175], v[132:135], v[40:43]
    ds_read_b128 v[156:159], v244 offset:21504
    v_mfma_f32_16x16x32_bf16 v[72:75], v[136:139], v[176:179], v[72:75]
    buffer_load_dwordx2 v[164:165], v2, s[4:7], s52 offen offset:0 sc1
    v_mfma_f32_16x16x32_bf16 v[44:47], v[136:139], v[172:175], v[44:47]
    ds_read_b128 v[160:163], v245 offset:21504
    s_waitcnt vmcnt(13)
    s_waitcnt lgkmcnt(6)
    v_mfma_f32_16x16x32_bf16 v[48:51], v[84:87], v[184:187], v[48:51]
    ds_read_b128 v[112:115], v248 offset:14336
    v_mfma_f32_16x16x32_bf16 v[20:23], v[84:87], v[180:183], v[20:23]
    buffer_load_dwordx2 v[166:167], v2, s[4:7], s52 offen offset:128 sc1
    v_mfma_f32_16x16x32_bf16 v[52:55], v[88:91], v[184:187], v[52:55]
    ds_read_b128 v[116:119], v248 offset:15360
    v_mfma_f32_16x16x32_bf16 v[24:27], v[88:91], v[180:183], v[24:27]
    ds_read_b128 v[120:123], v248 offset:16384
    v_mfma_f32_16x16x32_bf16 v[76:79], v[144:147], v[140:143], v[76:79]
    buffer_load_dwordx2 v[168:169], v2, s[4:7], s57 offen offset:0 sc1
    v_mfma_f32_16x16x32_bf16 v[80:83], v[140:143], v[148:151], v[80:83]
    ds_read_b128 v[140:143], v246 offset:4096
    v_mfma_f32_16x16x32_bf16 v[56:59], v[92:95], v[184:187], v[56:59]
    ds_read_b128 v[144:147], v244 offset:28672
    v_mfma_f32_16x16x32_bf16 v[28:31], v[92:95], v[180:183], v[28:31]
    buffer_load_dwordx2 v[170:171], v2, s[4:7], s57 offen offset:128 sc1
    v_mfma_f32_16x16x32_bf16 v[60:63], v[96:99], v[184:187], v[60:63]
    ds_read_b128 v[148:151], v245 offset:28672
    v_mfma_f32_16x16x32_bf16 v[32:35], v[96:99], v[180:183], v[32:35]
    ds_read_b128 v[124:127], v248 offset:17408
    s_waitcnt lgkmcnt(7)
    v_mfma_f32_16x16x32_bf16 v[64:67], v[184:187], v[100:103], v[64:67]
    buffer_load_dwordx2 v[172:173], v2, s[4:7], s52 offen offset:1024 sc1
    v_mfma_f32_16x16x32_bf16 v[36:39], v[180:183], v[100:103], v[36:39]
    ds_read_b128 v[128:131], v248 offset:18432
    v_mfma_f32_16x16x32_bf16 v[76:79], v[156:159], v[152:155], v[76:79]
    ds_read_b128 v[132:135], v248 offset:19456
    v_mfma_f32_16x16x32_bf16 v[80:83], v[152:155], v[160:163], v[80:83]
    buffer_load_dwordx2 v[174:175], v2, s[4:7], s52 offen offset:1152 sc1
    v_mfma_f32_16x16x32_bf16 v[68:71], v[184:187], v[104:107], v[68:71]
    ds_read_b128 v[152:155], v246 offset:5120
    v_mfma_f32_16x16x32_bf16 v[40:43], v[180:183], v[104:107], v[40:43]
    ds_read_b128 v[156:159], v244 offset:35840
    v_mfma_f32_16x16x32_bf16 v[72:75], v[108:111], v[184:187], v[72:75]
    buffer_load_dwordx2 v[176:177], v2, s[4:7], s57 offen offset:1024 sc1
    v_mfma_f32_16x16x32_bf16 v[44:47], v[108:111], v[180:183], v[44:47]
    ds_read_b128 v[160:163], v245 offset:35840
    ds_read_b128 v[136:139], v248 offset:20480
    buffer_load_dwordx2 v[178:179], v2, s[4:7], s57 offen offset:1152 sc1
    s_barrier
    s_waitcnt vmcnt(18)
    s_waitcnt lgkmcnt(7)
    v_mfma_f32_16x16x32_bf16 v[48:51], v[112:115], v[192:195], v[48:51]
    ds_read_b128 v[84:87], v248 offset:21504
    v_mfma_f32_16x16x32_bf16 v[20:23], v[112:115], v[188:191], v[20:23]
    ds_read_b128 v[88:91], v248 offset:22528
    v_mfma_f32_16x16x32_bf16 v[52:55], v[116:119], v[192:195], v[52:55]
    ds_read_b128 v[92:95], v248 offset:23552
    v_mfma_f32_16x16x32_bf16 v[24:27], v[116:119], v[188:191], v[24:27]
    ds_read_b128 v[96:99], v248 offset:24576
    v_mfma_f32_16x16x32_bf16 v[76:79], v[144:147], v[140:143], v[76:79]
    ds_read_b128 v[100:103], v248 offset:25600
    v_mfma_f32_16x16x32_bf16 v[80:83], v[140:143], v[148:151], v[80:83]
    ds_read_b128 v[140:143], v246 offset:6144
    v_mfma_f32_16x16x32_bf16 v[56:59], v[120:123], v[192:195], v[56:59]
    ds_read_b128 v[144:147], v244 offset:43008
    v_mfma_f32_16x16x32_bf16 v[28:31], v[120:123], v[188:191], v[28:31]
    ds_read_b128 v[148:151], v245 offset:43008
    s_waitcnt lgkmcnt(9)
    v_mfma_f32_16x16x32_bf16 v[60:63], v[124:127], v[192:195], v[60:63]
    ds_read_b128 v[104:107], v248 offset:26624
    v_mfma_f32_16x16x32_bf16 v[32:35], v[124:127], v[188:191], v[32:35]
    ds_read_b128 v[108:111], v248 offset:27648
    v_mfma_f32_16x16x32_bf16 v[64:67], v[192:195], v[128:131], v[64:67]
    v_mfma_f32_16x16x32_bf16 v[36:39], v[188:191], v[128:131], v[36:39]
    v_mfma_f32_16x16x32_bf16 v[76:79], v[156:159], v[152:155], v[76:79]
    v_mfma_f32_16x16x32_bf16 v[80:83], v[152:155], v[160:163], v[80:83]
    ds_read_b128 v[152:155], v246 offset:7168
    v_mfma_f32_16x16x32_bf16 v[68:71], v[192:195], v[132:135], v[68:71]
    ds_read_b128 v[156:159], v244 offset:50176
    v_mfma_f32_16x16x32_bf16 v[40:43], v[188:191], v[132:135], v[40:43]
    ds_read_b128 v[160:163], v245 offset:50176
    s_waitcnt lgkmcnt(13)
    v_mfma_f32_16x16x32_bf16 v[72:75], v[136:139], v[192:195], v[72:75]
    v_mfma_f32_16x16x32_bf16 v[44:47], v[136:139], v[188:191], v[44:47]
    s_waitcnt vmcnt(16)
    s_waitcnt lgkmcnt(5)
    v_mfma_f32_16x16x32_bf16 v[48:51], v[84:87], v[200:203], v[48:51]
    ds_read_b128 v[112:115], v248 offset:28672
    s_waitcnt vmcnt(8)
    v_mfma_f32_16x16x32_bf16 v[20:23], v[84:87], v[196:199], v[20:23]
    ds_read_b128 v[116:119], v248 offset:29696
    v_add_f32 v236, v236, v238
    v_mfma_f32_16x16x32_bf16 v[52:55], v[88:91], v[200:203], v[52:55]
    ds_read_b128 v[120:123], v248 offset:30720
    v_add_f32 v237, v237, v239
    v_mfma_f32_16x16x32_bf16 v[24:27], v[88:91], v[196:199], v[24:27]
    ds_read_b128 v[124:127], v248 offset:31744
    v_mov_b32 v238, v236
    v_mfma_f32_16x16x32_bf16 v[76:79], v[144:147], v[140:143], v[76:79]
    ds_read_b128 v[128:131], v248 offset:32768
    v_mov_b32 v239, v237
    v_mfma_f32_16x16x32_bf16 v[80:83], v[140:143], v[148:151], v[80:83]
    ds_read_b128 v[140:143], v246 offset:8192
    v_permlane32_swap_b32 v236, v238
    v_mfma_f32_16x16x32_bf16 v[56:59], v[92:95], v[200:203], v[56:59]
    ds_read_b128 v[144:147], v244 offset:57344
    v_permlane32_swap_b32 v237, v239
    v_mfma_f32_16x16x32_bf16 v[28:31], v[92:95], v[196:199], v[28:31]
    ds_read_b128 v[148:151], v245 offset:57344
    v_add_f32 v236, v236, v238
    v_mfma_f32_16x16x32_bf16 v[60:63], v[96:99], v[200:203], v[60:63]
    ds_read_b128 v[132:135], v248 offset:33792
    v_add_f32 v237, v237, v239
    v_mfma_f32_16x16x32_bf16 v[32:35], v[96:99], v[196:199], v[32:35]
    ds_read_b128 v[136:139], v248 offset:34816
    v_mov_b32 v238, v236
    v_mfma_f32_16x16x32_bf16 v[64:67], v[200:203], v[100:103], v[64:67]
    v_mov_b32 v239, v237
    v_permlane16_swap_b32 v236, v238
    v_mfma_f32_16x16x32_bf16 v[36:39], v[196:199], v[100:103], v[36:39]
    v_permlane16_swap_b32 v237, v239
    v_add_f32 v236, v236, v238
    s_waitcnt lgkmcnt(10)
    v_mfma_f32_16x16x32_bf16 v[76:79], v[156:159], v[152:155], v[76:79]
    v_add_f32 v237, v237, v239
    v_mul_f32 v238, 0xbae38e39, v236
    v_mfma_f32_16x16x32_bf16 v[80:83], v[152:155], v[160:163], v[80:83]
    v_add_u32 v244, 64512, v244
    v_mul_f32 v237, 0x3ae38e39, v237
    v_mfma_f32_16x16x32_bf16 v[68:71], v[200:203], v[104:107], v[68:71]
    v_add_u32 v245, 64512, v245
    v_fma_f32 v237, -v238, v238, v237
    v_mfma_f32_16x16x32_bf16 v[40:43], v[196:199], v[104:107], v[40:43]
    ds_read_b128 v[152:155], v246 offset:9216
    v_max_f32 v237, 0, v237
    v_mfma_f32_16x16x32_bf16 v[72:75], v[108:111], v[200:203], v[72:75]
    ds_read_b128 v[156:159], v244 offset:0
    v_add_f32 v237, 0x3727c5ac, v237
    v_mfma_f32_16x16x32_bf16 v[44:47], v[108:111], v[196:199], v[44:47]
    ds_read_b128 v[160:163], v245 offset:0
    v_rsq_f32 v239, v237
    s_waitcnt vmcnt(14)
    s_waitcnt lgkmcnt(5)
    v_mfma_f32_16x16x32_bf16 v[48:51], v[112:115], v[208:211], v[48:51]
    ds_read_b128 v[84:87], v248 offset:35840
    ds_write_b32 v240, v238 offset:256
    v_mfma_f32_16x16x32_bf16 v[20:23], v[112:115], v[204:207], v[20:23]
    ds_read_b128 v[88:91], v248 offset:36864
    ds_write_b32 v240, v239 offset:320
    v_mfma_f32_16x16x32_bf16 v[52:55], v[116:119], v[208:211], v[52:55]
    ds_read_b128 v[92:95], v248 offset:37888
    v_mov_b32 v243, 0xf149f2ca
    v_mfma_f32_16x16x32_bf16 v[24:27], v[116:119], v[204:207], v[24:27]
    ds_read_b128 v[96:99], v248 offset:38912
    v_and_b32 v242, 1, v249
    v_mfma_f32_16x16x32_bf16 v[76:79], v[144:147], v[140:143], v[76:79]
    ds_read_b128 v[100:103], v248 offset:39936
    v_lshlrev_b32 v242, 4, v242
    v_mfma_f32_16x16x32_bf16 v[80:83], v[140:143], v[148:151], v[80:83]
    ds_read_b128 v[140:143], v246 offset:10240
    v_lshlrev_b32 v240, v242, s72
    v_mfma_f32_16x16x32_bf16 v[56:59], v[120:123], v[208:211], v[56:59]
    ds_read_b128 v[144:147], v244 offset:7168
    v_lshl_add_u32 v251, v250, 2, 0
    v_mfma_f32_16x16x32_bf16 v[28:31], v[120:123], v[204:207], v[28:31]
    ds_read_b128 v[148:151], v245 offset:7168
    v_sub_u32 v251, v249, v251
    v_mfma_f32_16x16x32_bf16 v[60:63], v[124:127], v[208:211], v[60:63]
    ds_read_b128 v[104:107], v248 offset:40960
    v_cmp_le_i32 vcc, 0, v251
    v_mfma_f32_16x16x32_bf16 v[32:35], v[124:127], v[204:207], v[32:35]
    ds_read_b128 v[108:111], v248 offset:41984
    v_cndmask_b32 v194, 0, v240, vcc
    v_mfma_f32_16x16x32_bf16 v[64:67], v[208:211], v[128:131], v[64:67]
    v_cndmask_b32 v192, v240, 0, vcc
    v_and_b32 v251, 0x80000001, v251
    v_mfma_f32_16x16x32_bf16 v[36:39], v[204:207], v[128:131], v[36:39]
    v_cmp_eq_u32 vcc, 0, v251
    s_nop 1
    v_cndmask_b32 v184, v243, 0, vcc
    s_waitcnt lgkmcnt(12)
    v_mfma_f32_16x16x32_bf16 v[76:79], v[156:159], v[152:155], v[76:79]
    v_cmp_eq_u32 vcc, 0x80000000, v251
    s_nop 1
    v_cndmask_b32 v180, v243, 0, vcc
    v_mfma_f32_16x16x32_bf16 v[80:83], v[152:155], v[160:163], v[80:83]
    ds_read_b128 v[152:155], v246 offset:11264
    v_cndmask_b32 v188, v180, v243, s[62:63]
    v_mfma_f32_16x16x32_bf16 v[68:71], v[208:211], v[132:135], v[68:71]
    ds_read_b128 v[156:159], v244 offset:14336
    v_lshl_add_u32 v251, v250, 2, 1
    v_mfma_f32_16x16x32_bf16 v[40:43], v[204:207], v[132:135], v[40:43]
    ds_read_b128 v[160:163], v245 offset:14336
    v_sub_u32 v251, v249, v251
    v_mfma_f32_16x16x32_bf16 v[72:75], v[136:139], v[208:211], v[72:75]
    v_and_b32 v251, 0x80000001, v251
    v_cmp_eq_u32 vcc, 0, v251
    v_mfma_f32_16x16x32_bf16 v[44:47], v[136:139], v[204:207], v[44:47]
    s_nop 0
    v_cndmask_b32 v185, v243, 0, vcc
    v_cmp_eq_u32 vcc, 0x80000000, v251
    s_waitcnt vmcnt(12)
    s_waitcnt lgkmcnt(5)
    v_mfma_f32_16x16x32_bf16 v[48:51], v[84:87], v[216:219], v[48:51]
    ds_read_b128 v[112:115], v248 offset:43008
    v_cndmask_b32 v181, v243, 0, vcc
    v_mfma_f32_16x16x32_bf16 v[20:23], v[84:87], v[212:215], v[20:23]
    ds_read_b128 v[116:119], v248 offset:44032
    v_cndmask_b32 v189, v181, v243, s[62:63]
    v_mfma_f32_16x16x32_bf16 v[52:55], v[88:91], v[216:219], v[52:55]
    ds_read_b128 v[120:123], v248 offset:45056
    v_lshl_add_u32 v251, v250, 2, 2
    v_mfma_f32_16x16x32_bf16 v[24:27], v[88:91], v[212:215], v[24:27]
    ds_read_b128 v[124:127], v248 offset:46080
    v_sub_u32 v251, v249, v251
    v_mfma_f32_16x16x32_bf16 v[76:79], v[144:147], v[140:143], v[76:79]
    ds_read_b128 v[128:131], v248 offset:47104
    v_cmp_le_i32 vcc, 0, v251
    v_mfma_f32_16x16x32_bf16 v[80:83], v[140:143], v[148:151], v[80:83]
    ds_read_b128 v[140:143], v246 offset:12288
    v_cndmask_b32 v195, 0, v240, vcc
    v_mfma_f32_16x16x32_bf16 v[56:59], v[92:95], v[216:219], v[56:59]
    ds_read_b128 v[144:147], v244 offset:21504
    v_cndmask_b32 v193, v240, 0, vcc
    v_mfma_f32_16x16x32_bf16 v[28:31], v[92:95], v[212:215], v[28:31]
    ds_read_b128 v[148:151], v245 offset:21504
    v_and_b32 v251, 0x80000001, v251
    v_mfma_f32_16x16x32_bf16 v[60:63], v[96:99], v[216:219], v[60:63]
    ds_read_b128 v[132:135], v248 offset:48128
    v_cmp_eq_u32 vcc, 0, v251
    v_mfma_f32_16x16x32_bf16 v[32:35], v[96:99], v[212:215], v[32:35]
    ds_read_b128 v[136:139], v248 offset:49152
    v_cndmask_b32 v186, v243, 0, vcc
    v_mfma_f32_16x16x32_bf16 v[64:67], v[216:219], v[100:103], v[64:67]
    v_cmp_eq_u32 vcc, 0x80000000, v251
    s_nop 1
    v_cndmask_b32 v182, v243, 0, vcc
    v_mfma_f32_16x16x32_bf16 v[36:39], v[212:215], v[100:103], v[36:39]
    v_cndmask_b32 v190, v182, v243, s[62:63]
    v_lshl_add_u32 v251, v250, 2, 3
    s_waitcnt lgkmcnt(10)
    v_mfma_f32_16x16x32_bf16 v[76:79], v[156:159], v[152:155], v[76:79]
    v_sub_u32 v251, v249, v251
    v_and_b32 v251, 0x80000001, v251
    v_mfma_f32_16x16x32_bf16 v[80:83], v[152:155], v[160:163], v[80:83]
    ds_read_b128 v[152:155], v246 offset:13312
    v_cmp_eq_u32 vcc, 0, v251
    v_mfma_f32_16x16x32_bf16 v[68:71], v[216:219], v[104:107], v[68:71]
    ds_read_b128 v[156:159], v244 offset:28672
    v_cndmask_b32 v187, v243, 0, vcc
    v_mfma_f32_16x16x32_bf16 v[40:43], v[212:215], v[104:107], v[40:43]
    ds_read_b128 v[160:163], v245 offset:28672
    v_cmp_eq_u32 vcc, 0x80000000, v251
    v_mfma_f32_16x16x32_bf16 v[72:75], v[108:111], v[216:219], v[72:75]
    s_nop 0
    v_cndmask_b32 v183, v243, 0, vcc
    v_cndmask_b32 v191, v183, v243, s[62:63]
    v_mfma_f32_16x16x32_bf16 v[44:47], v[108:111], v[212:215], v[44:47]
    v_add_u32 v196, s32, v1
    v_lshl_add_u32 v197, v3, 2, s32
    s_waitcnt vmcnt(10)
    s_waitcnt lgkmcnt(5)
    v_mfma_f32_16x16x32_bf16 v[48:51], v[112:115], v[224:227], v[48:51]
    ds_read_b128 v[84:87], v248 offset:50176
    v_lshl_add_u32 v198, v249, 4, s33
    v_mfma_f32_16x16x32_bf16 v[20:23], v[112:115], v[220:223], v[20:23]
    ds_read_b128 v[88:91], v248 offset:51200
    v_lshlrev_b32 v199, 4, v250
    v_mfma_f32_16x16x32_bf16 v[76:79], v[144:147], v[140:143], v[76:79]
    ds_read_b128 v[92:95], v248 offset:52224
    v_lshlrev_b32 v200, 2, v249
    v_mfma_f32_16x16x32_bf16 v[80:83], v[140:143], v[148:151], v[80:83]
    ds_read_b128 v[140:143], v246 offset:14336
    v_add_u32 v202, s38, v199
    v_mfma_f32_16x16x32_bf16 v[52:55], v[116:119], v[224:227], v[52:55]
    ds_read_b128 v[144:147], v244 offset:35840
    v_add_u32 v203, s39, v200
    v_mfma_f32_16x16x32_bf16 v[24:27], v[116:119], v[220:223], v[24:27]
    ds_read_b128 v[148:151], v245 offset:35840
    v_add_u32 v199, 160512, v199
    v_mfma_f32_16x16x32_bf16 v[56:59], v[120:123], v[224:227], v[56:59]
    ds_read_b128 v[96:99], v248 offset:53248
    v_add_u32 v200, 160512, v200
    v_mfma_f32_16x16x32_bf16 v[28:31], v[120:123], v[220:223], v[28:31]
    ds_read_b128 v[100:103], v248 offset:54272
    v_and_b32 v201, 60, v3
    s_waitcnt lgkmcnt(8)
    v_mfma_f32_16x16x32_bf16 v[76:79], v[156:159], v[152:155], v[76:79]
    ds_read_b128 v[104:107], v248 offset:55296
    v_lshl_add_u32 v201, v201, 2, s33
    v_mfma_f32_16x16x32_bf16 v[80:83], v[152:155], v[160:163], v[80:83]
    ds_read_b128 v[152:155], v246 offset:15360
    v_mov_b32 v207, 0
    v_mfma_f32_16x16x32_bf16 v[60:63], v[124:127], v[224:227], v[60:63]
    ds_read_b128 v[156:159], v244 offset:43008
    v_mov_b32 v211, 0
    v_mfma_f32_16x16x32_bf16 v[32:35], v[124:127], v[220:223], v[32:35]
    ds_read_b128 v[160:163], v245 offset:43008
    v_mov_b32 v215, 0
    v_mfma_f32_16x16x32_bf16 v[64:67], v[224:227], v[128:131], v[64:67]
    ds_read_b128 v[108:111], v248 offset:56320
    v_mov_b32 v219, 0
    v_mfma_f32_16x16x32_bf16 v[36:39], v[220:223], v[128:131], v[36:39]
    s_mul_i32 s28, s17, -1792
    v_mfma_f32_16x16x32_bf16 v[68:71], v[224:227], v[132:135], v[68:71]
    v_mfma_f32_16x16x32_bf16 v[40:43], v[220:223], v[132:135], v[40:43]
    s_waitcnt lgkmcnt(7)
    v_mfma_f32_16x16x32_bf16 v[76:79], v[144:147], v[140:143], v[76:79]
    v_mfma_f32_16x16x32_bf16 v[80:83], v[140:143], v[148:151], v[80:83]
    ds_read_b64 v[140:141], v247 offset:0
    v_mfma_f32_16x16x32_bf16 v[72:75], v[136:139], v[224:227], v[72:75]
    ds_read_b64 v[142:143], v247 offset:128
    v_mfma_f32_16x16x32_bf16 v[44:47], v[136:139], v[220:223], v[44:47]
    ds_read_b128 v[144:147], v244 offset:50176
    ds_read_b128 v[148:151], v245 offset:50176
    s_waitcnt vmcnt(4)
    s_waitcnt lgkmcnt(5)
    v_mfma_f32_16x16x32_bf16 v[48:51], v[84:87], v[168:171], v[48:51]
    ds_read_b128 v[112:115], v248 offset:57344
    v_add_u32 v225, s28, v196
    v_mfma_f32_16x16x32_bf16 v[20:23], v[84:87], v[164:167], v[20:23]
    ds_read_b128 v[116:119], v248 offset:58368
    v_lshlrev_b32 v226, 2, v3
    v_mfma_f32_16x16x32_bf16 v[76:79], v[156:159], v[152:155], v[76:79]
    ds_read_b128 v[120:123], v248 offset:59392
    v_lshlrev_b32 v227, 4, v249
    v_mfma_f32_16x16x32_bf16 v[80:83], v[152:155], v[160:163], v[80:83]
    ds_read_b64 v[152:153], v247 offset:1024
    v_add_u32 v226, 149504, v226
    v_mfma_f32_16x16x32_bf16 v[52:55], v[88:91], v[168:171], v[52:55]
    ds_read_b64 v[154:155], v247 offset:1152
    v_add_u32 v227, 156672, v227
    v_mfma_f32_16x16x32_bf16 v[24:27], v[88:91], v[164:167], v[24:27]
    ds_read_b128 v[156:159], v244 offset:57344
    v_mfma_f32_16x16x32_bf16 v[56:59], v[92:95], v[168:171], v[56:59]
    ds_read_b128 v[160:163], v245 offset:57344
    v_mfma_f32_16x16x32_bf16 v[28:31], v[92:95], v[164:167], v[28:31]
    ds_read_b128 v[124:127], v248 offset:60416
    s_waitcnt lgkmcnt(8)
    v_mfma_f32_16x16x32_bf16 v[76:79], v[144:147], v[140:143], v[76:79]
    ds_read_b128 v[128:131], v248 offset:61440
    v_mfma_f32_16x16x32_bf16 v[80:83], v[140:143], v[148:151], v[80:83]
    ds_read_b128 v[132:135], v248 offset:62464
    v_mfma_f32_16x16x32_bf16 v[60:63], v[96:99], v[168:171], v[60:63]
    ds_read_b128 v[136:139], v248 offset:63488
    v_mfma_f32_16x16x32_bf16 v[32:35], v[96:99], v[164:167], v[32:35]
    v_mfma_f32_16x16x32_bf16 v[64:67], v[168:171], v[100:103], v[64:67]
    v_mfma_f32_16x16x32_bf16 v[36:39], v[164:167], v[100:103], v[36:39]
    v_mfma_f32_16x16x32_bf16 v[68:71], v[168:171], v[104:107], v[68:71]
    v_mfma_f32_16x16x32_bf16 v[40:43], v[164:167], v[104:107], v[40:43]
    s_waitcnt lgkmcnt(4)
    v_mfma_f32_16x16x32_bf16 v[76:79], v[156:159], v[152:155], v[76:79]
    v_mfma_f32_16x16x32_bf16 v[80:83], v[152:155], v[160:163], v[80:83]
    v_mfma_f32_16x16x32_bf16 v[72:75], v[108:111], v[168:171], v[72:75]
    v_mfma_f32_16x16x32_bf16 v[44:47], v[108:111], v[164:167], v[44:47]
    s_waitcnt vmcnt(0)
    s_waitcnt lgkmcnt(2)
    v_mfma_f32_16x16x32_bf16 v[56:59], v[120:123], v[176:179], v[56:59]
    v_mfma_f32_16x16x32_bf16 v[28:31], v[120:123], v[172:175], v[28:31]
    v_mfma_f32_16x16x32_bf16 v[64:67], v[176:179], v[128:131], v[64:67]
    v_mfma_f32_16x16x32_bf16 v[36:39], v[172:175], v[128:131], v[36:39]
    s_mov_b32 exec_lo, 0x10001
    s_mov_b32 exec_hi, 0x10001
    ds_write_b128 v202, v[76:79]
    s_mov_b64 exec, 0xffff
    ds_write_b32 v203, v80
    s_mov_b64 exec, -1
    ds_read_b128 v[220:223], v202
    ds_read_b32 v224, v203
    ds_read_b128 v[156:159], v241 offset:256
    ds_read_b128 v[160:163], v241 offset:320
    ds_read_b128 v[148:151], v241 offset:128
    ds_read_b128 v[152:155], v241 offset:192
    ds_read_b128 v[140:143], v241 offset:0
    ds_read_b128 v[144:147], v241 offset:64
    v_mfma_f32_16x16x32_bf16 v[60:63], v[124:127], v[176:179], v[60:63]
    v_mfma_f32_16x16x32_bf16 v[32:35], v[124:127], v[172:175], v[32:35]
    s_waitcnt lgkmcnt(10)
    v_mfma_f32_16x16x32_bf16 v[68:71], v[176:179], v[132:135], v[68:71]
    v_mfma_f32_16x16x32_bf16 v[40:43], v[172:175], v[132:135], v[40:43]
    s_waitcnt lgkmcnt(8)
    s_barrier
    ds_read_b128 v[92:95], v199 offset:128
    ds_read2_b32 v[104:105], v200 offset0:64 offset1:80
    ds_read_b128 v[96:99], v199 offset:192
    ds_read_b128 v[100:103], v199 offset:384
    ds_read_b128 v[84:87], v199 offset:0
    ds_read_b128 v[88:91], v199 offset:64
    v_mfma_f32_16x16x32_bf16 v[72:75], v[136:139], v[176:179], v[72:75]
    v_mfma_f32_16x16x32_bf16 v[44:47], v[136:139], v[172:175], v[44:47]
    v_mfma_f32_16x16x32_bf16 v[48:51], v[112:115], v[176:179], v[48:51]
    v_mfma_f32_16x16x32_bf16 v[20:23], v[112:115], v[172:175], v[20:23]
    v_mfma_f32_16x16x32_bf16 v[52:55], v[116:119], v[176:179], v[52:55]
    v_mfma_f32_16x16x32_bf16 v[24:27], v[116:119], v[172:175], v[24:27]
L_TAIL:
    v_mov_b32 v137, v16
    v_mov_b32 v139, v16
    v_mov_b32 v177, v16
    v_mov_b32 v179, v16
    v_mov_b32 v109, v16
    v_mov_b32 v111, v16
    s_waitcnt lgkmcnt(10)
    v_pk_fma_f32 v[76:77], v[220:221], v[238:239], v[76:77] op_sel_hi:[1,0,1]
    v_pk_fma_f32 v[78:79], v[222:223], v[238:239], v[78:79] op_sel_hi:[1,0,1]
    v_pk_fma_f32 v[80:81], v[156:157], v[224:225], v[80:81] op_sel:[0,0,0] op_sel_hi:[1,0,1]
    v_pk_fma_f32 v[82:83], v[158:159], v[224:225], v[82:83] op_sel:[0,0,0] op_sel_hi:[1,0,1]
    v_pk_mul_f32 v[80:81], v[80:81], v[160:161]
    v_pk_mul_f32 v[82:83], v[82:83], v[162:163]
    v_pk_mul_f32 v[76:77], v[76:77], v[238:239] op_sel:[0,1] op_sel_hi:[1,1]
    v_pk_mul_f32 v[78:79], v[78:79], v[238:239] op_sel:[0,1] op_sel_hi:[1,1]
    v_cvt_pk_bf16_f32 v108, v76, v77
    v_cvt_pk_bf16_f32 v110, v78, v79
    v_cvt_pk_bf16_f32 v76, v76, v77
    v_cvt_pk_bf16_f32 v77, v78, v79
    v_cvt_pk_bf16_f32 v80, v80, v81
    v_cvt_pk_bf16_f32 v81, v82, v83
    s_mov_b64 exec, s[64:65]
    ds_write_b64 v225, v[76:77]
    ds_write_b64 v225, v[80:81] offset:1024
    s_not_b64 exec, exec
    ds_write_b32 v226, v110
    s_mov_b32 exec_lo, 0
    s_mov_b32 exec_hi, s66
    ds_write_b128 v227, v[108:111]
    s_mov_b64 exec, -1
    s_waitcnt lgkmcnt(6)
    v_pk_fma_f32 v[56:57], v[92:93], v[234:235], v[56:57] op_sel_hi:[1,0,1]
    v_pk_fma_f32 v[58:59], v[94:95], v[234:235], v[58:59] op_sel_hi:[1,0,1]
    v_pk_fma_f32 v[64:65], v[148:149], v[104:105], v[64:65] op_sel:[0,0,0] op_sel_hi:[1,0,1]
    v_pk_fma_f32 v[66:67], v[150:151], v[104:105], v[66:67] op_sel:[0,0,0] op_sel_hi:[1,0,1]
    v_pk_mul_f32 v[64:65], v[64:65], v[152:153]
    v_pk_mul_f32 v[66:67], v[66:67], v[154:155]
    v_pk_mul_f32 v[56:57], v[56:57], v[234:235] op_sel:[0,1] op_sel_hi:[1,1]
    v_pk_mul_f32 v[58:59], v[58:59], v[234:235] op_sel:[0,1] op_sel_hi:[1,1]
    v_cvt_pk_bf16_f32 v168, v64, v65
    v_cvt_pk_bf16_f32 v169, v66, v67
    v_cvt_pk_bf16_f32 v120, v56, v57
    v_cvt_pk_bf16_f32 v121, v58, v59
    s_waitcnt lgkmcnt(4)
    v_pk_fma_f32 v[60:61], v[96:97], v[234:235], v[60:61] op_sel_hi:[1,0,1]
    v_pk_fma_f32 v[62:63], v[98:99], v[234:235], v[62:63] op_sel_hi:[1,0,1]
    v_pk_fma_f32 v[68:69], v[148:149], v[104:105], v[68:69] op_sel:[0,1,0] op_sel_hi:[1,1,1]
    v_pk_fma_f32 v[70:71], v[150:151], v[104:105], v[70:71] op_sel:[0,1,0] op_sel_hi:[1,1,1]
    v_pk_mul_f32 v[68:69], v[68:69], v[152:153]
    v_pk_mul_f32 v[70:71], v[70:71], v[154:155]
    v_pk_mul_f32 v[60:61], v[60:61], v[234:235] op_sel:[0,1] op_sel_hi:[1,1]
    v_pk_mul_f32 v[62:63], v[62:63], v[234:235] op_sel:[0,1] op_sel_hi:[1,1]
    v_cvt_pk_bf16_f32 v174, v68, v69
    v_cvt_pk_bf16_f32 v175, v70, v71
    v_cvt_pk_bf16_f32 v132, v60, v61
    v_cvt_pk_bf16_f32 v133, v62, v63
    v_pk_fma_f32 v[72:73], v[100:101], v[234:235], v[72:73] op_sel_hi:[1,0,1]
    v_pk_fma_f32 v[74:75], v[102:103], v[234:235], v[74:75] op_sel_hi:[1,0,1]
    v_pk_mul_f32 v[72:73], v[72:73], v[232:233] op_sel_hi:[1,0]
    v_pk_mul_f32 v[74:75], v[74:75], v[234:235] op_sel:[0,1] op_sel_hi:[1,1]
    v_cvt_pk_bf16_f32 v176, v72, v73
    v_cvt_pk_bf16_f32 v178, v74, v75
    v_cvt_pk_bf16_f32 v122, v74, v75
    v_cvt_pk_bf16_f32 v134, v74, v75
    s_mov_b64 exec, s[78:79]
    ds_write_b64 v196, v[120:121] offset:2304
    ds_write_b64 v196, v[168:169] offset:3328
    ds_write_b64 v196, v[132:133] offset:2816
    ds_write_b64 v196, v[174:175] offset:3840
    ds_write_b32 v197, v122 offset:4352
    s_mov_b64 exec, -1
    v_pk_fma_f32 v[44:45], v[100:101], v[230:231], v[44:45] op_sel_hi:[1,0,1]
    v_pk_fma_f32 v[46:47], v[102:103], v[230:231], v[46:47] op_sel_hi:[1,0,1]
    v_pk_mul_f32 v[44:45], v[44:45], v[228:229] op_sel_hi:[1,0]
    v_pk_mul_f32 v[46:47], v[46:47], v[230:231] op_sel:[0,1] op_sel_hi:[1,1]
    v_cvt_pk_bf16_f32 v136, v44, v45
    v_cvt_pk_bf16_f32 v138, v46, v47
    v_cvt_pk_bf16_f32 v118, v46, v47
    v_cvt_pk_bf16_f32 v130, v46, v47
    s_mov_b32 exec_lo, 0x0
    s_mov_b32 exec_hi, 0xffff
    ds_write_b128 v198, v[176:179] offset:512
    ds_write_b128 v198, v[136:139] offset:256
    s_mov_b64 exec, -1
    v_pk_fma_f32 v[28:29], v[92:93], v[230:231], v[28:29] op_sel_hi:[1,0,1]
    v_pk_fma_f32 v[30:31], v[94:95], v[230:231], v[30:31] op_sel_hi:[1,0,1]
    v_pk_fma_f32 v[36:37], v[140:141], v[104:105], v[36:37] op_sel:[0,0,0] op_sel_hi:[1,0,1]
    v_pk_fma_f32 v[38:39], v[142:143], v[104:105], v[38:39] op_sel:[0,0,0] op_sel_hi:[1,0,1]
    v_pk_mul_f32 v[36:37], v[36:37], v[144:145]
    v_pk_mul_f32 v[38:39], v[38:39], v[146:147]
    v_pk_mul_f32 v[28:29], v[28:29], v[230:231] op_sel:[0,1] op_sel_hi:[1,1]
    v_pk_mul_f32 v[30:31], v[30:31], v[230:231] op_sel:[0,1] op_sel_hi:[1,1]
    v_cvt_pk_bf16_f32 v166, v36, v37
    v_cvt_pk_bf16_f32 v167, v38, v39
    v_cvt_pk_bf16_f32 v116, v28, v29
    v_cvt_pk_bf16_f32 v117, v30, v31
    v_pk_fma_f32 v[32:33], v[96:97], v[230:231], v[32:33] op_sel_hi:[1,0,1]
    v_pk_fma_f32 v[34:35], v[98:99], v[230:231], v[34:35] op_sel_hi:[1,0,1]
    v_pk_fma_f32 v[40:41], v[140:141], v[104:105], v[40:41] op_sel:[0,1,0] op_sel_hi:[1,1,1]
    v_pk_fma_f32 v[42:43], v[142:143], v[104:105], v[42:43] op_sel:[0,1,0] op_sel_hi:[1,1,1]
    v_pk_mul_f32 v[40:41], v[40:41], v[144:145]
    v_pk_mul_f32 v[42:43], v[42:43], v[146:147]
    v_pk_mul_f32 v[32:33], v[32:33], v[230:231] op_sel:[0,1] op_sel_hi:[1,1]
    v_pk_mul_f32 v[34:35], v[34:35], v[230:231] op_sel:[0,1] op_sel_hi:[1,1]
    v_cvt_pk_bf16_f32 v172, v40, v41
    v_cvt_pk_bf16_f32 v173, v42, v43
    v_cvt_pk_bf16_f32 v128, v32, v33
    v_cvt_pk_bf16_f32 v129, v34, v35
    s_waitcnt lgkmcnt(0)
    s_barrier
    ds_read_b64 v[112:113], v196 offset:0
    ds_read_b32 v114, v197 offset:2048
    ds_read_b64 v[124:125], v196 offset:512
    ds_read_b32 v126, v197 offset:2048
    ds_read_b64 v[164:165], v196 offset:1024
    ds_read_b64_tr_b16 v[220:221], v201 offset:0
    ds_read_b64_tr_b16 v[222:223], v201 offset:256
    ds_read_b64_tr_b16 v[224:225], v201 offset:512
    ds_read_b64 v[170:171], v196 offset:1536
    ds_read_b64_tr_b16 v[106:107], v201 offset:8
    ds_read_b64_tr_b16 v[108:109], v201 offset:264
    ds_read_b64_tr_b16 v[110:111], v201 offset:520
    v_pk_fma_f32 v[48:49], v[84:85], v[234:235], v[48:49] op_sel_hi:[1,0,1]
    v_pk_fma_f32 v[50:51], v[86:87], v[234:235], v[50:51] op_sel_hi:[1,0,1]
    v_cndmask_b32 v214, 0, v176, s[72:73]
    v_cvt_pk_bf16_f32 v212, v48, v49
    v_cvt_pk_bf16_f32 v213, v50, v51
    v_pk_fma_f32 v[52:53], v[88:89], v[234:235], v[52:53] op_sel_hi:[1,0,1]
    v_pk_fma_f32 v[54:55], v[90:91], v[234:235], v[54:55] op_sel_hi:[1,0,1]
    v_cndmask_b32 v218, 0, v176, s[74:75]
    v_cvt_pk_bf16_f32 v216, v52, v53
    v_cvt_pk_bf16_f32 v217, v54, v55
    v_mfma_f32_16x16x32_bf16 v[56:59], v[116:119], v[212:215], v[180:183]
    v_mfma_f32_16x16x32_bf16 v[60:63], v[120:123], v[212:215], v[184:187]
    v_pk_fma_f32 v[20:21], v[84:85], v[230:231], v[20:21] op_sel_hi:[1,0,1]
    v_pk_fma_f32 v[22:23], v[86:87], v[230:231], v[22:23] op_sel_hi:[1,0,1]
    v_cndmask_b32 v206, 0, v136, s[72:73]
    v_cvt_pk_bf16_f32 v204, v20, v21
    v_cvt_pk_bf16_f32 v205, v22, v23
    v_mfma_f32_16x16x32_bf16 v[64:67], v[128:131], v[216:219], v[180:183]
    v_mfma_f32_16x16x32_bf16 v[68:71], v[132:135], v[216:219], v[184:187]
    v_pk_fma_f32 v[24:25], v[88:89], v[230:231], v[24:25] op_sel_hi:[1,0,1]
    v_pk_fma_f32 v[26:27], v[90:91], v[230:231], v[26:27] op_sel_hi:[1,0,1]
    v_cndmask_b32 v210, 0, v136, s[74:75]
    v_cvt_pk_bf16_f32 v208, v24, v25
    v_cvt_pk_bf16_f32 v209, v26, v27
    s_waitcnt lgkmcnt(8)
    v_mfma_f32_16x16x32_bf16 v[28:31], v[112:115], v[204:207], v[188:191]
    v_mfma_f32_16x16x32_bf16 v[32:35], v[116:119], v[204:207], v[184:187]
    v_mfma_f32_16x16x32_bf16 v[36:39], v[124:127], v[208:211], v[188:191]
    v_mfma_f32_16x16x32_bf16 v[40:43], v[128:131], v[208:211], v[184:187]
    v_max3_f32 v56, v56, v57, v60
    v_max3_f32 v58, v58, v59, v62
    v_max_f32 v56, v56, v61
    v_max_f32 v58, v58, v63
    v_max_f32 v72, v56, v58
    v_max_f32 v73, v56, v58
    v_max3_f32 v64, v64, v65, v68
    v_max3_f32 v66, v66, v67, v70
    v_max_f32 v64, v64, v69
    v_max_f32 v66, v66, v71
    v_max_f32 v74, v64, v66
    v_max_f32 v75, v64, v66
    v_max3_f32 v28, v28, v29, v32
    v_max3_f32 v30, v30, v31, v34
    v_max_f32 v28, v28, v33
    v_max_f32 v30, v30, v35
    v_max_f32 v76, v28, v30
    v_max_f32 v77, v28, v30
    v_max3_f32 v36, v36, v37, v40
    v_max3_f32 v38, v38, v39, v42
    v_max_f32 v36, v36, v41
    v_max_f32 v38, v38, v43
    v_max_f32 v78, v36, v38
    v_max_f32 v79, v36, v38
    v_permlane32_swap_b32 v72, v73
    v_permlane32_swap_b32 v74, v75
    v_permlane32_swap_b32 v76, v77
    v_permlane32_swap_b32 v78, v79
    v_max_f32 v72, v72, v73
    v_max_f32 v74, v74, v75
    v_max_f32 v76, v76, v77
    v_max_f32 v78, v78, v79
    v_mov_b32 v73, v72
    v_mov_b32 v75, v74
    v_mov_b32 v77, v76
    v_mov_b32 v79, v78
    v_permlane16_swap_b32 v72, v73
    v_permlane16_swap_b32 v74, v75
    v_permlane16_swap_b32 v76, v77
    v_permlane16_swap_b32 v78, v79
    v_max_f32 v72, v72, v73
    v_max_f32 v74, v74, v75
    v_max_f32 v76, v76, v77
    v_max_f32 v78, v78, v79
    v_sub_f32 v56, v56, v72
    v_sub_f32 v58, v58, v72
    v_sub_f32 v64, v64, v74
    v_sub_f32 v66, v66, v74
    v_sub_f32 v28, v28, v76
    v_sub_f32 v30, v30, v76
    v_sub_f32 v36, v36, v78
    v_sub_f32 v38, v38, v78
    v_mul_f32 v56, v56, v233
    v_mul_f32 v58, v58, v233
    v_mul_f32 v64, v64, v233
    v_mul_f32 v66, v66, v233
    v_mul_f32 v28, v28, v229
    v_mul_f32 v30, v30, v229
    v_mul_f32 v36, v36, v229
    v_mul_f32 v38, v38, v229
    v_exp_f32 v56, v56
    v_exp_f32 v58, v58
    v_exp_f32 v64, v64
    v_exp_f32 v66, v66
    v_exp_f32 v28, v28
    v_exp_f32 v30, v30
    v_exp_f32 v36, v36
    v_exp_f32 v38, v38
    s_waitcnt vmcnt(0) lgkmcnt(0)
    v_cmp_ne_u32 vcc, s84, v15
    s_nop 0
    s_cmp_eq_u64 vcc, 0
    s_cselect_b32 s28, 1, 0
    s_cmp_eq_u32 s19, 0
    s_cselect_b32 s68, s28, s68
    v_cvt_pk_bf16_f32 v56, v56, v56
    v_cvt_pk_bf16_f32 v58, v58, v58
    v_and_b32 v48, v56, v192
    v_and_b32 v49, v58, v193
    v_and_b32 v50, v56, v194
    v_and_b32 v51, v58, v195
    v_cvt_pk_bf16_f32 v64, v64, v64
    v_cvt_pk_bf16_f32 v66, v66, v66
    v_and_b32 v52, v64, v192
    v_and_b32 v53, v66, v193
    v_and_b32 v54, v64, v194
    v_and_b32 v55, v66, v195
    v_mfma_f32_16x16x32_bf16 v[116:119], v[222:225], v[48:51], 0
    v_mfma_f32_16x16x32_bf16 v[112:115], v[166:169], v[48:51], 0
    v_cvt_pk_bf16_f32 v28, v28, v28
    v_cvt_pk_bf16_f32 v30, v30, v30
    v_and_b32 v20, v28, v192
    v_and_b32 v21, v30, v193
    v_and_b32 v22, v28, v194
    v_and_b32 v23, v30, v195
    v_mfma_f32_16x16x32_bf16 v[124:127], v[108:111], v[52:55], 0
    v_mfma_f32_16x16x32_bf16 v[120:123], v[172:175], v[52:55], 0
    v_cvt_pk_bf16_f32 v36, v36, v36
    v_cvt_pk_bf16_f32 v38, v38, v38
    v_and_b32 v24, v36, v192
    v_and_b32 v25, v38, v193
    v_and_b32 v26, v36, v194
    v_and_b32 v27, v38, v195
    v_mfma_f32_16x16x32_bf16 v[132:135], v[220:223], v[20:23], 0
    v_mfma_f32_16x16x32_bf16 v[128:131], v[164:167], v[20:23], 0
    v_rcp_f32 v118, v118
    v_mfma_f32_16x16x32_bf16 v[140:143], v[106:109], v[24:27], 0
    v_mfma_f32_16x16x32_bf16 v[136:139], v[170:173], v[24:27], 0
    v_rcp_f32 v126, v126
    v_pk_mul_f32 v[112:113], v[112:113], v[118:119] op_sel_hi:[1,0]
    v_pk_mul_f32 v[114:115], v[114:115], v[118:119] op_sel_hi:[1,0]
    v_pk_mul_f32 v[116:117], v[116:117], v[118:119] op_sel_hi:[1,0]
    v_cvt_pk_bf16_f32 v92, v112, v113
    v_cvt_pk_bf16_f32 v93, v114, v115
    v_cvt_pk_bf16_f32 v96, v116, v117
    v_rcp_f32 v134, v134
    v_pk_mul_f32 v[120:121], v[120:121], v[126:127] op_sel_hi:[1,0]
    v_pk_mul_f32 v[122:123], v[122:123], v[126:127] op_sel_hi:[1,0]
    v_pk_mul_f32 v[124:125], v[124:125], v[126:127] op_sel_hi:[1,0]
    v_cvt_pk_bf16_f32 v94, v120, v121
    v_cvt_pk_bf16_f32 v95, v122, v123
    v_cvt_pk_bf16_f32 v97, v124, v125
    v_rcp_f32 v142, v142
    v_pk_mul_f32 v[128:129], v[128:129], v[134:135] op_sel_hi:[1,0]
    v_pk_mul_f32 v[130:131], v[130:131], v[134:135] op_sel_hi:[1,0]
    v_pk_mul_f32 v[132:133], v[132:133], v[134:135] op_sel_hi:[1,0]
    v_cvt_pk_bf16_f32 v84, v128, v129
    v_cvt_pk_bf16_f32 v85, v130, v131
    v_cvt_pk_bf16_f32 v88, v132, v133
    v_pk_mul_f32 v[136:137], v[136:137], v[142:143] op_sel_hi:[1,0]
    v_pk_mul_f32 v[138:139], v[138:139], v[142:143] op_sel_hi:[1,0]
    v_pk_mul_f32 v[140:141], v[140:141], v[142:143] op_sel_hi:[1,0]
    v_cvt_pk_bf16_f32 v86, v136, v137
    v_cvt_pk_bf16_f32 v87, v138, v139
    v_cvt_pk_bf16_f32 v89, v140, v141
    s_cmp_eq_u32 s68, 0
    s_cbranch_scc1 LOC_24
    buffer_store_dwordx4 v[84:87], v0, s[4:7], s34 offen
    buffer_store_dwordx4 v[92:95], v0, s[4:7], s35 offen
    s_mov_b64 exec, 0xffff
    buffer_store_dwordx2 v[88:89], v1, s[4:7], s36 offen
    buffer_store_dwordx2 v[96:97], v1, s[4:7], s37 offen
    s_mov_b64 exec, -1
LOCE_25:
    v_and_b32 v14, 15, v3
    v_lshlrev_b32 v14, 9, v14
    s_lshl_b32 s30, s22, 13
    s_and_b32 s28, s20, 1
    s_lshl_b32 s28, s28, 1
    s_lshr_b32 s29, s17, 1
    s_add_u32 s28, s28, s29
    s_lshl_b32 s28, s28, 7
    s_add_u32 s30, s30, s28
    s_add_u32 s30, s30, 25165824
    s_add_u32 s31, s26, 0
    v_add_u32 v49, 61440, v0
    v_add_u32 v51, 0, v0
    s_add_u32 s34, s88, s24
    s_add_u32 s34, s34, 0
    s_lshl_b32 s35, s21, 8
    s_add_u32 s35, s35, s34
    s_add_u32 s35, s35, 16384
    s_lshl_b32 s36, s21, 11
    s_add_u32 s34, s34, s36
    s_lshl_b32 s36, s21, 7
    s_add_u32 s36, s36, s89
    s_add_u32 s36, s36, s25
    s_add_u32 s36, s36, 0
    v_and_b32 v48, 0x78, v1
    s_add_u32 s48, s88, s24
    s_add_u32 s48, s48, 2359296
    s_add_u32 s49, s48, 4096
    s_add_u32 s50, s48, 8192
    s_add_u32 s51, s48, 12288
    s_add_u32 s52, s48, 16384
    v_mov_b32 v254, s31
    v_mov_b32 v255, s31
    s_mov_b64 exec, 0xffff
    s_waitcnt vmcnt(0)
    s_cmp_eq_u32 s68, 0
    s_cbranch_scc1 LOC_26
    buffer_store_dwordx2 v[254:255], v1, s[4:7], s81 offen
LOCE_27:
    s_mov_b64 exec, -1
    s_barrier
    ds_read_b128 v[132:135], v51 offset:0
    v_lshlrev_b32 v20, 16, v4
    v_and_b32 v21, 0xffff0000, v4
    ds_read_b128 v[136:139], v51 offset:1024
    v_lshlrev_b32 v22, 16, v5
    v_and_b32 v23, 0xffff0000, v5
    ds_read_b128 v[140:143], v51 offset:2048
    v_lshlrev_b32 v24, 16, v6
    v_and_b32 v25, 0xffff0000, v6
    ds_read_b128 v[144:147], v51 offset:3072
    v_lshlrev_b32 v26, 16, v7
    v_and_b32 v27, 0xffff0000, v7
    ds_read_b128 v[148:151], v51 offset:4096
    v_lshlrev_b32 v28, 16, v8
    v_and_b32 v29, 0xffff0000, v8
    ds_read_b128 v[152:155], v51 offset:5120
    v_lshlrev_b32 v30, 16, v9
    v_and_b32 v31, 0xffff0000, v9
    ds_read_b128 v[156:159], v51 offset:6144
    v_lshlrev_b32 v32, 16, v10
    v_and_b32 v33, 0xffff0000, v10
    ds_read_b128 v[160:163], v51 offset:7168
    v_lshlrev_b32 v34, 16, v11
    v_and_b32 v35, 0xffff0000, v11
    ds_read_b128 v[164:167], v51 offset:8192
    v_lshlrev_b32 v36, 16, v12
    v_and_b32 v37, 0xffff0000, v12
    ds_read_b128 v[168:171], v51 offset:9216
    v_lshlrev_b32 v38, 16, v13
    v_and_b32 v39, 0xffff0000, v13
    buffer_load_dword v15, v14, s[4:7], s30 offen sc1
    ds_read_b128 v[172:175], v51 offset:10240
    ds_read_b128 v[176:179], v51 offset:11264
    ds_read_b128 v[180:183], v51 offset:12288
    ds_read_b128 v[184:187], v51 offset:13312
    ds_read_b128 v[188:191], v51 offset:14336
    ds_read_b128 v[192:195], v51 offset:15360
    ds_read_b128 v[196:199], v51 offset:16384
    ds_read_b128 v[200:203], v51 offset:17408
    ds_read_b128 v[204:207], v51 offset:18432
    ds_read_b128 v[208:211], v51 offset:19456
    s_waitcnt vmcnt(0)
    v_subrev_u32 v15, s31, v15
    v_cmp_le_u32 vcc, 16, v15
    s_nop 0
    s_cbranch_vccnz POLLC_29
POLLE_28:
    buffer_load_dwordx4 v[52:55], v0, s[4:7], s48 offen offset:0 sc1
    ds_read_b128 v[212:215], v51 offset:20480
    buffer_load_dwordx4 v[56:59], v0, s[4:7], s48 offen offset:1024 sc1
    ds_read_b128 v[216:219], v51 offset:21504
    buffer_load_dwordx4 v[60:63], v0, s[4:7], s48 offen offset:2048 sc1
    ds_read_b128 v[220:223], v51 offset:22528
    buffer_load_dwordx4 v[64:67], v0, s[4:7], s48 offen offset:3072 sc1
    ds_read_b128 v[224:227], v51 offset:23552
    ds_read_b128 v[228:231], v51 offset:24576
    buffer_load_dwordx4 v[68:71], v0, s[4:7], s49 offen offset:0 sc1
    ds_read_b128 v[232:235], v51 offset:25600
    buffer_load_dwordx4 v[72:75], v0, s[4:7], s49 offen offset:1024 sc1
    ds_read_b128 v[236:239], v51 offset:26624
    buffer_load_dwordx4 v[76:79], v0, s[4:7], s49 offen offset:2048 sc1
    ds_read_b128 v[240:243], v51 offset:27648
    buffer_load_dwordx4 v[80:83], v0, s[4:7], s49 offen offset:3072 sc1
    ds_read_b128 v[244:247], v51 offset:28672
    ds_read_b128 v[248:251], v51 offset:29696
    s_waitcnt vmcnt(7)
    s_waitcnt lgkmcnt(15)
    v_mfma_f32_16x16x32_bf16 v[20:23], v[132:135], v[52:55], v[20:23]
    buffer_load_dwordx4 v[84:87], v0, s[4:7], s50 offen offset:0 sc1
    v_mfma_f32_16x16x32_bf16 v[24:27], v[136:139], v[52:55], v[24:27]
    ds_read_b128 v[132:135], v51 offset:30720
    v_mfma_f32_16x16x32_bf16 v[28:31], v[140:143], v[52:55], v[28:31]
    ds_read_b128 v[136:139], v51 offset:31744
    v_mfma_f32_16x16x32_bf16 v[32:35], v[144:147], v[52:55], v[32:35]
    ds_read_b128 v[140:143], v51 offset:32768
    v_mfma_f32_16x16x32_bf16 v[36:39], v[148:151], v[52:55], v[36:39]
    ds_read_b128 v[144:147], v51 offset:33792
    s_waitcnt vmcnt(7)
    s_waitcnt lgkmcnt(15)
    v_mfma_f32_16x16x32_bf16 v[20:23], v[152:155], v[56:59], v[20:23]
    buffer_load_dwordx4 v[88:91], v0, s[4:7], s50 offen offset:1024 sc1
    v_mfma_f32_16x16x32_bf16 v[24:27], v[156:159], v[56:59], v[24:27]
    ds_read_b128 v[148:151], v51 offset:34816
    v_mfma_f32_16x16x32_bf16 v[28:31], v[160:163], v[56:59], v[28:31]
    ds_read_b128 v[152:155], v51 offset:35840
    v_mfma_f32_16x16x32_bf16 v[32:35], v[164:167], v[56:59], v[32:35]
    ds_read_b128 v[156:159], v51 offset:36864
    v_mfma_f32_16x16x32_bf16 v[36:39], v[168:171], v[56:59], v[36:39]
    ds_read_b128 v[160:163], v51 offset:37888
    s_waitcnt vmcnt(7)
    s_waitcnt lgkmcnt(15)
    v_mfma_f32_16x16x32_bf16 v[20:23], v[172:175], v[60:63], v[20:23]
    buffer_load_dwordx4 v[92:95], v0, s[4:7], s50 offen offset:2048 sc1
    v_mfma_f32_16x16x32_bf16 v[24:27], v[176:179], v[60:63], v[24:27]
    ds_read_b128 v[164:167], v51 offset:38912
    v_mfma_f32_16x16x32_bf16 v[28:31], v[180:183], v[60:63], v[28:31]
    ds_read_b128 v[168:171], v51 offset:39936
    v_mfma_f32_16x16x32_bf16 v[32:35], v[184:187], v[60:63], v[32:35]
    ds_read_b128 v[172:175], v51 offset:40960
    v_mfma_f32_16x16x32_bf16 v[36:39], v[188:191], v[60:63], v[36:39]
    ds_read_b128 v[176:179], v51 offset:41984
    s_waitcnt vmcnt(7)
    s_waitcnt lgkmcnt(15)
    v_mfma_f32_16x16x32_bf16 v[20:23], v[192:195], v[64:67], v[20:23]
    buffer_load_dwordx4 v[96:99], v0, s[4:7], s50 offen offset:3072 sc1
    v_mfma_f32_16x16x32_bf16 v[24:27], v[196:199], v[64:67], v[24:27]
    ds_read_b128 v[180:183], v51 offset:43008
    v_mfma_f32_16x16x32_bf16 v[28:31], v[200:203], v[64:67], v[28:31]
    ds_read_b128 v[184:187], v51 offset:44032
    v_mfma_f32_16x16x32_bf16 v[32:35], v[204:207], v[64:67], v[32:35]
    ds_read_b128 v[188:191], v51 offset:45056
    v_mfma_f32_16x16x32_bf16 v[36:39], v[208:211], v[64:67], v[36:39]
    ds_read_b128 v[192:195], v51 offset:46080
    s_waitcnt vmcnt(7)
    s_waitcnt lgkmcnt(15)
    v_mfma_f32_16x16x32_bf16 v[20:23], v[212:215], v[68:71], v[20:23]
    buffer_load_dwordx4 v[100:103], v0, s[4:7], s51 offen offset:0 sc1
    v_mfma_f32_16x16x32_bf16 v[24:27], v[216:219], v[68:71], v[24:27]
    ds_read_b128 v[196:199], v51 offset:47104
    v_mfma_f32_16x16x32_bf16 v[28:31], v[220:223], v[68:71], v[28:31]
    ds_read_b128 v[200:203], v51 offset:48128
    v_mfma_f32_16x16x32_bf16 v[32:35], v[224:227], v[68:71], v[32:35]
    ds_read_b128 v[204:207], v51 offset:49152
    v_mfma_f32_16x16x32_bf16 v[36:39], v[228:231], v[68:71], v[36:39]
    ds_read_b128 v[208:211], v51 offset:50176
    s_waitcnt vmcnt(7)
    s_waitcnt lgkmcnt(15)
    v_mfma_f32_16x16x32_bf16 v[20:23], v[232:235], v[72:75], v[20:23]
    buffer_load_dwordx4 v[104:107], v0, s[4:7], s51 offen offset:1024 sc1
    v_mfma_f32_16x16x32_bf16 v[24:27], v[236:239], v[72:75], v[24:27]
    ds_read_b128 v[212:215], v51 offset:51200
    v_mfma_f32_16x16x32_bf16 v[28:31], v[240:243], v[72:75], v[28:31]
    ds_read_b128 v[216:219], v51 offset:52224
    v_mfma_f32_16x16x32_bf16 v[32:35], v[244:247], v[72:75], v[32:35]
    ds_read_b128 v[220:223], v51 offset:53248
    v_mfma_f32_16x16x32_bf16 v[36:39], v[248:251], v[72:75], v[36:39]
    ds_read_b128 v[224:227], v51 offset:54272
    s_waitcnt vmcnt(7)
    s_waitcnt lgkmcnt(15)
    v_mfma_f32_16x16x32_bf16 v[20:23], v[132:135], v[76:79], v[20:23]
    buffer_load_dwordx4 v[108:111], v0, s[4:7], s51 offen offset:2048 sc1
    v_mfma_f32_16x16x32_bf16 v[24:27], v[136:139], v[76:79], v[24:27]
    ds_read_b128 v[228:231], v51 offset:55296
    v_mfma_f32_16x16x32_bf16 v[28:31], v[140:143], v[76:79], v[28:31]
    ds_read_b128 v[232:235], v51 offset:56320
    v_mfma_f32_16x16x32_bf16 v[32:35], v[144:147], v[76:79], v[32:35]
    ds_read_b128 v[236:239], v51 offset:57344
    v_mfma_f32_16x16x32_bf16 v[36:39], v[148:151], v[76:79], v[36:39]
    ds_read_b128 v[240:243], v51 offset:58368
    s_waitcnt vmcnt(7)
    s_waitcnt lgkmcnt(15)
    v_mfma_f32_16x16x32_bf16 v[20:23], v[152:155], v[80:83], v[20:23]
    buffer_load_dwordx4 v[112:115], v0, s[4:7], s51 offen offset:3072 sc1
    v_mfma_f32_16x16x32_bf16 v[24:27], v[156:159], v[80:83], v[24:27]
    ds_read_b128 v[244:247], v51 offset:59392
    v_mfma_f32_16x16x32_bf16 v[28:31], v[160:163], v[80:83], v[28:31]
    ds_read_b128 v[248:251], v51 offset:60416
    v_mfma_f32_16x16x32_bf16 v[32:35], v[164:167], v[80:83], v[32:35]
    ds_read_b128 v[132:135], v49 offset:0
    v_mfma_f32_16x16x32_bf16 v[36:39], v[168:171], v[80:83], v[36:39]
    ds_read_b128 v[136:139], v49 offset:1024
    s_waitcnt vmcnt(7)
    s_waitcnt lgkmcnt(15)
    v_mfma_f32_16x16x32_bf16 v[20:23], v[172:175], v[84:87], v[20:23]
    buffer_load_dwordx2 v[116:117], v2, s[4:7], s52 offen offset:0 sc1
    v_mfma_f32_16x16x32_bf16 v[24:27], v[176:179], v[84:87], v[24:27]
    ds_read_b128 v[140:143], v49 offset:2048
    v_mfma_f32_16x16x32_bf16 v[28:31], v[180:183], v[84:87], v[28:31]
    ds_read_b128 v[144:147], v49 offset:3072
    v_mfma_f32_16x16x32_bf16 v[32:35], v[184:187], v[84:87], v[32:35]
    ds_read_b128 v[148:151], v49 offset:4096
    v_mfma_f32_16x16x32_bf16 v[36:39], v[188:191], v[84:87], v[36:39]
    ds_read_b128 v[152:155], v49 offset:5120
    s_waitcnt vmcnt(7)
    s_waitcnt lgkmcnt(15)
    v_mfma_f32_16x16x32_bf16 v[20:23], v[192:195], v[88:91], v[20:23]
    buffer_load_dwordx2 v[118:119], v2, s[4:7], s52 offen offset:128 sc1
    v_mfma_f32_16x16x32_bf16 v[24:27], v[196:199], v[88:91], v[24:27]
    ds_read_b128 v[156:159], v49 offset:6144
    v_mfma_f32_16x16x32_bf16 v[28:31], v[200:203], v[88:91], v[28:31]
    ds_read_b128 v[160:163], v49 offset:7168
    v_mfma_f32_16x16x32_bf16 v[32:35], v[204:207], v[88:91], v[32:35]
    ds_read_b128 v[164:167], v49 offset:8192
    v_mfma_f32_16x16x32_bf16 v[36:39], v[208:211], v[88:91], v[36:39]
    ds_read_b128 v[168:171], v49 offset:9216
    s_waitcnt vmcnt(7)
    s_waitcnt lgkmcnt(15)
    v_mfma_f32_16x16x32_bf16 v[20:23], v[212:215], v[92:95], v[20:23]
    buffer_load_dwordx2 v[120:121], v2, s[4:7], s52 offen offset:1024 sc1
    v_mfma_f32_16x16x32_bf16 v[24:27], v[216:219], v[92:95], v[24:27]
    ds_read_b128 v[172:175], v49 offset:10240
    v_mfma_f32_16x16x32_bf16 v[28:31], v[220:223], v[92:95], v[28:31]
    ds_read_b128 v[176:179], v49 offset:11264
    v_mfma_f32_16x16x32_bf16 v[32:35], v[224:227], v[92:95], v[32:35]
    ds_read_b128 v[180:183], v49 offset:12288
    v_mfma_f32_16x16x32_bf16 v[36:39], v[228:231], v[92:95], v[36:39]
    ds_read_b128 v[184:187], v49 offset:13312
    s_waitcnt vmcnt(7)
    s_waitcnt lgkmcnt(14)
    v_mfma_f32_16x16x32_bf16 v[20:23], v[232:235], v[96:99], v[20:23]
    buffer_load_dwordx2 v[122:123], v2, s[4:7], s52 offen offset:1152 sc1
    v_mfma_f32_16x16x32_bf16 v[24:27], v[236:239], v[96:99], v[24:27]
    ds_read_b128 v[188:191], v49 offset:14336
    v_mfma_f32_16x16x32_bf16 v[28:31], v[240:243], v[96:99], v[28:31]
    ds_read_b128 v[192:195], v49 offset:15360
    v_mfma_f32_16x16x32_bf16 v[32:35], v[244:247], v[96:99], v[32:35]
    ds_read_b128 v[196:199], v49 offset:16384
    v_mfma_f32_16x16x32_bf16 v[36:39], v[248:251], v[96:99], v[36:39]
    ds_read_b128 v[200:203], v49 offset:17408
    s_waitcnt vmcnt(7)
    s_waitcnt lgkmcnt(13)
    v_mfma_f32_16x16x32_bf16 v[20:23], v[132:135], v[100:103], v[20:23]
    v_mfma_f32_16x16x32_bf16 v[24:27], v[136:139], v[100:103], v[24:27]
    ds_read_b128 v[204:207], v49 offset:18432
    v_mfma_f32_16x16x32_bf16 v[28:31], v[140:143], v[100:103], v[28:31]
    ds_read_b128 v[208:211], v49 offset:19456
    v_mfma_f32_16x16x32_bf16 v[32:35], v[144:147], v[100:103], v[32:35]
    ds_read_b128 v[212:215], v49 offset:20480
    v_mfma_f32_16x16x32_bf16 v[36:39], v[148:151], v[100:103], v[36:39]
    ds_read_b128 v[216:219], v49 offset:21504
    s_waitcnt vmcnt(6)
    s_waitcnt lgkmcnt(12)
    v_mfma_f32_16x16x32_bf16 v[20:23], v[152:155], v[104:107], v[20:23]
    v_mfma_f32_16x16x32_bf16 v[24:27], v[156:159], v[104:107], v[24:27]
    ds_read_b128 v[220:223], v49 offset:22528
    v_mfma_f32_16x16x32_bf16 v[28:31], v[160:163], v[104:107], v[28:31]
    ds_read_b128 v[224:227], v49 offset:23552
    v_mfma_f32_16x16x32_bf16 v[32:35], v[164:167], v[104:107], v[32:35]
    ds_read_b128 v[228:231], v49 offset:24576
    v_mfma_f32_16x16x32_bf16 v[36:39], v[168:171], v[104:107], v[36:39]
    ds_read_b128 v[232:235], v49 offset:25600
    s_waitcnt vmcnt(5)
    s_waitcnt lgkmcnt(11)
    v_mfma_f32_16x16x32_bf16 v[20:23], v[172:175], v[108:111], v[20:23]
    v_mfma_f32_16x16x32_bf16 v[24:27], v[176:179], v[108:111], v[24:27]
    ds_read_b128 v[236:239], v49 offset:26624
    v_mfma_f32_16x16x32_bf16 v[28:31], v[180:183], v[108:111], v[28:31]
    ds_read_b128 v[240:243], v49 offset:27648
    v_mfma_f32_16x16x32_bf16 v[32:35], v[184:187], v[108:111], v[32:35]
    ds_read_b128 v[244:247], v49 offset:28672
    v_mfma_f32_16x16x32_bf16 v[36:39], v[188:191], v[108:111], v[36:39]
    ds_read_b128 v[248:251], v49 offset:29696
    s_waitcnt vmcnt(4)
    s_waitcnt lgkmcnt(10)
    v_mfma_f32_16x16x32_bf16 v[20:23], v[192:195], v[112:115], v[20:23]
    v_mfma_f32_16x16x32_bf16 v[24:27], v[196:199], v[112:115], v[24:27]
    v_mfma_f32_16x16x32_bf16 v[28:31], v[200:203], v[112:115], v[28:31]
    v_mfma_f32_16x16x32_bf16 v[32:35], v[204:207], v[112:115], v[32:35]
    v_mfma_f32_16x16x32_bf16 v[36:39], v[208:211], v[112:115], v[36:39]
    s_waitcnt vmcnt(2)
    s_waitcnt lgkmcnt(5)
    v_mfma_f32_16x16x32_bf16 v[20:23], v[212:215], v[116:119], v[20:23]
    v_mfma_f32_16x16x32_bf16 v[24:27], v[216:219], v[116:119], v[24:27]
    v_mfma_f32_16x16x32_bf16 v[28:31], v[220:223], v[116:119], v[28:31]
    v_mfma_f32_16x16x32_bf16 v[32:35], v[224:227], v[116:119], v[32:35]
    v_mfma_f32_16x16x32_bf16 v[36:39], v[228:231], v[116:119], v[36:39]
    s_waitcnt vmcnt(0)
    s_waitcnt lgkmcnt(0)
    s_barrier
    v_mfma_f32_16x16x32_bf16 v[20:23], v[232:235], v[120:123], v[20:23]
    v_mfma_f32_16x16x32_bf16 v[24:27], v[236:239], v[120:123], v[24:27]
    v_mfma_f32_16x16x32_bf16 v[28:31], v[240:243], v[120:123], v[28:31]
    v_mfma_f32_16x16x32_bf16 v[32:35], v[244:247], v[120:123], v[32:35]
    v_mfma_f32_16x16x32_bf16 v[36:39], v[248:251], v[120:123], v[36:39]
    s_nop 3
    v_cvt_pk_bf16_f32 v4, v20, v21
    v_cvt_pk_bf16_f32 v5, v22, v23
    v_cvt_pk_bf16_f32 v6, v24, v25
    v_cvt_pk_bf16_f32 v7, v26, v27
    v_cvt_pk_bf16_f32 v8, v28, v29
    v_cvt_pk_bf16_f32 v9, v30, v31
    v_cvt_pk_bf16_f32 v10, v32, v33
    v_cvt_pk_bf16_f32 v11, v34, v35
    v_cvt_pk_bf16_f32 v12, v36, v37
    v_cvt_pk_bf16_f32 v13, v38, v39
    v_mfma_f32_16x16x32_bf16 v[40:43], v[4:7], v[4:7], 0
    v_mfma_f32_16x16x32_bf16 v[44:47], v[16:19], v[4:7], 0
    v_mfma_f32_16x16x32_bf16 v[40:43], v[8:11], v[8:11], v[40:43]
    v_mfma_f32_16x16x32_bf16 v[44:47], v[16:19], v[8:11], v[44:47]
    v_mfma_f32_16x16x16_bf16 v[40:43], v[12:13], v[12:13], v[40:43]
    v_mfma_f32_16x16x16_bf16 v[44:47], v[16:17], v[12:13], v[44:47]
    s_cmp_eq_u32 s68, 0
    s_cbranch_scc1 LOC_30
    buffer_store_dwordx4 v[4:7], v0, s[4:7], s34 offen
    buffer_store_dwordx4 v[8:11], v0, s[4:7], s34 offen offset:1024
    s_mov_b32 exec_hi, 0
    buffer_store_dwordx2 v[12:13], v1, s[4:7], s35 offen
    s_mov_b64 exec, -1
    s_nop 2
    v_cndmask_b32 v40, v40, v41, s[42:43]
    v_cndmask_b32 v42, v42, v43, s[42:43]
    v_cndmask_b32 v45, v40, v42, s[44:45]
    s_mov_b64 exec, s[40:41]
    buffer_store_dwordx2 v[44:45], v48, s[4:7], s36 offen
    s_mov_b64 exec, -1
LOCE_31:
    v_and_b32 v14, 7, v3
    v_lshlrev_b32 v14, 9, v14
    s_add_u32 s33, s26, 1
    s_add_u32 s58, s89, s25
    s_add_u32 s58, s58, 0
    v_and_b32 v124, 15, v3
    v_lshrrev_b32 v125, 4, v3
    s_and_b32 s29, s21, 3
    s_cmp_lg_u32 s29, s17
    s_cbranch_scc1 NOPROD_32
    v_add_u32 v126, 92160, v0
    s_lshr_b32 s28, s20, 2
    s_mul_i32 s28, s28, 18944
    s_mul_i32 s29, s19, 163840
    s_add_u32 s28, s28, s29
    s_add_u32 s28, s28, 131072
    s_and_b32 s29, s20, 3
    s_lshl_b32 s34, s29, 8
    s_add_u32 s34, s34, s28
    s_lshr_b32 s30, s17, 1
    s_lshl_b32 s31, s30, 2
    s_add_u32 s34, s34, s31
    s_and_b32 s31, s17, 1
    s_lshl_b32 s35, s31, 7
    s_add_u32 s34, s34, s35
    s_lshl_b32 s29, s29, 1
    s_add_u32 s29, s29, s30
    s_mul_i32 s29, s29, 2240
    s_add_u32 s28, s28, s29
    s_add_u32 s28, s28, 1024
    s_lshl_b32 s35, s31, 8
    s_add_u32 s35, s35, s28
    s_mul_i32 s36, s31, 608
    s_add_u32 s36, s36, s28
    s_add_u32 s36, s36, 1024
    s_add_u32 s48, s88, s24
    s_add_u32 s48, s48, 0
    s_add_u32 s49, s48, 4096
    s_add_u32 s50, s48, 8192
    s_add_u32 s51, s48, 12288
    s_add_u32 s52, s48, 16384
    v_mov_b32 v254, s33
    v_mov_b32 v255, s33
    s_mov_b64 exec, 0xffff
    s_waitcnt vmcnt(0)
    s_cmp_eq_u32 s68, 0
    s_cbranch_scc1 LOC_35
    buffer_store_dwordx2 v[254:255], v1, s[4:7], s81 offen
LOCE_36:
    s_mov_b64 exec, -1
    buffer_load_dword v15, v14, s[4:7], s83 offen sc1
    ds_read_b128 v[132:135], v126 offset:0
    ds_read_b128 v[136:139], v126 offset:1024
    ds_read_b128 v[140:143], v126 offset:2048
    ds_read_b128 v[144:147], v126 offset:3072
    ds_read_b128 v[148:151], v126 offset:4096
    ds_read_b128 v[152:155], v126 offset:5120
    ds_read_b128 v[156:159], v126 offset:6144
    ds_read_b128 v[160:163], v126 offset:7168
    ds_read_b128 v[164:167], v126 offset:8192
    ds_read_b128 v[168:171], v126 offset:9216
    ds_read_b128 v[172:175], v126 offset:10240
    ds_read_b128 v[176:179], v126 offset:11264
    ds_read_b128 v[180:183], v126 offset:12288
    ds_read_b128 v[184:187], v126 offset:13312
    ds_read_b128 v[188:191], v126 offset:14336
    ds_read_b128 v[192:195], v126 offset:15360
    s_waitcnt vmcnt(0)
    v_subrev_u32 v15, s33, v15
    v_cmp_le_u32 vcc, 16, v15
    s_nop 0
    s_cbranch_vccnz POLLC_38
POLLE_37:
    buffer_load_dwordx2 v[40:41], v1, s[4:7], s58 offen sc1
    buffer_load_dwordx2 v[42:43], v1, s[4:7], s58 offen offset:512 sc1
    buffer_load_dwordx4 v[52:55], v0, s[4:7], s48 offen offset:0 sc1
    buffer_load_dwordx4 v[56:59], v0, s[4:7], s48 offen offset:1024 sc1
    buffer_load_dwordx4 v[60:63], v0, s[4:7], s48 offen offset:2048 sc1
    buffer_load_dwordx4 v[64:67], v0, s[4:7], s48 offen offset:3072 sc1
    buffer_load_dwordx4 v[68:71], v0, s[4:7], s49 offen offset:0 sc1
    buffer_load_dwordx4 v[72:75], v0, s[4:7], s49 offen offset:1024 sc1
    buffer_load_dwordx4 v[76:79], v0, s[4:7], s49 offen offset:2048 sc1
    buffer_load_dwordx4 v[80:83], v0, s[4:7], s49 offen offset:3072 sc1
    buffer_load_dwordx4 v[84:87], v0, s[4:7], s50 offen offset:0 sc1
    buffer_load_dwordx4 v[88:91], v0, s[4:7], s50 offen offset:1024 sc1
    buffer_load_dwordx4 v[92:95], v0, s[4:7], s50 offen offset:2048 sc1
    buffer_load_dwordx4 v[96:99], v0, s[4:7], s50 offen offset:3072 sc1
    buffer_load_dwordx4 v[100:103], v0, s[4:7], s51 offen offset:0 sc1
    buffer_load_dwordx4 v[104:107], v0, s[4:7], s51 offen offset:1024 sc1
    buffer_load_dwordx4 v[108:111], v0, s[4:7], s51 offen offset:2048 sc1
    buffer_load_dwordx4 v[112:115], v0, s[4:7], s51 offen offset:3072 sc1
    buffer_load_dwordx2 v[116:117], v2, s[4:7], s52 offen offset:0 sc1
    buffer_load_dwordx2 v[118:119], v2, s[4:7], s52 offen offset:128 sc1
    buffer_load_dwordx2 v[120:121], v2, s[4:7], s52 offen offset:1024 sc1
    buffer_load_dwordx2 v[122:123], v2, s[4:7], s52 offen offset:1152 sc1
    s_barrier
    ds_read_b128 v[196:199], v126 offset:16384
    ds_read_b128 v[200:203], v126 offset:17408
    ds_read_b128 v[204:207], v126 offset:18432
    ds_read_b128 v[208:211], v126 offset:19456
    ds_read_b128 v[212:215], v126 offset:20480
    ds_read_b128 v[216:219], v126 offset:21504
    ds_read_b128 v[220:223], v126 offset:22528
    ds_read_b128 v[224:227], v126 offset:23552
    ds_read_b128 v[228:231], v126 offset:24576
    ds_read_b128 v[232:235], v126 offset:25600
    ds_read_b128 v[236:239], v126 offset:26624
    ds_read_b128 v[240:243], v126 offset:27648
    ds_read_b128 v[244:247], v126 offset:28672
    ds_read_b128 v[248:251], v126 offset:29696
    v_lshlrev_b32 v127, 4, v125
    v_lshlrev_b32 v128, 2, v124
    s_lshl_b32 s28, s17, 9
    s_add_u32 s28, s28, 161536
    v_add_u32 v129, s28, v128
    v_add_u32 v130, s28, v127
    v_add_u32 v127, 161280, v127
    v_add_u32 v128, 161280, v128
    s_cmp_ge_u32 s21, 4
    s_cbranch_scc1 VPATH_34
    s_waitcnt vmcnt(19)
    s_waitcnt lgkmcnt(15)
    v_mfma_f32_16x16x32_bf16 v[20:23], v[132:135], v[52:55], 0
    ds_read_b128 v[132:135], v126 offset:30720
    v_mfma_f32_16x16x32_bf16 v[24:27], v[136:139], v[52:55], 0
    ds_read_b128 v[136:139], v126 offset:31744
    s_waitcnt vmcnt(18)
    s_waitcnt lgkmcnt(15)
    v_mfma_f32_16x16x32_bf16 v[20:23], v[140:143], v[56:59], v[20:23]
    ds_read_b128 v[140:143], v126 offset:32768
    v_mfma_f32_16x16x32_bf16 v[24:27], v[144:147], v[56:59], v[24:27]
    ds_read_b128 v[144:147], v126 offset:33792
    s_waitcnt vmcnt(17)
    s_waitcnt lgkmcnt(15)
    v_mfma_f32_16x16x32_bf16 v[20:23], v[148:151], v[60:63], v[20:23]
    ds_read_b128 v[148:151], v126 offset:34816
    v_mfma_f32_16x16x32_bf16 v[24:27], v[152:155], v[60:63], v[24:27]
    ds_read_b128 v[152:155], v126 offset:35840
    s_waitcnt vmcnt(16)
    s_waitcnt lgkmcnt(15)
    v_mfma_f32_16x16x32_bf16 v[20:23], v[156:159], v[64:67], v[20:23]
    ds_read_b128 v[28:31], v127
    v_mfma_f32_16x16x32_bf16 v[24:27], v[160:163], v[64:67], v[24:27]
    ds_read_b64 v[32:33], v127 offset:128
    s_waitcnt vmcnt(15)
    s_waitcnt lgkmcnt(15)
    v_mfma_f32_16x16x32_bf16 v[20:23], v[164:167], v[68:71], v[20:23]
    v_lshlrev_b32 v131, 8, v125
    v_mfma_f32_16x16x32_bf16 v[24:27], v[168:171], v[68:71], v[24:27]
    v_lshl_add_u32 v131, v124, 4, v131
    s_waitcnt vmcnt(14)
    s_waitcnt lgkmcnt(15)
    v_mfma_f32_16x16x32_bf16 v[20:23], v[172:175], v[72:75], v[20:23]
    v_add_f32 v40, v40, v42
    v_mfma_f32_16x16x32_bf16 v[24:27], v[176:179], v[72:75], v[24:27]
    v_add_f32 v41, v41, v43
    s_waitcnt vmcnt(13)
    s_waitcnt lgkmcnt(15)
    v_mfma_f32_16x16x32_bf16 v[20:23], v[180:183], v[76:79], v[20:23]
    v_mov_b32 v42, v40
    v_mfma_f32_16x16x32_bf16 v[24:27], v[184:187], v[76:79], v[24:27]
    v_mov_b32 v43, v41
    s_waitcnt vmcnt(12)
    s_waitcnt lgkmcnt(15)
    v_mfma_f32_16x16x32_bf16 v[20:23], v[188:191], v[80:83], v[20:23]
    v_permlane32_swap_b32 v40, v42
    v_mfma_f32_16x16x32_bf16 v[24:27], v[192:195], v[80:83], v[24:27]
    v_permlane32_swap_b32 v41, v43
    s_waitcnt vmcnt(11)
    s_waitcnt lgkmcnt(15)
    v_mfma_f32_16x16x32_bf16 v[20:23], v[196:199], v[84:87], v[20:23]
    v_add_f32 v40, v40, v42
    v_mfma_f32_16x16x32_bf16 v[24:27], v[200:203], v[84:87], v[24:27]
    v_add_f32 v41, v41, v43
    s_waitcnt vmcnt(10)
    s_waitcnt lgkmcnt(15)
    v_mfma_f32_16x16x32_bf16 v[20:23], v[204:207], v[88:91], v[20:23]
    v_mov_b32 v42, v40
    v_mfma_f32_16x16x32_bf16 v[24:27], v[208:211], v[88:91], v[24:27]
    v_mov_b32 v43, v41
    s_waitcnt vmcnt(9)
    s_waitcnt lgkmcnt(15)
    v_mfma_f32_16x16x32_bf16 v[20:23], v[212:215], v[92:95], v[20:23]
    v_permlane16_swap_b32 v40, v42
    v_mfma_f32_16x16x32_bf16 v[24:27], v[216:219], v[92:95], v[24:27]
    v_permlane16_swap_b32 v41, v43
    s_waitcnt vmcnt(8)
    s_waitcnt lgkmcnt(14)
    v_mfma_f32_16x16x32_bf16 v[20:23], v[220:223], v[96:99], v[20:23]
    v_add_f32 v40, v40, v42
    v_mfma_f32_16x16x32_bf16 v[24:27], v[224:227], v[96:99], v[24:27]
    v_add_f32 v41, v41, v43
    s_waitcnt vmcnt(7)
    s_waitcnt lgkmcnt(12)
    v_mfma_f32_16x16x32_bf16 v[20:23], v[228:231], v[100:103], v[20:23]
    v_mul_f32 v42, 0xbae38e39, v40
    v_mfma_f32_16x16x32_bf16 v[24:27], v[232:235], v[100:103], v[24:27]
    v_mul_f32 v41, 0x3ae38e39, v41
    s_waitcnt vmcnt(6)
    s_waitcnt lgkmcnt(10)
    v_mfma_f32_16x16x32_bf16 v[20:23], v[236:239], v[104:107], v[20:23]
    v_fma_f32 v41, -v42, v42, v41
    v_mfma_f32_16x16x32_bf16 v[24:27], v[240:243], v[104:107], v[24:27]
    v_max_f32 v41, 0, v41
    s_waitcnt vmcnt(5)
    s_waitcnt lgkmcnt(8)
    v_mfma_f32_16x16x32_bf16 v[20:23], v[244:247], v[108:111], v[20:23]
    v_add_f32 v41, 0x3727c5ac, v41
    v_mfma_f32_16x16x32_bf16 v[24:27], v[248:251], v[108:111], v[24:27]
    v_rsq_f32 v43, v41
    s_waitcnt vmcnt(4)
    s_waitcnt lgkmcnt(6)
    v_mfma_f32_16x16x32_bf16 v[20:23], v[132:135], v[112:115], v[20:23]
    v_mfma_f32_16x16x32_bf16 v[24:27], v[136:139], v[112:115], v[24:27]
    s_waitcnt vmcnt(2)
    s_waitcnt lgkmcnt(4)
    v_mfma_f32_16x16x32_bf16 v[20:23], v[140:143], v[116:119], v[20:23]
    v_mfma_f32_16x16x32_bf16 v[24:27], v[144:147], v[116:119], v[24:27]
    s_waitcnt vmcnt(0)
    s_waitcnt lgkmcnt(2)
    v_mfma_f32_16x16x32_bf16 v[20:23], v[148:151], v[120:123], v[20:23]
    v_mfma_f32_16x16x32_bf16 v[24:27], v[152:155], v[120:123], v[24:27]
    s_waitcnt lgkmcnt(0)
    s_nop 5
    v_pk_fma_f32 v[20:21], v[28:29], v[42:43], v[20:21] op_sel_hi:[1,0,1]
    v_pk_fma_f32 v[22:23], v[30:31], v[42:43], v[22:23] op_sel_hi:[1,0,1]
    v_pk_fma_f32 v[24:25], v[32:33], v[42:43], v[24:25] op_sel_hi:[1,0,1]
    v_pk_mul_f32 v[20:21], v[20:21], v[42:43] op_sel:[0,1] op_sel_hi:[1,1]
    v_pk_mul_f32 v[22:23], v[22:23], v[42:43] op_sel:[0,1] op_sel_hi:[1,1]
    v_pk_mul_f32 v[24:25], v[24:25], v[42:43] op_sel:[0,1] op_sel_hi:[1,1]
    v_cvt_pk_bf16_f32 v132, v20, v21
    v_cvt_pk_bf16_f32 v133, v22, v23
    v_cvt_pk_bf16_f32 v134, v20, v21
    v_cvt_pk_bf16_f32 v135, v22, v23
    v_cvt_pk_bf16_f32 v136, v24, v25
    v_dot2_f32_bf16 v137, v132, v132, 0
    v_dot2_f32_bf16 v137, v133, v133, v137
    v_permlane16_swap_b32 v132, v134
    v_permlane16_swap_b32 v133, v135
    s_mov_b32 exec_lo, 0xffff
    s_mov_b32 exec_hi, 0xffff
    buffer_store_dwordx4 v[132:135], v131, s[4:7], s35 offen sc1
    s_mov_b32 exec_hi, 0
    buffer_store_dword v136, v1, s[4:7], s34 offen sc1
    s_mov_b64 exec, -1
    v_dot2_f32_bf16 v137, v136, v136, v137
    s_nop 2
    v_mov_b32 v138, v137
    s_nop 1
    v_permlane32_swap_b32 v137, v138
    v_add_f32 v137, v137, v138
    v_mov_b32 v138, v137
    s_nop 1
    v_permlane16_swap_b32 v137, v138
    v_add_f32 v137, v137, v138
    s_nop 1
    v_max_f32_dpp v137, v137, v137 row_ror:8 row_mask:0xf bank_mask:0xf
    s_nop 1
    v_max_f32_dpp v137, v137, v137 row_ror:4 row_mask:0xf bank_mask:0xf
    s_nop 1
    v_max_f32_dpp v137, v137, v137 row_ror:2 row_mask:0xf bank_mask:0xf
    s_nop 1
    v_max_f32_dpp v137, v137, v137 row_ror:1 row_mask:0xf bank_mask:0xf
    s_branch JOIN_33
VPATH_34:
    s_waitcnt vmcnt(19)
    s_waitcnt lgkmcnt(15)
    v_mfma_f32_16x16x32_bf16 v[20:23], v[52:55], v[132:135], 0
    ds_read_b128 v[132:135], v126 offset:30720
    v_mfma_f32_16x16x32_bf16 v[24:27], v[52:55], v[136:139], 0
    ds_read_b128 v[136:139], v126 offset:31744
    s_waitcnt vmcnt(18)
    s_waitcnt lgkmcnt(15)
    v_mfma_f32_16x16x32_bf16 v[20:23], v[56:59], v[140:143], v[20:23]
    ds_read_b128 v[140:143], v126 offset:32768
    v_mfma_f32_16x16x32_bf16 v[24:27], v[56:59], v[144:147], v[24:27]
    ds_read_b128 v[144:147], v126 offset:33792
    s_waitcnt vmcnt(17)
    s_waitcnt lgkmcnt(15)
    v_mfma_f32_16x16x32_bf16 v[20:23], v[60:63], v[148:151], v[20:23]
    ds_read_b128 v[148:151], v126 offset:34816
    v_mfma_f32_16x16x32_bf16 v[24:27], v[60:63], v[152:155], v[24:27]
    ds_read_b128 v[152:155], v126 offset:35840
    s_waitcnt vmcnt(16)
    s_waitcnt lgkmcnt(15)
    v_mfma_f32_16x16x32_bf16 v[20:23], v[64:67], v[156:159], v[20:23]
    ds_read2_b32 v[28:29], v128 offset0:16 offset1:32
    v_mfma_f32_16x16x32_bf16 v[24:27], v[64:67], v[160:163], v[24:27]
    v_mul_u32_u24 v131, 304, v125
    s_waitcnt vmcnt(15)
    s_waitcnt lgkmcnt(15)
    v_mfma_f32_16x16x32_bf16 v[20:23], v[68:71], v[164:167], v[20:23]
    v_lshl_add_u32 v131, v124, 4, v131
    v_mfma_f32_16x16x32_bf16 v[24:27], v[68:71], v[168:171], v[24:27]
    v_add_f32 v40, v40, v42
    s_waitcnt vmcnt(14)
    s_waitcnt lgkmcnt(15)
    v_mfma_f32_16x16x32_bf16 v[20:23], v[72:75], v[172:175], v[20:23]
    v_add_f32 v41, v41, v43
    v_mfma_f32_16x16x32_bf16 v[24:27], v[72:75], v[176:179], v[24:27]
    v_mov_b32 v42, v40
    s_waitcnt vmcnt(13)
    s_waitcnt lgkmcnt(15)
    v_mfma_f32_16x16x32_bf16 v[20:23], v[76:79], v[180:183], v[20:23]
    v_mov_b32 v43, v41
    v_mfma_f32_16x16x32_bf16 v[24:27], v[76:79], v[184:187], v[24:27]
    v_permlane32_swap_b32 v40, v42
    s_waitcnt vmcnt(12)
    s_waitcnt lgkmcnt(15)
    v_mfma_f32_16x16x32_bf16 v[20:23], v[80:83], v[188:191], v[20:23]
    v_permlane32_swap_b32 v41, v43
    v_mfma_f32_16x16x32_bf16 v[24:27], v[80:83], v[192:195], v[24:27]
    v_add_f32 v40, v40, v42
    s_waitcnt vmcnt(11)
    s_waitcnt lgkmcnt(15)
    v_mfma_f32_16x16x32_bf16 v[20:23], v[84:87], v[196:199], v[20:23]
    v_add_f32 v41, v41, v43
    v_mfma_f32_16x16x32_bf16 v[24:27], v[84:87], v[200:203], v[24:27]
    v_mov_b32 v42, v40
    s_waitcnt vmcnt(10)
    s_waitcnt lgkmcnt(15)
    v_mfma_f32_16x16x32_bf16 v[20:23], v[88:91], v[204:207], v[20:23]
    v_mov_b32 v43, v41
    v_mfma_f32_16x16x32_bf16 v[24:27], v[88:91], v[208:211], v[24:27]
    v_permlane16_swap_b32 v40, v42
    s_waitcnt vmcnt(9)
    s_waitcnt lgkmcnt(15)
    v_mfma_f32_16x16x32_bf16 v[20:23], v[92:95], v[212:215], v[20:23]
    v_permlane16_swap_b32 v41, v43
    v_mfma_f32_16x16x32_bf16 v[24:27], v[92:95], v[216:219], v[24:27]
    v_add_f32 v40, v40, v42
    s_waitcnt vmcnt(8)
    s_waitcnt lgkmcnt(13)
    v_mfma_f32_16x16x32_bf16 v[20:23], v[96:99], v[220:223], v[20:23]
    v_add_f32 v41, v41, v43
    v_mfma_f32_16x16x32_bf16 v[24:27], v[96:99], v[224:227], v[24:27]
    v_mul_f32 v42, 0xbae38e39, v40
    s_waitcnt vmcnt(7)
    s_waitcnt lgkmcnt(11)
    v_mfma_f32_16x16x32_bf16 v[20:23], v[100:103], v[228:231], v[20:23]
    v_mul_f32 v41, 0x3ae38e39, v41
    v_mfma_f32_16x16x32_bf16 v[24:27], v[100:103], v[232:235], v[24:27]
    v_fma_f32 v41, -v42, v42, v41
    s_waitcnt vmcnt(6)
    s_waitcnt lgkmcnt(9)
    v_mfma_f32_16x16x32_bf16 v[20:23], v[104:107], v[236:239], v[20:23]
    v_max_f32 v41, 0, v41
    v_mfma_f32_16x16x32_bf16 v[24:27], v[104:107], v[240:243], v[24:27]
    v_add_f32 v41, 0x3727c5ac, v41
    s_waitcnt vmcnt(5)
    s_waitcnt lgkmcnt(7)
    v_mfma_f32_16x16x32_bf16 v[20:23], v[108:111], v[244:247], v[20:23]
    v_rsq_f32 v43, v41
    v_mfma_f32_16x16x32_bf16 v[24:27], v[108:111], v[248:251], v[24:27]
    ds_write_b32 v129, v42
    s_waitcnt vmcnt(4)
    s_waitcnt lgkmcnt(6)
    v_mfma_f32_16x16x32_bf16 v[20:23], v[112:115], v[132:135], v[20:23]
    ds_write_b32 v129, v43 offset:64
    v_mfma_f32_16x16x32_bf16 v[24:27], v[112:115], v[136:139], v[24:27]
    ds_read_b128 v[44:47], v130
    s_waitcnt vmcnt(2)
    s_waitcnt lgkmcnt(6)
    v_mfma_f32_16x16x32_bf16 v[20:23], v[116:119], v[140:143], v[20:23]
    ds_read_b128 v[48:51], v130 offset:64
    v_mfma_f32_16x16x32_bf16 v[24:27], v[116:119], v[144:147], v[24:27]
    s_waitcnt vmcnt(0)
    s_waitcnt lgkmcnt(5)
    v_mfma_f32_16x16x32_bf16 v[20:23], v[120:123], v[148:151], v[20:23]
    v_mfma_f32_16x16x32_bf16 v[24:27], v[120:123], v[152:155], v[24:27]
    s_waitcnt lgkmcnt(0)
    s_nop 5
    v_pk_fma_f32 v[20:21], v[44:45], v[28:29], v[20:21] op_sel:[0,0,0] op_sel_hi:[1,0,1]
    v_pk_fma_f32 v[22:23], v[46:47], v[28:29], v[22:23] op_sel:[0,0,0] op_sel_hi:[1,0,1]
    v_pk_fma_f32 v[24:25], v[44:45], v[28:29], v[24:25] op_sel:[0,1,0] op_sel_hi:[1,1,1]
    v_pk_fma_f32 v[26:27], v[46:47], v[28:29], v[26:27] op_sel:[0,1,0] op_sel_hi:[1,1,1]
    v_pk_mul_f32 v[20:21], v[20:21], v[48:49]
    v_pk_mul_f32 v[22:23], v[22:23], v[50:51]
    v_pk_mul_f32 v[24:25], v[24:25], v[48:49]
    v_pk_mul_f32 v[26:27], v[26:27], v[50:51]
    v_cvt_pk_bf16_f32 v140, v20, v21
    v_cvt_pk_bf16_f32 v141, v22, v23
    v_cvt_pk_bf16_f32 v142, v20, v21
    v_cvt_pk_bf16_f32 v143, v22, v23
    v_cvt_pk_bf16_f32 v144, v24, v25
    v_cvt_pk_bf16_f32 v145, v26, v27
    v_cvt_pk_bf16_f32 v146, v24, v25
    v_cvt_pk_bf16_f32 v147, v26, v27
    v_permlane32_swap_b32 v140, v142
    v_permlane32_swap_b32 v141, v143
    v_permlane32_swap_b32 v144, v146
    v_permlane32_swap_b32 v145, v147
    s_mov_b32 exec_hi, 0
    buffer_store_dwordx4 v[140:143], v131, s[4:7], s36 offen sc1
    s_mov_b32 exec_lo, 0x000c000c
    buffer_store_dwordx4 v[144:147], v131, s[4:7], s36 offen offset:224 sc1
    s_mov_b64 exec, -1
    v_mov_b32 v137, 0
    s_branch JOIN_33
NOPROD_32:
    s_add_u32 s48, s88, s24
    s_add_u32 s48, s48, 0
    s_add_u32 s49, s48, 4096
    s_add_u32 s50, s48, 8192
    s_add_u32 s51, s48, 12288
    s_add_u32 s52, s48, 16384
    v_mov_b32 v254, s33
    v_mov_b32 v255, s33
    s_mov_b64 exec, 0xffff
    s_waitcnt vmcnt(0)
    s_cmp_eq_u32 s68, 0
    s_cbranch_scc1 LOC_39
    buffer_store_dwordx2 v[254:255], v1, s[4:7], s81 offen
LOCE_40:
    s_mov_b64 exec, -1
    s_mov_b32 s70, 0
POLL_41:
    buffer_load_dword v15, v14, s[4:7], s83 offen sc1
    s_waitcnt vmcnt(0)
    v_subrev_u32 v15, s33, v15
    v_cmp_le_u32 vcc, 16, v15
    s_add_u32 s70, s70, 1
    s_cmp_gt_u32 s70, 200000
    s_cbranch_scc1 POLLD_42
    s_cbranch_vccnz POLL_41
POLLD_42:
    s_barrier
    buffer_load_dwordx2 v[40:41], v1, s[4:7], s58 offen sc1
    buffer_load_dwordx2 v[42:43], v1, s[4:7], s58 offen offset:512 sc1
    buffer_load_dwordx4 v[52:55], v0, s[4:7], s48 offen offset:0 sc1
    buffer_load_dwordx4 v[56:59], v0, s[4:7], s48 offen offset:1024 sc1
    buffer_load_dwordx4 v[60:63], v0, s[4:7], s48 offen offset:2048 sc1
    buffer_load_dwordx4 v[64:67], v0, s[4:7], s48 offen offset:3072 sc1
    buffer_load_dwordx4 v[68:71], v0, s[4:7], s49 offen offset:0 sc1
    buffer_load_dwordx4 v[72:75], v0, s[4:7], s49 offen offset:1024 sc1
    buffer_load_dwordx4 v[76:79], v0, s[4:7], s49 offen offset:2048 sc1
    buffer_load_dwordx4 v[80:83], v0, s[4:7], s49 offen offset:3072 sc1
    buffer_load_dwordx4 v[84:87], v0, s[4:7], s50 offen offset:0 sc1
    buffer_load_dwordx4 v[88:91], v0, s[4:7], s50 offen offset:1024 sc1
    buffer_load_dwordx4 v[92:95], v0, s[4:7], s50 offen offset:2048 sc1
    buffer_load_dwordx4 v[96:99], v0, s[4:7], s50 offen offset:3072 sc1
    buffer_load_dwordx4 v[100:103], v0, s[4:7], s51 offen offset:0 sc1
    buffer_load_dwordx4 v[104:107], v0, s[4:7], s51 offen offset:1024 sc1
    buffer_load_dwordx4 v[108:111], v0, s[4:7], s51 offen offset:2048 sc1
    buffer_load_dwordx4 v[112:115], v0, s[4:7], s51 offen offset:3072 sc1
    buffer_load_dwordx2 v[116:117], v2, s[4:7], s52 offen offset:0 sc1
    buffer_load_dwordx2 v[118:119], v2, s[4:7], s52 offen offset:128 sc1
    buffer_load_dwordx2 v[120:121], v2, s[4:7], s52 offen offset:1024 sc1
    buffer_load_dwordx2 v[122:123], v2, s[4:7], s52 offen offset:1152 sc1
    s_waitcnt vmcnt(20)
    v_add_f32 v40, v40, v42
    v_add_f32 v41, v41, v43
    v_mov_b32 v42, v40
    v_mov_b32 v43, v41
    s_nop 0
    v_permlane32_swap_b32 v40, v42
    v_permlane32_swap_b32 v41, v43
    v_add_f32 v40, v40, v42
    v_add_f32 v41, v41, v43
    v_mov_b32 v42, v40
    v_mov_b32 v43, v41
    s_nop 0
    v_permlane16_swap_b32 v40, v42
    v_permlane16_swap_b32 v41, v43
    v_add_f32 v40, v40, v42
    v_add_f32 v41, v41, v43
    v_mul_f32 v42, 0xbae38e39, v40
    v_mul_f32 v41, 0x3ae38e39, v41
    v_fma_f32 v41, -v42, v42, v41
    v_max_f32 v41, 0, v41
    v_add_f32 v41, 0x3727c5ac, v41
    v_rsq_f32 v43, v41
JOIN_33:
    ds_read_b128 v[152:155], v0 offset:0
    ds_read_b128 v[156:159], v0 offset:1024
    ds_read_b128 v[160:163], v0 offset:2048
    ds_read_b128 v[164:167], v0 offset:3072
    ds_read_b128 v[168:171], v0 offset:4096
    ds_read_b128 v[172:175], v0 offset:5120
    ds_read_b128 v[176:179], v0 offset:6144
    ds_read_b128 v[180:183], v0 offset:7168
    ds_read_b128 v[184:187], v0 offset:8192
    ds_read_b128 v[188:191], v0 offset:9216
    ds_read_b128 v[192:195], v0 offset:10240
    ds_read_b128 v[196:199], v0 offset:11264
    ds_read_b128 v[200:203], v0 offset:12288
    ds_read_b128 v[204:207], v0 offset:13312
    ds_read_b128 v[208:211], v0 offset:14336
    ds_read_b128 v[212:215], v0 offset:15360
    ds_read_b128 v[216:219], v0 offset:16384
    ds_read_b128 v[220:223], v0 offset:17408
    ds_read_b128 v[224:227], v0 offset:18432
    ds_read_b128 v[228:231], v0 offset:19456
    ds_read_b128 v[232:235], v0 offset:20480
    ds_read_b128 v[236:239], v0 offset:21504
    ds_read_b128 v[240:243], v0 offset:22528
    ds_read_b128 v[244:247], v0 offset:23552
    v_add_u32 v126, 61440, v0
    v_lshlrev_b32 v127, 4, v125
    v_add_u32 v127, 160960, v127
    s_add_u32 s28, s18, 1
    v_mov_b32 v138, s28
    v_mov_b32 v139, v137
    s_lshl_b32 s34, s19, 15
    s_lshl_b32 s35, s16, 7
    s_add_u32 s34, s34, s35
    s_add_u32 s34, s34, 25296896
    s_and_b32 s35, s21, 3
    s_waitcnt vmcnt(19)
    s_waitcnt lgkmcnt(15)
    v_mfma_f32_16x16x32_bf16 v[20:23], v[152:155], v[52:55], 0
    v_mov_b32 v148, 163632
    ds_read_b128 v[248:251], v0 offset:24576
    v_mfma_f32_16x16x32_bf16 v[24:27], v[156:159], v[52:55], 0
    v_mov_b32 v149, 1
    ds_read_b128 v[152:155], v0 offset:25600
    v_mfma_f32_16x16x32_bf16 v[28:31], v[160:163], v[52:55], 0
    v_and_b32 v150, 31, v3
    ds_read_b128 v[156:159], v0 offset:26624
    v_mfma_f32_16x16x32_bf16 v[32:35], v[164:167], v[52:55], 0
    v_lshrrev_b32 v151, 5, v3
    ds_read_b128 v[160:163], v0 offset:27648
    v_mfma_f32_16x16x32_bf16 v[36:39], v[168:171], v[52:55], 0
    v_mul_u32_u24 v151, 304, v151
    ds_read_b128 v[164:167], v0 offset:28672
    s_waitcnt vmcnt(18)
    s_waitcnt lgkmcnt(15)
    v_mfma_f32_16x16x32_bf16 v[20:23], v[172:175], v[56:59], v[20:23]
    v_lshl_add_u32 v151, v150, 4, v151
    ds_read_b128 v[168:171], v0 offset:29696
    v_mfma_f32_16x16x32_bf16 v[24:27], v[176:179], v[56:59], v[24:27]
    v_add_u32 v151, 132608, v151
    ds_read_b128 v[172:175], v0 offset:30720
    v_mfma_f32_16x16x32_bf16 v[28:31], v[180:183], v[56:59], v[28:31]
    v_cmp_lt_u32 s[62:63], 18, v150
    ds_read_b128 v[176:179], v0 offset:31744
    v_mfma_f32_16x16x32_bf16 v[32:35], v[184:187], v[56:59], v[32:35]
    v_mov_b32 v150, 0x400000
    ds_read_b128 v[180:183], v0 offset:32768
    v_mfma_f32_16x16x32_bf16 v[36:39], v[188:191], v[56:59], v[36:39]
    s_add_u32 s32, s88, s24
    ds_read_b128 v[184:187], v0 offset:33792
    s_waitcnt vmcnt(17)
    s_waitcnt lgkmcnt(15)
    v_mfma_f32_16x16x32_bf16 v[20:23], v[192:195], v[60:63], v[20:23]
    s_add_u32 s32, s32, 2359296
    ds_read_b128 v[188:191], v0 offset:34816
    v_mfma_f32_16x16x32_bf16 v[24:27], v[196:199], v[60:63], v[24:27]
    v_cndmask_b32 v44, v151, v150, s[62:63]
    ds_read_b128 v[192:195], v0 offset:35840
    v_mfma_f32_16x16x32_bf16 v[28:31], v[200:203], v[60:63], v[28:31]
    s_lshl_b32 s33, s21, 8
    ds_read_b128 v[196:199], v0 offset:36864
    v_mfma_f32_16x16x32_bf16 v[32:35], v[204:207], v[60:63], v[32:35]
    s_add_u32 s33, s33, s32
    ds_read_b128 v[200:203], v0 offset:37888
    v_mfma_f32_16x16x32_bf16 v[36:39], v[208:211], v[60:63], v[36:39]
    s_add_u32 s33, s33, 16384
    ds_read_b128 v[204:207], v0 offset:38912
    s_waitcnt vmcnt(16)
    s_waitcnt lgkmcnt(15)
    v_mfma_f32_16x16x32_bf16 v[20:23], v[212:215], v[64:67], v[20:23]
    s_lshl_b32 s36, s21, 11
    ds_read_b128 v[208:211], v0 offset:39936
    v_mfma_f32_16x16x32_bf16 v[24:27], v[216:219], v[64:67], v[24:27]
    s_add_u32 s32, s32, s36
    ds_read_b128 v[212:215], v0 offset:40960
    v_mfma_f32_16x16x32_bf16 v[28:31], v[220:223], v[64:67], v[28:31]
    s_lshl_b32 s37, s19, 1
    ds_read_b128 v[216:219], v0 offset:41984
    v_mfma_f32_16x16x32_bf16 v[32:35], v[224:227], v[64:67], v[32:35]
    s_add_u32 s37, s37, 2
    ds_read_b128 v[220:223], v0 offset:43008
    v_mfma_f32_16x16x32_bf16 v[36:39], v[228:231], v[64:67], v[36:39]
    s_lshl_b32 s71, s19, 2
    ds_read_b128 v[224:227], v0 offset:44032
    s_cmp_eq_u32 s35, s17
    s_cbranch_scc1 KVSIG_43
KVRET_44:
    s_waitcnt vmcnt(15)
    s_waitcnt lgkmcnt(15)
    v_mfma_f32_16x16x32_bf16 v[20:23], v[232:235], v[68:71], v[20:23]
    s_add_u32 s71, s71, 8
    ds_read_b128 v[228:231], v0 offset:45056
    v_mfma_f32_16x16x32_bf16 v[24:27], v[236:239], v[68:71], v[24:27]
    v_mov_b32 v128, 0
    ds_read_b128 v[232:235], v0 offset:46080
    v_mfma_f32_16x16x32_bf16 v[28:31], v[240:243], v[68:71], v[28:31]
    v_mov_b32 v129, 0
    ds_read_b128 v[236:239], v0 offset:47104
    v_mfma_f32_16x16x32_bf16 v[32:35], v[244:247], v[68:71], v[32:35]
    v_mov_b32 v130, 0
    ds_read_b128 v[240:243], v0 offset:48128
    v_mfma_f32_16x16x32_bf16 v[36:39], v[248:251], v[68:71], v[36:39]
    v_mov_b32 v131, 0
    ds_read_b128 v[244:247], v0 offset:49152
    s_waitcnt vmcnt(14)
    s_waitcnt lgkmcnt(15)
    v_mfma_f32_16x16x32_bf16 v[20:23], v[152:155], v[72:75], v[20:23]
    v_mov_b32 v45, 163632
    ds_read_b128 v[248:251], v0 offset:50176
    v_mfma_f32_16x16x32_bf16 v[24:27], v[156:159], v[72:75], v[24:27]
    v_mov_b32 v46, 163584
    ds_read_b128 v[152:155], v0 offset:51200
    v_mfma_f32_16x16x32_bf16 v[28:31], v[160:163], v[72:75], v[28:31]
    ds_read_b128 v[156:159], v0 offset:52224
    v_mfma_f32_16x16x32_bf16 v[32:35], v[164:167], v[72:75], v[32:35]
    ds_read_b128 v[160:163], v0 offset:53248
    v_mfma_f32_16x16x32_bf16 v[36:39], v[168:171], v[72:75], v[36:39]
    ds_read_b128 v[164:167], v0 offset:54272
    s_waitcnt vmcnt(13)
    s_waitcnt lgkmcnt(15)
    v_mfma_f32_16x16x32_bf16 v[20:23], v[172:175], v[76:79], v[20:23]
    ds_read_b128 v[168:171], v0 offset:55296
    v_mfma_f32_16x16x32_bf16 v[24:27], v[176:179], v[76:79], v[24:27]
    ds_read_b128 v[172:175], v0 offset:56320
    v_mfma_f32_16x16x32_bf16 v[28:31], v[180:183], v[76:79], v[28:31]
    ds_read_b128 v[176:179], v0 offset:57344
    v_mfma_f32_16x16x32_bf16 v[32:35], v[184:187], v[76:79], v[32:35]
    ds_read_b128 v[180:183], v0 offset:58368
    v_mfma_f32_16x16x32_bf16 v[36:39], v[188:191], v[76:79], v[36:39]
    ds_read_b128 v[184:187], v0 offset:59392
    s_waitcnt vmcnt(12)
    s_waitcnt lgkmcnt(15)
    v_mfma_f32_16x16x32_bf16 v[20:23], v[192:195], v[80:83], v[20:23]
    ds_read_b128 v[188:191], v0 offset:60416
    v_mfma_f32_16x16x32_bf16 v[24:27], v[196:199], v[80:83], v[24:27]
    ds_read_b128 v[192:195], v126 offset:0
    v_mfma_f32_16x16x32_bf16 v[28:31], v[200:203], v[80:83], v[28:31]
    ds_read_b128 v[196:199], v126 offset:1024
    v_mfma_f32_16x16x32_bf16 v[32:35], v[204:207], v[80:83], v[32:35]
    ds_read_b128 v[200:203], v126 offset:2048
    v_mfma_f32_16x16x32_bf16 v[36:39], v[208:211], v[80:83], v[36:39]
    ds_read_b128 v[204:207], v126 offset:3072
    s_waitcnt vmcnt(11)
    s_waitcnt lgkmcnt(15)
    v_mfma_f32_16x16x32_bf16 v[20:23], v[212:215], v[84:87], v[20:23]
    ds_read_b128 v[208:211], v126 offset:4096
    v_mfma_f32_16x16x32_bf16 v[24:27], v[216:219], v[84:87], v[24:27]
    ds_read_b128 v[212:215], v126 offset:5120
    v_mfma_f32_16x16x32_bf16 v[28:31], v[220:223], v[84:87], v[28:31]
    ds_read_b128 v[216:219], v126 offset:6144
    v_mfma_f32_16x16x32_bf16 v[32:35], v[224:227], v[84:87], v[32:35]
    ds_read_b128 v[220:223], v126 offset:7168
    v_mfma_f32_16x16x32_bf16 v[36:39], v[228:231], v[84:87], v[36:39]
    ds_read_b128 v[224:227], v126 offset:8192
    s_waitcnt vmcnt(10)
    s_waitcnt lgkmcnt(15)
    v_mfma_f32_16x16x32_bf16 v[20:23], v[232:235], v[88:91], v[20:23]
    v_mov_b32 v84, 0
    ds_read_b128 v[228:231], v126 offset:9216
    v_mfma_f32_16x16x32_bf16 v[24:27], v[236:239], v[88:91], v[24:27]
    v_mov_b32 v85, 0
    ds_read_b128 v[232:235], v126 offset:10240
    v_mfma_f32_16x16x32_bf16 v[28:31], v[240:243], v[88:91], v[28:31]
    v_mov_b32 v86, 0
    ds_read_b128 v[236:239], v126 offset:11264
    v_mfma_f32_16x16x32_bf16 v[32:35], v[244:247], v[88:91], v[32:35]
    v_mov_b32 v87, 0
    ds_read_b128 v[240:243], v126 offset:12288
    v_mfma_f32_16x16x32_bf16 v[36:39], v[248:251], v[88:91], v[36:39]
    ds_read_b128 v[244:247], v126 offset:13312
    s_waitcnt vmcnt(9)
    s_waitcnt lgkmcnt(15)
    v_mfma_f32_16x16x32_bf16 v[20:23], v[152:155], v[92:95], v[20:23]
    v_mov_b32 v88, 0
    ds_read_b128 v[248:251], v126 offset:14336
    v_mfma_f32_16x16x32_bf16 v[24:27], v[156:159], v[92:95], v[24:27]
    v_mov_b32 v89, 0
    ds_read_b128 v[152:155], v126 offset:15360
    v_mfma_f32_16x16x32_bf16 v[28:31], v[160:163], v[92:95], v[28:31]
    v_mov_b32 v90, 0
    ds_read_b128 v[156:159], v126 offset:16384
    v_mfma_f32_16x16x32_bf16 v[32:35], v[164:167], v[92:95], v[32:35]
    v_mov_b32 v91, 0
    ds_read_b128 v[160:163], v126 offset:17408
    v_mfma_f32_16x16x32_bf16 v[36:39], v[168:171], v[92:95], v[36:39]
    ds_read_b128 v[164:167], v126 offset:18432
    s_waitcnt vmcnt(8)
    s_waitcnt lgkmcnt(15)
    v_mfma_f32_16x16x32_bf16 v[20:23], v[172:175], v[96:99], v[20:23]
    v_mov_b32 v92, 0
    ds_read_b128 v[168:171], v126 offset:19456
    v_mfma_f32_16x16x32_bf16 v[24:27], v[176:179], v[96:99], v[24:27]
    v_mov_b32 v93, 0
    ds_read_b128 v[172:175], v126 offset:20480
    v_mfma_f32_16x16x32_bf16 v[28:31], v[180:183], v[96:99], v[28:31]
    v_mov_b32 v94, 0
    ds_read_b128 v[176:179], v126 offset:21504
    v_mfma_f32_16x16x32_bf16 v[32:35], v[184:187], v[96:99], v[32:35]
    v_mov_b32 v95, 0
    ds_read_b128 v[180:183], v126 offset:22528
    v_mfma_f32_16x16x32_bf16 v[36:39], v[188:191], v[96:99], v[36:39]
    ds_read_b128 v[184:187], v126 offset:23552
    s_waitcnt vmcnt(7)
    s_waitcnt lgkmcnt(15)
    v_mfma_f32_16x16x32_bf16 v[20:23], v[192:195], v[100:103], v[20:23]
    v_mov_b32 v96, 0
    ds_read_b128 v[188:191], v126 offset:24576
    v_mfma_f32_16x16x32_bf16 v[24:27], v[196:199], v[100:103], v[24:27]
    v_mov_b32 v97, 0
    ds_read_b128 v[192:195], v126 offset:25600
    v_mfma_f32_16x16x32_bf16 v[28:31], v[200:203], v[100:103], v[28:31]
    v_mov_b32 v98, 0
    ds_read_b128 v[196:199], v126 offset:26624
    v_mfma_f32_16x16x32_bf16 v[32:35], v[204:207], v[100:103], v[32:35]
    v_mov_b32 v99, 0
    ds_read_b128 v[200:203], v126 offset:27648
    v_mfma_f32_16x16x32_bf16 v[36:39], v[208:211], v[100:103], v[36:39]
    ds_read_b128 v[204:207], v126 offset:28672
    s_waitcnt vmcnt(6)
    s_waitcnt lgkmcnt(15)
    v_mfma_f32_16x16x32_bf16 v[20:23], v[212:215], v[104:107], v[20:23]
    v_mov_b32 v100, 0
    ds_read_b128 v[208:211], v126 offset:29696
    v_mfma_f32_16x16x32_bf16 v[24:27], v[216:219], v[104:107], v[24:27]
    v_mov_b32 v101, 0
    ds_read_b128 v[52:55], v127 offset:0
    v_mfma_f32_16x16x32_bf16 v[28:31], v[220:223], v[104:107], v[28:31]
    v_mov_b32 v102, 0
    ds_read_b128 v[56:59], v127 offset:64
    v_mfma_f32_16x16x32_bf16 v[32:35], v[224:227], v[104:107], v[32:35]
    v_mov_b32 v103, 0
    ds_read_b128 v[60:63], v127 offset:128
    v_mfma_f32_16x16x32_bf16 v[36:39], v[228:231], v[104:107], v[36:39]
    ds_read_b128 v[64:67], v127 offset:192
    s_waitcnt vmcnt(5)
    s_waitcnt lgkmcnt(15)
    v_mfma_f32_16x16x32_bf16 v[20:23], v[232:235], v[108:111], v[20:23]
    v_mov_b32 v104, 0
    ds_read_b128 v[68:71], v127 offset:256
    v_mfma_f32_16x16x32_bf16 v[24:27], v[236:239], v[108:111], v[24:27]
    v_mov_b32 v105, 0
    v_mfma_f32_16x16x32_bf16 v[28:31], v[240:243], v[108:111], v[28:31]
    v_mov_b32 v106, 0
    v_mfma_f32_16x16x32_bf16 v[32:35], v[244:247], v[108:111], v[32:35]
    v_mov_b32 v107, 0
    v_mfma_f32_16x16x32_bf16 v[36:39], v[248:251], v[108:111], v[36:39]
    s_waitcnt vmcnt(4)
    s_waitcnt lgkmcnt(15)
    v_mfma_f32_16x16x32_bf16 v[20:23], v[152:155], v[112:115], v[20:23]
    v_mov_b32 v108, 0
    v_mfma_f32_16x16x32_bf16 v[24:27], v[156:159], v[112:115], v[24:27]
    v_mov_b32 v109, 0
    v_mfma_f32_16x16x32_bf16 v[28:31], v[160:163], v[112:115], v[28:31]
    v_mov_b32 v110, 0
    v_mfma_f32_16x16x32_bf16 v[32:35], v[164:167], v[112:115], v[32:35]
    v_mov_b32 v111, 0
    v_mfma_f32_16x16x32_bf16 v[36:39], v[168:171], v[112:115], v[36:39]
    s_waitcnt vmcnt(2)
    s_waitcnt lgkmcnt(10)
    v_mfma_f32_16x16x32_bf16 v[20:23], v[172:175], v[116:119], v[20:23]
    v_mov_b32 v112, 0
    v_mfma_f32_16x16x32_bf16 v[24:27], v[176:179], v[116:119], v[24:27]
    v_mov_b32 v113, 0
    v_mfma_f32_16x16x32_bf16 v[28:31], v[180:183], v[116:119], v[28:31]
    v_mov_b32 v114, 0
    v_mfma_f32_16x16x32_bf16 v[32:35], v[184:187], v[116:119], v[32:35]
    v_mov_b32 v115, 0
    v_mfma_f32_16x16x32_bf16 v[36:39], v[188:191], v[116:119], v[36:39]
    s_waitcnt vmcnt(0)
    s_waitcnt lgkmcnt(5)
    v_mfma_f32_16x16x32_bf16 v[20:23], v[192:195], v[120:123], v[20:23]
    v_mfma_f32_16x16x32_bf16 v[24:27], v[196:199], v[120:123], v[24:27]
    v_mfma_f32_16x16x32_bf16 v[28:31], v[200:203], v[120:123], v[28:31]
    v_mfma_f32_16x16x32_bf16 v[32:35], v[204:207], v[120:123], v[32:35]
    v_mfma_f32_16x16x32_bf16 v[36:39], v[208:211], v[120:123], v[36:39]
    v_mul_f32 v43, 0x3eae1a93, v43
    v_mov_b32 v141, 0
    v_mov_b32 v142, 0
    v_mov_b32 v144, 0
    v_mov_b32 v145, 0
    v_mov_b32 v146, 0
    v_mov_b32 v149, 0
    v_mov_b32 v150, 0
    v_mov_b32 v152, 0
    v_mov_b32 v153, 0
    v_mov_b32 v154, 0
    s_waitcnt lgkmcnt(0)
    v_pk_fma_f32 v[36:37], v[68:69], v[42:43], v[36:37] op_sel_hi:[1,0,1]
    v_pk_fma_f32 v[38:39], v[70:71], v[42:43], v[38:39] op_sel_hi:[1,0,1]
    v_pk_fma_f32 v[20:21], v[52:53], v[42:43], v[20:21] op_sel_hi:[1,0,1]
    v_pk_fma_f32 v[22:23], v[54:55], v[42:43], v[22:23] op_sel_hi:[1,0,1]
    v_pk_fma_f32 v[24:25], v[56:57], v[42:43], v[24:25] op_sel_hi:[1,0,1]
    v_pk_fma_f32 v[26:27], v[58:59], v[42:43], v[26:27] op_sel_hi:[1,0,1]
    v_pk_fma_f32 v[28:29], v[60:61], v[42:43], v[28:29] op_sel_hi:[1,0,1]
    v_pk_fma_f32 v[30:31], v[62:63], v[42:43], v[30:31] op_sel_hi:[1,0,1]
    v_pk_fma_f32 v[32:33], v[64:65], v[42:43], v[32:33] op_sel_hi:[1,0,1]
    v_pk_fma_f32 v[34:35], v[66:67], v[42:43], v[34:35] op_sel_hi:[1,0,1]
    v_pk_mul_f32 v[36:37], v[36:37], v[42:43] op_sel:[0,1] op_sel_hi:[1,1]
    v_pk_mul_f32 v[38:39], v[38:39], v[42:43] op_sel:[0,1] op_sel_hi:[1,1]
    v_pk_mul_f32 v[20:21], v[20:21], v[42:43] op_sel:[0,1] op_sel_hi:[1,1]
    v_pk_mul_f32 v[22:23], v[22:23], v[42:43] op_sel:[0,1] op_sel_hi:[1,1]
    v_pk_mul_f32 v[24:25], v[24:25], v[42:43] op_sel:[0,1] op_sel_hi:[1,1]
    v_pk_mul_f32 v[26:27], v[26:27], v[42:43] op_sel:[0,1] op_sel_hi:[1,1]
    v_pk_mul_f32 v[28:29], v[28:29], v[42:43] op_sel:[0,1] op_sel_hi:[1,1]
    v_pk_mul_f32 v[30:31], v[30:31], v[42:43] op_sel:[0,1] op_sel_hi:[1,1]
    v_pk_mul_f32 v[32:33], v[32:33], v[42:43] op_sel:[0,1] op_sel_hi:[1,1]
    v_pk_mul_f32 v[34:35], v[34:35], v[42:43] op_sel:[0,1] op_sel_hi:[1,1]
    v_cvt_pk_bf16_f32 v140, v36, v37
    v_cvt_pk_bf16_f32 v143, v36, v37
    v_cvt_pk_bf16_f32 v147, v36, v37
    v_cvt_pk_bf16_f32 v148, v38, v39
    v_cvt_pk_bf16_f32 v151, v38, v39
    v_cvt_pk_bf16_f32 v155, v38, v39
    s_waitcnt vmcnt(0)
    v_cvt_pk_bf16_f32 v132, v20, v21
    v_cvt_pk_bf16_f32 v133, v22, v23
    v_cvt_pk_bf16_f32 v134, v24, v25
    v_cvt_pk_bf16_f32 v135, v26, v27
    v_cvt_pk_bf16_f32 v136, v28, v29
    v_cvt_pk_bf16_f32 v137, v30, v31
    v_cvt_pk_bf16_f32 v138, v32, v33
    v_cvt_pk_bf16_f32 v139, v34, v35
    v_permlane32_swap_b32 v144, v147
    v_permlane32_swap_b32 v152, v155
    v_dot2_f32_bf16 v156, v140, v140, 0
    v_dot2_f32_bf16 v157, v148, v148, 0
    v_permlane16_swap_b32 v132, v134
    v_permlane16_swap_b32 v133, v135
    v_permlane16_swap_b32 v136, v138
    v_permlane16_swap_b32 v137, v139
    v_mov_b32 v147, v144
    v_mov_b32 v155, v152
    v_dot2_f32_bf16 v156, v132, v132, v156
    v_dot2_f32_bf16 v157, v136, v136, v157
    v_dot2_f32_bf16 v156, v133, v133, v156
    v_dot2_f32_bf16 v157, v137, v137, v157
    v_dot2_f32_bf16 v156, v134, v134, v156
    v_dot2_f32_bf16 v157, v138, v138, v157
    v_dot2_f32_bf16 v156, v135, v135, v156
    v_dot2_f32_bf16 v157, v139, v139, v157
    ds_read_b32 v47, v45 offset:12
    v_add_u32 v160, 132608, v0
    v_add_u32 v161, 132608, v1
    v_mov_b32 v162, v44
    v_mov_b32 v163, v46
    v_mov_b32 v188, 0
    v_mov_b32 v189, 0
    v_mov_b32 v190, 0
    v_mov_b32 v191, 0
    v_mov_b32 v158, v156
    s_nop 1
    v_permlane32_swap_b32 v156, v158
    v_add_f32 v156, v156, v158
    v_mov_b32 v159, v157
    s_nop 1
    v_permlane32_swap_b32 v157, v159
    v_add_f32 v157, v157, v159
    s_waitcnt lgkmcnt(0)
    v_cmp_gt_u32 vcc, s37, v47
    s_nop 0
    s_cbranch_vccnz SPINC_47
SPIND_46:
    ds_read_b32 v198, v163 offset:32
    s_mov_b32 s34, 5
    s_mov_b32 s30, 0
    s_waitcnt lgkmcnt(0)
    v_mul_f32 v158, v156, v198
    v_mul_f32 v159, v157, v198
    v_sqrt_f32 v158, v158
    v_sqrt_f32 v159, v159
    v_sub_f32 v52, 0, v158
    v_sub_f32 v53, 0, v158
    v_sub_f32 v54, 0, v158
    v_sub_f32 v55, 0, v158
    v_sub_f32 v56, 0, v158
    v_sub_f32 v57, 0, v158
    v_sub_f32 v58, 0, v158
    v_sub_f32 v59, 0, v158
    v_sub_f32 v60, 0, v158
    v_sub_f32 v61, 0, v158
    v_sub_f32 v62, 0, v158
    v_sub_f32 v63, 0, v158
    v_sub_f32 v64, 0, v158
    v_sub_f32 v65, 0, v158
    v_sub_f32 v66, 0, v158
    v_sub_f32 v67, 0, v158
    v_sub_f32 v68, 0, v159
    v_sub_f32 v69, 0, v159
    v_sub_f32 v70, 0, v159
    v_sub_f32 v71, 0, v159
    v_sub_f32 v72, 0, v159
    v_sub_f32 v73, 0, v159
    v_sub_f32 v74, 0, v159
    v_sub_f32 v75, 0, v159
    v_sub_f32 v76, 0, v159
    v_sub_f32 v77, 0, v159
    v_sub_f32 v78, 0, v159
    v_sub_f32 v79, 0, v159
    v_sub_f32 v80, 0, v159
    v_sub_f32 v81, 0, v159
    v_sub_f32 v82, 0, v159
    v_sub_f32 v83, 0, v159
    s_barrier
GO_49:
    ds_read_b64 v[192:193], v161 offset:0
    ds_read_b128 v[168:171], v160 offset:1024
    ds_read_b128 v[172:175], v160 offset:3264
    ds_read_b128 v[176:179], v162 offset:2048
    ds_read_b128 v[180:183], v162 offset:2656
    s_waitcnt lgkmcnt(3)
    v_mfma_f32_32x32x8_bf16 v[20:35], v[192:193], v[140:141], v[52:67]
    v_mfma_f32_32x32x16_bf16 v[20:35], v[168:171], v[132:135], v[20:35]
    s_mov_b32 s35, 0
    s_mov_b32 s36, 0x00c4221
    s_waitcnt lgkmcnt(0)
    s_nop 7
.p2align 6
ATT_50:
    v_mfma_f32_32x32x8_bf16 v[36:51], v[192:193], v[148:149], v[68:83]
    v_exp_f32 v20, v20
    v_exp_f32 v21, v21
    v_exp_f32 v22, v22
    v_cvt_pk_bf16_f32 v116, v20, v21
    v_exp_f32 v23, v23
    v_mfma_f32_32x32x16_bf16 v[36:51], v[168:171], v[136:139], v[36:51]
    ds_read_b128 v[168:171], v160 offset:5504
    v_exp_f32 v24, v24
    v_cvt_pk_bf16_f32 v117, v22, v23
    v_exp_f32 v25, v25
    v_exp_f32 v26, v26
    v_cvt_pk_bf16_f32 v118, v24, v25
    v_exp_f32 v27, v27
    v_mfma_f32_32x32x16_bf16 v[100:115], v[188:191], v[128:131], v[100:115]
    ds_read_b128 v[188:191], v162 offset:4896
    v_exp_f32 v28, v28
    v_cvt_pk_bf16_f32 v119, v26, v27
    v_exp_f32 v29, v29
    v_exp_f32 v30, v30
    v_cvt_pk_bf16_f32 v120, v28, v29
    v_exp_f32 v31, v31
    v_mfma_f32_32x32x16_bf16 v[84:99], v[176:179], v[116:119], v[84:99]
    ds_read_b128 v[184:187], v162 offset:4288
    v_exp_f32 v32, v32
    v_cvt_pk_bf16_f32 v121, v30, v31
    v_exp_f32 v33, v33
    v_exp_f32 v34, v34
    v_exp_f32 v35, v35
    v_cvt_pk_bf16_f32 v122, v32, v33
    v_cvt_pk_bf16_f32 v123, v34, v35
    v_mfma_f32_32x32x8_bf16 v[20:35], v[192:193], v[142:143], v[52:67]
    v_exp_f32 v36, v36
    v_exp_f32 v37, v37
    v_exp_f32 v38, v38
    v_cvt_pk_bf16_f32 v124, v36, v37
    v_exp_f32 v39, v39
    v_mfma_f32_32x32x16_bf16 v[20:35], v[172:175], v[132:135], v[20:35]
    v_exp_f32 v40, v40
    v_cvt_pk_bf16_f32 v125, v38, v39
    v_exp_f32 v41, v41
    v_exp_f32 v42, v42
    v_cvt_pk_bf16_f32 v126, v40, v41
    v_exp_f32 v43, v43
    v_mfma_f32_32x32x16_bf16 v[84:99], v[180:183], v[120:123], v[84:99]
    v_exp_f32 v44, v44
    v_cvt_pk_bf16_f32 v127, v42, v43
    v_exp_f32 v45, v45
    v_exp_f32 v46, v46
    v_cvt_pk_bf16_f32 v128, v44, v45
    v_exp_f32 v47, v47
    v_mfma_f32_32x32x16_bf16 v[100:115], v[176:179], v[124:127], v[100:115]
    s_waitcnt lgkmcnt(0)
    v_exp_f32 v48, v48
    v_cvt_pk_bf16_f32 v129, v46, v47
    v_exp_f32 v49, v49
    v_exp_f32 v50, v50
    v_exp_f32 v51, v51
    v_cvt_pk_bf16_f32 v130, v48, v49
    v_cvt_pk_bf16_f32 v131, v50, v51
    v_mfma_f32_32x32x8_bf16 v[36:51], v[192:193], v[150:151], v[68:83]
    v_exp_f32 v20, v20
    v_exp_f32 v21, v21
    v_exp_f32 v22, v22
    v_cvt_pk_bf16_f32 v116, v20, v21
    v_exp_f32 v23, v23
    v_mfma_f32_32x32x16_bf16 v[36:51], v[172:175], v[136:139], v[36:51]
    ds_read_b128 v[172:175], v160 offset:7744
    v_exp_f32 v24, v24
    v_cvt_pk_bf16_f32 v117, v22, v23
    v_exp_f32 v25, v25
    v_exp_f32 v26, v26
    v_cvt_pk_bf16_f32 v118, v24, v25
    v_exp_f32 v27, v27
    v_mfma_f32_32x32x16_bf16 v[100:115], v[180:183], v[128:131], v[100:115]
    ds_read_b128 v[180:183], v162 offset:7136
    v_exp_f32 v28, v28
    v_cvt_pk_bf16_f32 v119, v26, v27
    v_exp_f32 v29, v29
    v_exp_f32 v30, v30
    v_cvt_pk_bf16_f32 v120, v28, v29
    v_exp_f32 v31, v31
    v_mfma_f32_32x32x16_bf16 v[84:99], v[184:187], v[116:119], v[84:99]
    ds_read_b128 v[176:179], v162 offset:6528
    v_exp_f32 v32, v32
    v_cvt_pk_bf16_f32 v121, v30, v31
    v_exp_f32 v33, v33
    v_exp_f32 v34, v34
    v_exp_f32 v35, v35
    v_cvt_pk_bf16_f32 v122, v32, v33
    v_cvt_pk_bf16_f32 v123, v34, v35
    v_mfma_f32_32x32x8_bf16 v[20:35], v[192:193], v[144:145], v[52:67]
    v_exp_f32 v36, v36
    v_exp_f32 v37, v37
    v_exp_f32 v38, v38
    v_cvt_pk_bf16_f32 v124, v36, v37
    v_exp_f32 v39, v39
    v_mfma_f32_32x32x16_bf16 v[20:35], v[168:171], v[132:135], v[20:35]
    s_and_b32 s39, s36, 15
    v_exp_f32 v40, v40
    v_cvt_pk_bf16_f32 v125, v38, v39
    v_exp_f32 v41, v41
    v_exp_f32 v42, v42
    v_cvt_pk_bf16_f32 v126, v40, v41
    v_exp_f32 v43, v43
    v_mfma_f32_32x32x16_bf16 v[84:99], v[188:191], v[120:123], v[84:99]
    s_lshl_b32 s39, s39, s71
    v_exp_f32 v44, v44
    v_cvt_pk_bf16_f32 v127, v42, v43
    v_exp_f32 v45, v45
    v_exp_f32 v46, v46
    v_cvt_pk_bf16_f32 v128, v44, v45
    v_exp_f32 v47, v47
    v_mfma_f32_32x32x16_bf16 v[100:115], v[184:187], v[124:127], v[100:115]
    s_waitcnt lgkmcnt(0)
    v_exp_f32 v48, v48
    v_cvt_pk_bf16_f32 v129, v46, v47
    v_exp_f32 v49, v49
    v_exp_f32 v50, v50
    v_exp_f32 v51, v51
    v_cvt_pk_bf16_f32 v130, v48, v49
    v_cvt_pk_bf16_f32 v131, v50, v51
    v_mfma_f32_32x32x8_bf16 v[36:51], v[192:193], v[152:153], v[68:83]
    v_exp_f32 v20, v20
    v_exp_f32 v21, v21
    v_exp_f32 v22, v22
    v_cvt_pk_bf16_f32 v116, v20, v21
    v_exp_f32 v23, v23
    v_mfma_f32_32x32x16_bf16 v[36:51], v[168:171], v[136:139], v[36:51]
    ds_read_b128 v[168:171], v160 offset:9984
    v_exp_f32 v24, v24
    v_cvt_pk_bf16_f32 v117, v22, v23
    v_exp_f32 v25, v25
    v_exp_f32 v26, v26
    v_cvt_pk_bf16_f32 v118, v24, v25
    v_exp_f32 v27, v27
    v_mfma_f32_32x32x16_bf16 v[100:115], v[188:191], v[128:131], v[100:115]
    ds_read_b128 v[188:191], v162 offset:9376
    v_exp_f32 v28, v28
    v_cvt_pk_bf16_f32 v119, v26, v27
    v_exp_f32 v29, v29
    v_exp_f32 v30, v30
    v_cvt_pk_bf16_f32 v120, v28, v29
    v_exp_f32 v31, v31
    v_mfma_f32_32x32x16_bf16 v[84:99], v[176:179], v[116:119], v[84:99]
    ds_read_b128 v[184:187], v162 offset:8768
    v_exp_f32 v32, v32
    v_cvt_pk_bf16_f32 v121, v30, v31
    v_exp_f32 v33, v33
    v_exp_f32 v34, v34
    v_exp_f32 v35, v35
    v_cvt_pk_bf16_f32 v122, v32, v33
    v_cvt_pk_bf16_f32 v123, v34, v35
    v_mfma_f32_32x32x8_bf16 v[20:35], v[192:193], v[146:147], v[52:67]
    v_exp_f32 v36, v36
    v_exp_f32 v37, v37
    v_exp_f32 v38, v38
    v_cvt_pk_bf16_f32 v124, v36, v37
    v_exp_f32 v39, v39
    v_mfma_f32_32x32x16_bf16 v[20:35], v[172:175], v[132:135], v[20:35]
    ds_read_b64 v[194:195], v161 offset:512
    v_exp_f32 v40, v40
    v_cvt_pk_bf16_f32 v125, v38, v39
    v_exp_f32 v41, v41
    v_exp_f32 v42, v42
    v_cvt_pk_bf16_f32 v126, v40, v41
    v_exp_f32 v43, v43
    v_mfma_f32_32x32x16_bf16 v[84:99], v[180:183], v[120:123], v[84:99]
    v_exp_f32 v44, v44
    v_cvt_pk_bf16_f32 v127, v42, v43
    v_exp_f32 v45, v45
    v_exp_f32 v46, v46
    v_cvt_pk_bf16_f32 v128, v44, v45
    v_exp_f32 v47, v47
    v_mfma_f32_32x32x16_bf16 v[100:115], v[176:179], v[124:127], v[100:115]
    s_waitcnt lgkmcnt(0)
    v_exp_f32 v48, v48
    v_cvt_pk_bf16_f32 v129, v46, v47
    v_exp_f32 v49, v49
    v_exp_f32 v50, v50
    v_exp_f32 v51, v51
    v_cvt_pk_bf16_f32 v130, v48, v49
    v_cvt_pk_bf16_f32 v131, v50, v51
    v_mfma_f32_32x32x8_bf16 v[36:51], v[192:193], v[154:155], v[68:83]
    v_exp_f32 v20, v20
    v_exp_f32 v21, v21
    v_exp_f32 v22, v22
    v_cvt_pk_bf16_f32 v116, v20, v21
    v_exp_f32 v23, v23
    v_mfma_f32_32x32x16_bf16 v[36:51], v[172:175], v[136:139], v[36:51]
    ds_read_b128 v[172:175], v160 offset:12224
    v_exp_f32 v24, v24
    v_cvt_pk_bf16_f32 v117, v22, v23
    v_exp_f32 v25, v25
    v_exp_f32 v26, v26
    v_cvt_pk_bf16_f32 v118, v24, v25
    v_exp_f32 v27, v27
    v_mfma_f32_32x32x16_bf16 v[100:115], v[180:183], v[128:131], v[100:115]
    ds_read_b128 v[180:183], v162 offset:11616
    v_exp_f32 v28, v28
    v_cvt_pk_bf16_f32 v119, v26, v27
    v_exp_f32 v29, v29
    v_exp_f32 v30, v30
    v_cvt_pk_bf16_f32 v120, v28, v29
    v_exp_f32 v31, v31
    v_mfma_f32_32x32x16_bf16 v[84:99], v[184:187], v[116:119], v[84:99]
    ds_read_b128 v[176:179], v162 offset:11008
    v_exp_f32 v32, v32
    v_cvt_pk_bf16_f32 v121, v30, v31
    v_exp_f32 v33, v33
    v_exp_f32 v34, v34
    v_exp_f32 v35, v35
    v_cvt_pk_bf16_f32 v122, v32, v33
    v_cvt_pk_bf16_f32 v123, v34, v35
    v_mfma_f32_32x32x8_bf16 v[20:35], v[194:195], v[140:141], v[52:67]
    v_exp_f32 v36, v36
    v_exp_f32 v37, v37
    v_exp_f32 v38, v38
    v_cvt_pk_bf16_f32 v124, v36, v37
    v_exp_f32 v39, v39
    v_mfma_f32_32x32x16_bf16 v[20:35], v[168:171], v[132:135], v[20:35]
    v_exp_f32 v40, v40
    v_cvt_pk_bf16_f32 v125, v38, v39
    v_exp_f32 v41, v41
    v_exp_f32 v42, v42
    v_cvt_pk_bf16_f32 v126, v40, v41
    v_exp_f32 v43, v43
    v_mfma_f32_32x32x16_bf16 v[84:99], v[188:191], v[120:123], v[84:99]
    s_lshr_b32 s36, s36, 4
    v_exp_f32 v44, v44
    v_cvt_pk_bf16_f32 v127, v42, v43
    v_exp_f32 v45, v45
    v_exp_f32 v46, v46
    v_cvt_pk_bf16_f32 v128, v44, v45
    v_exp_f32 v47, v47
    v_mfma_f32_32x32x16_bf16 v[100:115], v[184:187], v[124:127], v[100:115]
    s_waitcnt lgkmcnt(0)
    v_exp_f32 v48, v48
    v_cvt_pk_bf16_f32 v129, v46, v47
    v_exp_f32 v49, v49
    v_exp_f32 v50, v50
    v_exp_f32 v51, v51
    v_cvt_pk_bf16_f32 v130, v48, v49
    v_cvt_pk_bf16_f32 v131, v50, v51
    v_mfma_f32_32x32x8_bf16 v[36:51], v[194:195], v[148:149], v[68:83]
    v_exp_f32 v20, v20
    v_exp_f32 v21, v21
    v_exp_f32 v22, v22
    v_cvt_pk_bf16_f32 v116, v20, v21
    v_exp_f32 v23, v23
    v_mfma_f32_32x32x16_bf16 v[36:51], v[168:171], v[136:139], v[36:51]
    ds_read_b128 v[168:171], v160 offset:14464
    v_exp_f32 v24, v24
    v_cvt_pk_bf16_f32 v117, v22, v23
    v_exp_f32 v25, v25
    v_exp_f32 v26, v26
    v_cvt_pk_bf16_f32 v118, v24, v25
    v_exp_f32 v27, v27
    v_mfma_f32_32x32x16_bf16 v[100:115], v[188:191], v[128:131], v[100:115]
    ds_read_b128 v[188:191], v162 offset:13856
    v_exp_f32 v28, v28
    v_cvt_pk_bf16_f32 v119, v26, v27
    v_exp_f32 v29, v29
    v_exp_f32 v30, v30
    v_cvt_pk_bf16_f32 v120, v28, v29
    v_exp_f32 v31, v31
    v_mfma_f32_32x32x16_bf16 v[84:99], v[176:179], v[116:119], v[84:99]
    ds_read_b128 v[184:187], v162 offset:13248
    v_exp_f32 v32, v32
    v_cvt_pk_bf16_f32 v121, v30, v31
    v_exp_f32 v33, v33
    v_exp_f32 v34, v34
    v_exp_f32 v35, v35
    v_cvt_pk_bf16_f32 v122, v32, v33
    v_cvt_pk_bf16_f32 v123, v34, v35
    v_mfma_f32_32x32x8_bf16 v[20:35], v[194:195], v[142:143], v[52:67]
    v_exp_f32 v36, v36
    v_exp_f32 v37, v37
    v_exp_f32 v38, v38
    v_cvt_pk_bf16_f32 v124, v36, v37
    v_exp_f32 v39, v39
    v_mfma_f32_32x32x16_bf16 v[20:35], v[172:175], v[132:135], v[20:35]
    v_exp_f32 v40, v40
    v_cvt_pk_bf16_f32 v125, v38, v39
    v_exp_f32 v41, v41
    v_exp_f32 v42, v42
    v_cvt_pk_bf16_f32 v126, v40, v41
    v_exp_f32 v43, v43
    v_mfma_f32_32x32x16_bf16 v[84:99], v[180:183], v[120:123], v[84:99]
    v_subrev_u32 v161, 18944, v161
    v_exp_f32 v44, v44
    v_cvt_pk_bf16_f32 v127, v42, v43
    v_exp_f32 v45, v45
    v_exp_f32 v46, v46
    v_cvt_pk_bf16_f32 v128, v44, v45
    v_exp_f32 v47, v47
    v_mfma_f32_32x32x16_bf16 v[100:115], v[176:179], v[124:127], v[100:115]
    s_waitcnt lgkmcnt(0)
    v_exp_f32 v48, v48
    v_cvt_pk_bf16_f32 v129, v46, v47
    v_exp_f32 v49, v49
    v_exp_f32 v50, v50
    v_exp_f32 v51, v51
    v_cvt_pk_bf16_f32 v130, v48, v49
    v_cvt_pk_bf16_f32 v131, v50, v51
    v_mfma_f32_32x32x8_bf16 v[36:51], v[194:195], v[150:151], v[68:83]
    v_exp_f32 v20, v20
    v_exp_f32 v21, v21
    v_exp_f32 v22, v22
    v_cvt_pk_bf16_f32 v116, v20, v21
    v_exp_f32 v23, v23
    v_mfma_f32_32x32x16_bf16 v[36:51], v[172:175], v[136:139], v[36:51]
    ds_read_b128 v[172:175], v160 offset:16704
    v_exp_f32 v24, v24
    v_cvt_pk_bf16_f32 v117, v22, v23
    v_exp_f32 v25, v25
    v_exp_f32 v26, v26
    v_cvt_pk_bf16_f32 v118, v24, v25
    v_exp_f32 v27, v27
    v_mfma_f32_32x32x16_bf16 v[100:115], v[180:183], v[128:131], v[100:115]
    ds_read_b128 v[180:183], v162 offset:16096
    v_exp_f32 v28, v28
    v_cvt_pk_bf16_f32 v119, v26, v27
    v_exp_f32 v29, v29
    v_exp_f32 v30, v30
    v_cvt_pk_bf16_f32 v120, v28, v29
    v_exp_f32 v31, v31
    v_mfma_f32_32x32x16_bf16 v[84:99], v[184:187], v[116:119], v[84:99]
    ds_read_b128 v[176:179], v162 offset:15488
    v_exp_f32 v32, v32
    v_cvt_pk_bf16_f32 v121, v30, v31
    v_exp_f32 v33, v33
    v_exp_f32 v34, v34
    v_exp_f32 v35, v35
    v_cvt_pk_bf16_f32 v122, v32, v33
    v_cvt_pk_bf16_f32 v123, v34, v35
    v_mfma_f32_32x32x8_bf16 v[20:35], v[194:195], v[144:145], v[52:67]
    v_exp_f32 v36, v36
    v_exp_f32 v37, v37
    v_exp_f32 v38, v38
    v_cvt_pk_bf16_f32 v124, v36, v37
    v_exp_f32 v39, v39
    v_mfma_f32_32x32x16_bf16 v[20:35], v[168:171], v[132:135], v[20:35]
    ds_read_b32 v199, v163 offset:64
    v_exp_f32 v40, v40
    v_cvt_pk_bf16_f32 v125, v38, v39
    v_exp_f32 v41, v41
    v_exp_f32 v42, v42
    v_cvt_pk_bf16_f32 v126, v40, v41
    v_exp_f32 v43, v43
    v_mfma_f32_32x32x16_bf16 v[84:99], v[188:191], v[120:123], v[84:99]
    v_subrev_u32 v160, 18944, v160
    v_exp_f32 v44, v44
    v_cvt_pk_bf16_f32 v127, v42, v43
    v_exp_f32 v45, v45
    v_exp_f32 v46, v46
    v_cvt_pk_bf16_f32 v128, v44, v45
    v_exp_f32 v47, v47
    v_mfma_f32_32x32x16_bf16 v[100:115], v[184:187], v[124:127], v[100:115]
    s_waitcnt lgkmcnt(0)
    v_exp_f32 v48, v48
    v_cvt_pk_bf16_f32 v129, v46, v47
    v_exp_f32 v49, v49
    v_exp_f32 v50, v50
    v_exp_f32 v51, v51
    v_cvt_pk_bf16_f32 v130, v48, v49
    v_cvt_pk_bf16_f32 v131, v50, v51
    v_mfma_f32_32x32x8_bf16 v[36:51], v[194:195], v[152:153], v[68:83]
    v_and_b32 v199, s39, v199
    v_cmp_ne_u32 vcc, s39, v199
    s_nop 0
    s_cbranch_vccnz MASKC_52
MASKD_54:
    v_exp_f32 v20, v20
    v_exp_f32 v21, v21
    v_exp_f32 v22, v22
    v_cvt_pk_bf16_f32 v116, v20, v21
    v_exp_f32 v23, v23
    v_mfma_f32_32x32x16_bf16 v[36:51], v[168:171], v[136:139], v[36:51]
    ds_read_b128 v[168:171], v160 offset:1024
    v_exp_f32 v24, v24
    v_cvt_pk_bf16_f32 v117, v22, v23
    v_exp_f32 v25, v25
    v_exp_f32 v26, v26
    v_cvt_pk_bf16_f32 v118, v24, v25
    v_exp_f32 v27, v27
    v_mfma_f32_32x32x16_bf16 v[100:115], v[188:191], v[128:131], v[100:115]
    ds_read_b128 v[188:191], v162 offset:18336
    v_exp_f32 v28, v28
    v_cvt_pk_bf16_f32 v119, v26, v27
    v_exp_f32 v29, v29
    v_exp_f32 v30, v30
    v_cvt_pk_bf16_f32 v120, v28, v29
    v_exp_f32 v31, v31
    v_mfma_f32_32x32x16_bf16 v[84:99], v[176:179], v[116:119], v[84:99]
    ds_read_b128 v[184:187], v162 offset:17728
    v_exp_f32 v32, v32
    v_cvt_pk_bf16_f32 v121, v30, v31
    v_exp_f32 v33, v33
    v_exp_f32 v34, v34
    v_exp_f32 v35, v35
    v_cvt_pk_bf16_f32 v122, v32, v33
    v_cvt_pk_bf16_f32 v123, v34, v35
    v_mfma_f32_32x32x8_bf16 v[20:35], v[194:195], v[146:147], v[52:67]
    v_exp_f32 v36, v36
    v_exp_f32 v37, v37
    v_exp_f32 v38, v38
    v_cvt_pk_bf16_f32 v124, v36, v37
    v_exp_f32 v39, v39
    v_mfma_f32_32x32x16_bf16 v[20:35], v[172:175], v[132:135], v[20:35]
    ds_read_b64 v[192:193], v161 offset:0
    v_exp_f32 v40, v40
    v_cvt_pk_bf16_f32 v125, v38, v39
    v_exp_f32 v41, v41
    v_exp_f32 v42, v42
    v_cvt_pk_bf16_f32 v126, v40, v41
    v_exp_f32 v43, v43
    v_mfma_f32_32x32x16_bf16 v[84:99], v[180:183], v[120:123], v[84:99]
    v_subrev_u32 v162, 18944, v162
    v_exp_f32 v44, v44
    v_cvt_pk_bf16_f32 v127, v42, v43
    v_exp_f32 v45, v45
    v_exp_f32 v46, v46
    v_cvt_pk_bf16_f32 v128, v44, v45
    v_exp_f32 v47, v47
    v_mfma_f32_32x32x16_bf16 v[100:115], v[176:179], v[124:127], v[100:115]
    s_waitcnt lgkmcnt(0)
    v_exp_f32 v48, v48
    v_cvt_pk_bf16_f32 v129, v46, v47
    v_exp_f32 v49, v49
    v_exp_f32 v50, v50
    v_exp_f32 v51, v51
    v_cvt_pk_bf16_f32 v130, v48, v49
    v_cvt_pk_bf16_f32 v131, v50, v51
    v_mfma_f32_32x32x8_bf16 v[36:51], v[194:195], v[154:155], v[68:83]
    v_exp_f32 v20, v20
    v_exp_f32 v21, v21
    v_exp_f32 v22, v22
    v_cvt_pk_bf16_f32 v116, v20, v21
    v_exp_f32 v23, v23
    v_mfma_f32_32x32x16_bf16 v[36:51], v[172:175], v[136:139], v[36:51]
    ds_read_b128 v[172:175], v160 offset:3264
    v_exp_f32 v24, v24
    v_cvt_pk_bf16_f32 v117, v22, v23
    v_exp_f32 v25, v25
    v_exp_f32 v26, v26
    v_cvt_pk_bf16_f32 v118, v24, v25
    v_exp_f32 v27, v27
    v_mfma_f32_32x32x16_bf16 v[100:115], v[180:183], v[128:131], v[100:115]
    ds_read_b128 v[180:183], v162 offset:2656
    v_exp_f32 v28, v28
    v_cvt_pk_bf16_f32 v119, v26, v27
    v_exp_f32 v29, v29
    v_exp_f32 v30, v30
    v_cvt_pk_bf16_f32 v120, v28, v29
    v_exp_f32 v31, v31
    v_mfma_f32_32x32x16_bf16 v[84:99], v[184:187], v[116:119], v[84:99]
    ds_read_b128 v[176:179], v162 offset:2048
    v_exp_f32 v32, v32
    v_cvt_pk_bf16_f32 v121, v30, v31
    v_exp_f32 v33, v33
    v_exp_f32 v34, v34
    v_exp_f32 v35, v35
    v_cvt_pk_bf16_f32 v122, v32, v33
    v_cvt_pk_bf16_f32 v123, v34, v35
    v_mfma_f32_32x32x8_bf16 v[20:35], v[192:193], v[140:141], v[52:67]
    v_exp_f32 v36, v36
    v_exp_f32 v37, v37
    v_exp_f32 v38, v38
    v_cvt_pk_bf16_f32 v124, v36, v37
    v_exp_f32 v39, v39
    v_mfma_f32_32x32x16_bf16 v[20:35], v[168:171], v[132:135], v[20:35]
    s_add_u32 s35, s35, 1
    v_exp_f32 v40, v40
    v_cvt_pk_bf16_f32 v125, v38, v39
    v_exp_f32 v41, v41
    v_exp_f32 v42, v42
    v_cvt_pk_bf16_f32 v126, v40, v41
    v_exp_f32 v43, v43
    v_mfma_f32_32x32x16_bf16 v[84:99], v[188:191], v[120:123], v[84:99]
    s_cmp_lg_u32 s35, s34
    v_exp_f32 v44, v44
    v_cvt_pk_bf16_f32 v127, v42, v43
    v_exp_f32 v45, v45
    v_exp_f32 v46, v46
    v_cvt_pk_bf16_f32 v128, v44, v45
    v_exp_f32 v47, v47
    v_mfma_f32_32x32x16_bf16 v[100:115], v[184:187], v[124:127], v[100:115]
    s_waitcnt lgkmcnt(0)
    v_exp_f32 v48, v48
    v_cvt_pk_bf16_f32 v129, v46, v47
    v_exp_f32 v49, v49
    v_exp_f32 v50, v50
    v_exp_f32 v51, v51
    v_cvt_pk_bf16_f32 v130, v48, v49
    v_cvt_pk_bf16_f32 v131, v50, v51
    s_cbranch_scc1 ATT_50
    s_cmp_eq_u32 s35, 8
    s_cbranch_scc1 ATTD_51
    ds_read_b128 v[164:167], v163
    v_max_f32 v158, v156, v157
    v_add_f32 v159, v156, v157
    v_mov_b32 v196, 0x451ba07b
    s_waitcnt lgkmcnt(0)
    v_max3_f32 v197, v164, v165, v166
    v_add_f32 v164, v164, v165
    v_max3_f32 v197, v197, v167, v198
    v_add_f32 v166, v166, v167
    v_mul_f32 v158, v158, v197
    v_add_f32 v164, v164, v166
    v_cmp_nle_f32 vcc, v158, v196
    v_cmp_u_f32 s[28:29], v159, v164
    s_nop 0
    s_or_b64 vcc, vcc, s[28:29]
    s_cbranch_vccnz FALLBACK_48
K3_55:
    s_mov_b32 s34, 8
    s_barrier
    s_branch ATT_50
FALLBACK_48:
    s_cmp_lg_u32 s30, 0
    s_cbranch_scc1 K3_55
    s_mov_b32 s30, 1
    s_nop 15
    v_mov_b32 v84, 0
    v_mov_b32 v85, 0
    v_mov_b32 v86, 0
    v_mov_b32 v87, 0
    v_mov_b32 v88, 0
    v_mov_b32 v89, 0
    v_mov_b32 v90, 0
    v_mov_b32 v91, 0
    v_mov_b32 v92, 0
    v_mov_b32 v93, 0
    v_mov_b32 v94, 0
    v_mov_b32 v95, 0
    v_mov_b32 v96, 0
    v_mov_b32 v97, 0
    v_mov_b32 v98, 0
    v_mov_b32 v99, 0
    v_mov_b32 v100, 0
    v_mov_b32 v101, 0
    v_mov_b32 v102, 0
    v_mov_b32 v103, 0
    v_mov_b32 v104, 0
    v_mov_b32 v105, 0
    v_mov_b32 v106, 0
    v_mov_b32 v107, 0
    v_mov_b32 v108, 0
    v_mov_b32 v109, 0
    v_mov_b32 v110, 0
    v_mov_b32 v111, 0
    v_mov_b32 v112, 0
    v_mov_b32 v113, 0
    v_mov_b32 v114, 0
    v_mov_b32 v115, 0
    v_mov_b32 v128, 0
    v_mov_b32 v188, 0
    v_mov_b32 v129, 0
    v_mov_b32 v189, 0
    v_mov_b32 v130, 0
    v_mov_b32 v190, 0
    v_mov_b32 v131, 0
    v_mov_b32 v191, 0
    v_add_u32 v162, 94720, v162
    v_mov_b32 v160, v0
    v_mov_b32 v161, v1
    v_mov_b32 v158, 0xff61b1e6
    v_mov_b32 v159, 0xff61b1e6
    s_mov_b32 s35, 0
MAXL_56:
    ds_read_b64 v[192:193], v161 offset:0
    ds_read_b128 v[168:171], v160 offset:1024
    s_waitcnt lgkmcnt(0)
    v_mfma_f32_32x32x8_bf16 v[20:35], v[192:193], v[140:141], 0
    v_mfma_f32_32x32x16_bf16 v[20:35], v[168:171], v[132:135], v[20:35]
    v_mfma_f32_32x32x8_bf16 v[36:51], v[192:193], v[148:149], 0
    v_mfma_f32_32x32x16_bf16 v[36:51], v[168:171], v[136:139], v[36:51]
    s_nop 9
    v_max3_f32 v158, v158, v20, v21
    v_max3_f32 v158, v158, v22, v23
    v_max3_f32 v158, v158, v24, v25
    v_max3_f32 v158, v158, v26, v27
    v_max3_f32 v158, v158, v28, v29
    v_max3_f32 v158, v158, v30, v31
    v_max3_f32 v158, v158, v32, v33
    v_max3_f32 v158, v158, v34, v35
    v_max3_f32 v159, v159, v36, v37
    v_max3_f32 v159, v159, v38, v39
    v_max3_f32 v159, v159, v40, v41
    v_max3_f32 v159, v159, v42, v43
    v_max3_f32 v159, v159, v44, v45
    v_max3_f32 v159, v159, v46, v47
    v_max3_f32 v159, v159, v48, v49
    v_max3_f32 v159, v159, v50, v51
    ds_read_b128 v[172:175], v160 offset:3264
    s_waitcnt lgkmcnt(0)
    v_mfma_f32_32x32x8_bf16 v[20:35], v[192:193], v[142:143], 0
    v_mfma_f32_32x32x16_bf16 v[20:35], v[172:175], v[132:135], v[20:35]
    v_mfma_f32_32x32x8_bf16 v[36:51], v[192:193], v[150:151], 0
    v_mfma_f32_32x32x16_bf16 v[36:51], v[172:175], v[136:139], v[36:51]
    s_nop 9
    v_max3_f32 v158, v158, v20, v21
    v_max3_f32 v158, v158, v22, v23
    v_max3_f32 v158, v158, v24, v25
    v_max3_f32 v158, v158, v26, v27
    v_max3_f32 v158, v158, v28, v29
    v_max3_f32 v158, v158, v30, v31
    v_max3_f32 v158, v158, v32, v33
    v_max3_f32 v158, v158, v34, v35
    v_max3_f32 v159, v159, v36, v37
    v_max3_f32 v159, v159, v38, v39
    v_max3_f32 v159, v159, v40, v41
    v_max3_f32 v159, v159, v42, v43
    v_max3_f32 v159, v159, v44, v45
    v_max3_f32 v159, v159, v46, v47
    v_max3_f32 v159, v159, v48, v49
    v_max3_f32 v159, v159, v50, v51
    ds_read_b128 v[168:171], v160 offset:5504
    s_waitcnt lgkmcnt(0)
    v_mfma_f32_32x32x8_bf16 v[20:35], v[192:193], v[144:145], 0
    v_mfma_f32_32x32x16_bf16 v[20:35], v[168:171], v[132:135], v[20:35]
    v_mfma_f32_32x32x8_bf16 v[36:51], v[192:193], v[152:153], 0
    v_mfma_f32_32x32x16_bf16 v[36:51], v[168:171], v[136:139], v[36:51]
    s_nop 9
    v_max3_f32 v158, v158, v20, v21
    v_max3_f32 v158, v158, v22, v23
    v_max3_f32 v158, v158, v24, v25
    v_max3_f32 v158, v158, v26, v27
    v_max3_f32 v158, v158, v28, v29
    v_max3_f32 v158, v158, v30, v31
    v_max3_f32 v158, v158, v32, v33
    v_max3_f32 v158, v158, v34, v35
    v_max3_f32 v159, v159, v36, v37
    v_max3_f32 v159, v159, v38, v39
    v_max3_f32 v159, v159, v40, v41
    v_max3_f32 v159, v159, v42, v43
    v_max3_f32 v159, v159, v44, v45
    v_max3_f32 v159, v159, v46, v47
    v_max3_f32 v159, v159, v48, v49
    v_max3_f32 v159, v159, v50, v51
    ds_read_b128 v[172:175], v160 offset:7744
    s_waitcnt lgkmcnt(0)
    v_mfma_f32_32x32x8_bf16 v[20:35], v[192:193], v[146:147], 0
    v_mfma_f32_32x32x16_bf16 v[20:35], v[172:175], v[132:135], v[20:35]
    v_mfma_f32_32x32x8_bf16 v[36:51], v[192:193], v[154:155], 0
    v_mfma_f32_32x32x16_bf16 v[36:51], v[172:175], v[136:139], v[36:51]
    s_nop 9
    v_max3_f32 v158, v158, v20, v21
    v_max3_f32 v158, v158, v22, v23
    v_max3_f32 v158, v158, v24, v25
    v_max3_f32 v158, v158, v26, v27
    v_max3_f32 v158, v158, v28, v29
    v_max3_f32 v158, v158, v30, v31
    v_max3_f32 v158, v158, v32, v33
    v_max3_f32 v158, v158, v34, v35
    v_max3_f32 v159, v159, v36, v37
    v_max3_f32 v159, v159, v38, v39
    v_max3_f32 v159, v159, v40, v41
    v_max3_f32 v159, v159, v42, v43
    v_max3_f32 v159, v159, v44, v45
    v_max3_f32 v159, v159, v46, v47
    v_max3_f32 v159, v159, v48, v49
    v_max3_f32 v159, v159, v50, v51
    ds_read_b64 v[194:195], v161 offset:512
    ds_read_b128 v[168:171], v160 offset:9984
    s_waitcnt lgkmcnt(0)
    v_mfma_f32_32x32x8_bf16 v[20:35], v[194:195], v[140:141], 0
    v_mfma_f32_32x32x16_bf16 v[20:35], v[168:171], v[132:135], v[20:35]
    v_mfma_f32_32x32x8_bf16 v[36:51], v[194:195], v[148:149], 0
    v_mfma_f32_32x32x16_bf16 v[36:51], v[168:171], v[136:139], v[36:51]
    s_nop 9
    v_max3_f32 v158, v158, v20, v21
    v_max3_f32 v158, v158, v22, v23
    v_max3_f32 v158, v158, v24, v25
    v_max3_f32 v158, v158, v26, v27
    v_max3_f32 v158, v158, v28, v29
    v_max3_f32 v158, v158, v30, v31
    v_max3_f32 v158, v158, v32, v33
    v_max3_f32 v158, v158, v34, v35
    v_max3_f32 v159, v159, v36, v37
    v_max3_f32 v159, v159, v38, v39
    v_max3_f32 v159, v159, v40, v41
    v_max3_f32 v159, v159, v42, v43
    v_max3_f32 v159, v159, v44, v45
    v_max3_f32 v159, v159, v46, v47
    v_max3_f32 v159, v159, v48, v49
    v_max3_f32 v159, v159, v50, v51
    ds_read_b128 v[172:175], v160 offset:12224
    s_waitcnt lgkmcnt(0)
    v_mfma_f32_32x32x8_bf16 v[20:35], v[194:195], v[142:143], 0
    v_mfma_f32_32x32x16_bf16 v[20:35], v[172:175], v[132:135], v[20:35]
    v_mfma_f32_32x32x8_bf16 v[36:51], v[194:195], v[150:151], 0
    v_mfma_f32_32x32x16_bf16 v[36:51], v[172:175], v[136:139], v[36:51]
    s_nop 9
    v_max3_f32 v158, v158, v20, v21
    v_max3_f32 v158, v158, v22, v23
    v_max3_f32 v158, v158, v24, v25
    v_max3_f32 v158, v158, v26, v27
    v_max3_f32 v158, v158, v28, v29
    v_max3_f32 v158, v158, v30, v31
    v_max3_f32 v158, v158, v32, v33
    v_max3_f32 v158, v158, v34, v35
    v_max3_f32 v159, v159, v36, v37
    v_max3_f32 v159, v159, v38, v39
    v_max3_f32 v159, v159, v40, v41
    v_max3_f32 v159, v159, v42, v43
    v_max3_f32 v159, v159, v44, v45
    v_max3_f32 v159, v159, v46, v47
    v_max3_f32 v159, v159, v48, v49
    v_max3_f32 v159, v159, v50, v51
    ds_read_b128 v[168:171], v160 offset:14464
    s_waitcnt lgkmcnt(0)
    v_mfma_f32_32x32x8_bf16 v[20:35], v[194:195], v[144:145], 0
    v_mfma_f32_32x32x16_bf16 v[20:35], v[168:171], v[132:135], v[20:35]
    v_mfma_f32_32x32x8_bf16 v[36:51], v[194:195], v[152:153], 0
    v_mfma_f32_32x32x16_bf16 v[36:51], v[168:171], v[136:139], v[36:51]
    s_nop 9
    v_max3_f32 v158, v158, v20, v21
    v_max3_f32 v158, v158, v22, v23
    v_max3_f32 v158, v158, v24, v25
    v_max3_f32 v158, v158, v26, v27
    v_max3_f32 v158, v158, v28, v29
    v_max3_f32 v158, v158, v30, v31
    v_max3_f32 v158, v158, v32, v33
    v_max3_f32 v158, v158, v34, v35
    v_max3_f32 v159, v159, v36, v37
    v_max3_f32 v159, v159, v38, v39
    v_max3_f32 v159, v159, v40, v41
    v_max3_f32 v159, v159, v42, v43
    v_max3_f32 v159, v159, v44, v45
    v_max3_f32 v159, v159, v46, v47
    v_max3_f32 v159, v159, v48, v49
    v_max3_f32 v159, v159, v50, v51
    ds_read_b128 v[172:175], v160 offset:16704
    s_waitcnt lgkmcnt(0)
    v_mfma_f32_32x32x8_bf16 v[20:35], v[194:195], v[146:147], 0
    v_mfma_f32_32x32x16_bf16 v[20:35], v[172:175], v[132:135], v[20:35]
    v_mfma_f32_32x32x8_bf16 v[36:51], v[194:195], v[154:155], 0
    v_mfma_f32_32x32x16_bf16 v[36:51], v[172:175], v[136:139], v[36:51]
    s_nop 9
    v_max3_f32 v158, v158, v20, v21
    v_max3_f32 v158, v158, v22, v23
    v_max3_f32 v158, v158, v24, v25
    v_max3_f32 v158, v158, v26, v27
    v_max3_f32 v158, v158, v28, v29
    v_max3_f32 v158, v158, v30, v31
    v_max3_f32 v158, v158, v32, v33
    v_max3_f32 v158, v158, v34, v35
    v_max3_f32 v159, v159, v36, v37
    v_max3_f32 v159, v159, v38, v39
    v_max3_f32 v159, v159, v40, v41
    v_max3_f32 v159, v159, v42, v43
    v_max3_f32 v159, v159, v44, v45
    v_max3_f32 v159, v159, v46, v47
    v_max3_f32 v159, v159, v48, v49
    v_max3_f32 v159, v159, v50, v51
    v_add_u32 v160, 18944, v160
    v_add_u32 v161, 18944, v161
    s_add_u32 s35, s35, 1
    s_cmp_lt_u32 s35, 8
    s_cbranch_scc1 MAXL_56
    v_add_u32 v160, 132608, v0
    v_add_u32 v161, 132608, v1
    v_mov_b32 v164, v158
    s_nop 1
    v_permlane32_swap_b32 v158, v164
    v_max_f32 v158, v158, v164
    v_mov_b32 v164, v159
    s_nop 1
    v_permlane32_swap_b32 v159, v164
    v_max_f32 v159, v159, v164
    v_sub_f32 v52, 0, v158
    v_sub_f32 v53, 0, v158
    v_sub_f32 v54, 0, v158
    v_sub_f32 v55, 0, v158
    v_sub_f32 v56, 0, v158
    v_sub_f32 v57, 0, v158
    v_sub_f32 v58, 0, v158
    v_sub_f32 v59, 0, v158
    v_sub_f32 v60, 0, v158
    v_sub_f32 v61, 0, v158
    v_sub_f32 v62, 0, v158
    v_sub_f32 v63, 0, v158
    v_sub_f32 v64, 0, v158
    v_sub_f32 v65, 0, v158
    v_sub_f32 v66, 0, v158
    v_sub_f32 v67, 0, v158
    v_sub_f32 v68, 0, v159
    v_sub_f32 v69, 0, v159
    v_sub_f32 v70, 0, v159
    v_sub_f32 v71, 0, v159
    v_sub_f32 v72, 0, v159
    v_sub_f32 v73, 0, v159
    v_sub_f32 v74, 0, v159
    v_sub_f32 v75, 0, v159
    v_sub_f32 v76, 0, v159
    v_sub_f32 v77, 0, v159
    v_sub_f32 v78, 0, v159
    v_sub_f32 v79, 0, v159
    v_sub_f32 v80, 0, v159
    v_sub_f32 v81, 0, v159
    v_sub_f32 v82, 0, v159
    v_sub_f32 v83, 0, v159
    s_branch GO_49
ATTD_51:
    v_mfma_f32_32x32x16_bf16 v[100:115], v[188:191], v[128:131], v[100:115]
    v_mov_b32 v95, v94
    s_nop 1
    v_permlane32_swap_b32 v94, v95
    v_rcp_f32 v94, v94
    s_nop 0
    v_mul_f32 v84, v84, v94
    v_mul_f32 v85, v85, v94
    v_mul_f32 v86, v86, v94
    v_mul_f32 v87, v87, v94
    v_mul_f32 v88, v88, v94
    v_mul_f32 v89, v89, v94
    v_mul_f32 v90, v90, v94
    v_mul_f32 v91, v91, v94
    v_mul_f32 v92, v92, v94
    v_mul_f32 v93, v93, v94
    v_cvt_pk_bf16_f32 v116, v84, v85
    v_cvt_pk_bf16_f32 v117, v86, v87
    v_cvt_pk_bf16_f32 v118, v88, v89
    v_cvt_pk_bf16_f32 v119, v90, v91
    v_cvt_pk_bf16_f32 v124, v92, v93
    v_mov_b32 v111, v110
    s_nop 1
    v_permlane32_swap_b32 v110, v111
    v_rcp_f32 v110, v110
    s_nop 0
    v_mul_f32 v100, v100, v110
    v_mul_f32 v101, v101, v110
    v_mul_f32 v102, v102, v110
    v_mul_f32 v103, v103, v110
    v_mul_f32 v104, v104, v110
    v_mul_f32 v105, v105, v110
    v_mul_f32 v106, v106, v110
    v_mul_f32 v107, v107, v110
    v_mul_f32 v108, v108, v110
    v_mul_f32 v109, v109, v110
    v_cvt_pk_bf16_f32 v120, v100, v101
    v_cvt_pk_bf16_f32 v121, v102, v103
    v_cvt_pk_bf16_f32 v122, v104, v105
    v_cvt_pk_bf16_f32 v123, v106, v107
    v_cvt_pk_bf16_f32 v125, v108, v109
    s_nop 1
    v_permlane16_swap_b32 v124, v125
    s_cmp_eq_u32 s68, 0
    s_cbranch_scc1 LOC_57
    buffer_store_dwordx4 v[116:119], v0, s[4:7], s32 offen offset:0
    buffer_store_dwordx4 v[120:123], v0, s[4:7], s32 offen offset:1024
    s_mov_b32 exec_hi, 0
    buffer_store_dwordx2 v[124:125], v1, s[4:7], s33 offen
    s_mov_b64 exec, -1
LOCE_58:
    v_and_b32 v14, 7, v3
    v_lshlrev_b32 v14, 9, v14
    s_lshl_b32 s30, s22, 13
    s_and_b32 s28, s20, 1
    s_lshl_b32 s28, s28, 1
    s_lshr_b32 s29, s17, 1
    s_add_u32 s28, s28, s29
    s_lshl_b32 s28, s28, 7
    s_add_u32 s30, s30, s28
    s_add_u32 s30, s30, 25165824
    s_add_u32 s31, s26, 2
    v_add_u32 v49, 120832, v0
    v_add_u32 v51, 59392, v0
    s_add_u32 s34, s88, s24
    s_add_u32 s34, s34, 0
    s_lshl_b32 s35, s21, 8
    s_add_u32 s35, s35, s34
    s_add_u32 s35, s35, 16384
    s_lshl_b32 s36, s21, 11
    s_add_u32 s34, s34, s36
    s_lshl_b32 s36, s21, 7
    s_add_u32 s36, s36, s89
    s_add_u32 s36, s36, s25
    s_add_u32 s36, s36, 0
    v_and_b32 v48, 0x78, v1
    s_add_u32 s48, s88, s24
    s_add_u32 s48, s48, 2359296
    s_add_u32 s49, s48, 4096
    s_add_u32 s50, s48, 8192
    s_add_u32 s51, s48, 12288
    s_add_u32 s52, s48, 16384
    v_mov_b32 v254, s31
    v_mov_b32 v255, s31
    s_mov_b64 exec, 0xffff
    s_waitcnt vmcnt(0)
    s_cmp_eq_u32 s68, 0
    s_cbranch_scc1 LOC_59
    buffer_store_dwordx2 v[254:255], v1, s[4:7], s81 offen
LOCE_60:
    s_mov_b64 exec, -1
    s_barrier
    ds_read_b128 v[132:135], v51 offset:0
    v_lshlrev_b32 v20, 16, v4
    v_and_b32 v21, 0xffff0000, v4
    ds_read_b128 v[136:139], v51 offset:1024
    v_lshlrev_b32 v22, 16, v5
    v_and_b32 v23, 0xffff0000, v5
    ds_read_b128 v[140:143], v51 offset:2048
    v_lshlrev_b32 v24, 16, v6
    v_and_b32 v25, 0xffff0000, v6
    ds_read_b128 v[144:147], v51 offset:3072
    v_lshlrev_b32 v26, 16, v7
    v_and_b32 v27, 0xffff0000, v7
    ds_read_b128 v[148:151], v51 offset:4096
    v_lshlrev_b32 v28, 16, v8
    v_and_b32 v29, 0xffff0000, v8
    ds_read_b128 v[152:155], v51 offset:5120
    v_lshlrev_b32 v30, 16, v9
    v_and_b32 v31, 0xffff0000, v9
    ds_read_b128 v[156:159], v51 offset:6144
    v_lshlrev_b32 v32, 16, v10
    v_and_b32 v33, 0xffff0000, v10
    ds_read_b128 v[160:163], v51 offset:7168
    v_lshlrev_b32 v34, 16, v11
    v_and_b32 v35, 0xffff0000, v11
    ds_read_b128 v[164:167], v51 offset:8192
    v_lshlrev_b32 v36, 16, v12
    v_and_b32 v37, 0xffff0000, v12
    ds_read_b128 v[168:171], v51 offset:9216
    v_lshlrev_b32 v38, 16, v13
    v_and_b32 v39, 0xffff0000, v13
    buffer_load_dword v15, v14, s[4:7], s83 offen sc1
    ds_read_b128 v[172:175], v51 offset:10240
    ds_read_b128 v[176:179], v51 offset:11264
    ds_read_b128 v[180:183], v51 offset:12288
    ds_read_b128 v[184:187], v51 offset:13312
    ds_read_b128 v[188:191], v51 offset:14336
    ds_read_b128 v[192:195], v51 offset:15360
    ds_read_b128 v[196:199], v51 offset:16384
    ds_read_b128 v[200:203], v51 offset:17408
    ds_read_b128 v[204:207], v51 offset:18432
    ds_read_b128 v[208:211], v51 offset:19456
    s_waitcnt vmcnt(0)
    v_subrev_u32 v15, s31, v15
    v_cmp_le_u32 vcc, 16, v15
    s_nop 0
    s_cbranch_vccnz POLLC_62
POLLE_61:
    buffer_load_dwordx4 v[52:55], v0, s[4:7], s48 offen offset:0 sc1
    ds_read_b128 v[212:215], v51 offset:20480
    buffer_load_dwordx4 v[56:59], v0, s[4:7], s48 offen offset:1024 sc1
    ds_read_b128 v[216:219], v51 offset:21504
    buffer_load_dwordx4 v[60:63], v0, s[4:7], s48 offen offset:2048 sc1
    ds_read_b128 v[220:223], v51 offset:22528
    buffer_load_dwordx4 v[64:67], v0, s[4:7], s48 offen offset:3072 sc1
    ds_read_b128 v[224:227], v51 offset:23552
    ds_read_b128 v[228:231], v51 offset:24576
    buffer_load_dwordx4 v[68:71], v0, s[4:7], s49 offen offset:0 sc1
    ds_read_b128 v[232:235], v51 offset:25600
    buffer_load_dwordx4 v[72:75], v0, s[4:7], s49 offen offset:1024 sc1
    ds_read_b128 v[236:239], v51 offset:26624
    buffer_load_dwordx4 v[76:79], v0, s[4:7], s49 offen offset:2048 sc1
    ds_read_b128 v[240:243], v51 offset:27648
    buffer_load_dwordx4 v[80:83], v0, s[4:7], s49 offen offset:3072 sc1
    ds_read_b128 v[244:247], v51 offset:28672
    ds_read_b128 v[248:251], v51 offset:29696
    s_waitcnt vmcnt(7)
    s_waitcnt lgkmcnt(15)
    v_mfma_f32_16x16x32_bf16 v[20:23], v[132:135], v[52:55], v[20:23]
    buffer_load_dwordx4 v[84:87], v0, s[4:7], s50 offen offset:0 sc1
    v_mfma_f32_16x16x32_bf16 v[24:27], v[136:139], v[52:55], v[24:27]
    ds_read_b128 v[132:135], v51 offset:30720
    v_mfma_f32_16x16x32_bf16 v[28:31], v[140:143], v[52:55], v[28:31]
    ds_read_b128 v[136:139], v51 offset:31744
    v_mfma_f32_16x16x32_bf16 v[32:35], v[144:147], v[52:55], v[32:35]
    ds_read_b128 v[140:143], v51 offset:32768
    v_mfma_f32_16x16x32_bf16 v[36:39], v[148:151], v[52:55], v[36:39]
    ds_read_b128 v[144:147], v51 offset:33792
    s_waitcnt vmcnt(7)
    s_waitcnt lgkmcnt(15)
    v_mfma_f32_16x16x32_bf16 v[20:23], v[152:155], v[56:59], v[20:23]
    buffer_load_dwordx4 v[88:91], v0, s[4:7], s50 offen offset:1024 sc1
    v_mfma_f32_16x16x32_bf16 v[24:27], v[156:159], v[56:59], v[24:27]
    ds_read_b128 v[148:151], v51 offset:34816
    v_mfma_f32_16x16x32_bf16 v[28:31], v[160:163], v[56:59], v[28:31]
    ds_read_b128 v[152:155], v51 offset:35840
    v_mfma_f32_16x16x32_bf16 v[32:35], v[164:167], v[56:59], v[32:35]
    ds_read_b128 v[156:159], v51 offset:36864
    v_mfma_f32_16x16x32_bf16 v[36:39], v[168:171], v[56:59], v[36:39]
    ds_read_b128 v[160:163], v51 offset:37888
    s_waitcnt vmcnt(7)
    s_waitcnt lgkmcnt(15)
    v_mfma_f32_16x16x32_bf16 v[20:23], v[172:175], v[60:63], v[20:23]
    buffer_load_dwordx4 v[92:95], v0, s[4:7], s50 offen offset:2048 sc1
    v_mfma_f32_16x16x32_bf16 v[24:27], v[176:179], v[60:63], v[24:27]
    ds_read_b128 v[164:167], v51 offset:38912
    v_mfma_f32_16x16x32_bf16 v[28:31], v[180:183], v[60:63], v[28:31]
    ds_read_b128 v[168:171], v51 offset:39936
    v_mfma_f32_16x16x32_bf16 v[32:35], v[184:187], v[60:63], v[32:35]
    ds_read_b128 v[172:175], v51 offset:40960
    v_mfma_f32_16x16x32_bf16 v[36:39], v[188:191], v[60:63], v[36:39]
    ds_read_b128 v[176:179], v51 offset:41984
    s_waitcnt vmcnt(7)
    s_waitcnt lgkmcnt(15)
    v_mfma_f32_16x16x32_bf16 v[20:23], v[192:195], v[64:67], v[20:23]
    buffer_load_dwordx4 v[96:99], v0, s[4:7], s50 offen offset:3072 sc1
    v_mfma_f32_16x16x32_bf16 v[24:27], v[196:199], v[64:67], v[24:27]
    ds_read_b128 v[180:183], v51 offset:43008
    v_mfma_f32_16x16x32_bf16 v[28:31], v[200:203], v[64:67], v[28:31]
    ds_read_b128 v[184:187], v51 offset:44032
    v_mfma_f32_16x16x32_bf16 v[32:35], v[204:207], v[64:67], v[32:35]
    ds_read_b128 v[188:191], v51 offset:45056
    v_mfma_f32_16x16x32_bf16 v[36:39], v[208:211], v[64:67], v[36:39]
    ds_read_b128 v[192:195], v51 offset:46080
    s_waitcnt vmcnt(7)
    s_waitcnt lgkmcnt(15)
    v_mfma_f32_16x16x32_bf16 v[20:23], v[212:215], v[68:71], v[20:23]
    buffer_load_dwordx4 v[100:103], v0, s[4:7], s51 offen offset:0 sc1
    v_mfma_f32_16x16x32_bf16 v[24:27], v[216:219], v[68:71], v[24:27]
    ds_read_b128 v[196:199], v51 offset:47104
    v_mfma_f32_16x16x32_bf16 v[28:31], v[220:223], v[68:71], v[28:31]
    ds_read_b128 v[200:203], v51 offset:48128
    v_mfma_f32_16x16x32_bf16 v[32:35], v[224:227], v[68:71], v[32:35]
    ds_read_b128 v[204:207], v51 offset:49152
    v_mfma_f32_16x16x32_bf16 v[36:39], v[228:231], v[68:71], v[36:39]
    ds_read_b128 v[208:211], v51 offset:50176
    s_waitcnt vmcnt(7)
    s_waitcnt lgkmcnt(15)
    v_mfma_f32_16x16x32_bf16 v[20:23], v[232:235], v[72:75], v[20:23]
    buffer_load_dwordx4 v[104:107], v0, s[4:7], s51 offen offset:1024 sc1
    v_mfma_f32_16x16x32_bf16 v[24:27], v[236:239], v[72:75], v[24:27]
    ds_read_b128 v[212:215], v51 offset:51200
    v_mfma_f32_16x16x32_bf16 v[28:31], v[240:243], v[72:75], v[28:31]
    ds_read_b128 v[216:219], v51 offset:52224
    v_mfma_f32_16x16x32_bf16 v[32:35], v[244:247], v[72:75], v[32:35]
    ds_read_b128 v[220:223], v51 offset:53248
    v_mfma_f32_16x16x32_bf16 v[36:39], v[248:251], v[72:75], v[36:39]
    ds_read_b128 v[224:227], v51 offset:54272
    s_waitcnt vmcnt(7)
    s_waitcnt lgkmcnt(15)
    v_mfma_f32_16x16x32_bf16 v[20:23], v[132:135], v[76:79], v[20:23]
    buffer_load_dwordx4 v[108:111], v0, s[4:7], s51 offen offset:2048 sc1
    v_mfma_f32_16x16x32_bf16 v[24:27], v[136:139], v[76:79], v[24:27]
    ds_read_b128 v[228:231], v51 offset:55296
    v_mfma_f32_16x16x32_bf16 v[28:31], v[140:143], v[76:79], v[28:31]
    ds_read_b128 v[232:235], v51 offset:56320
    v_mfma_f32_16x16x32_bf16 v[32:35], v[144:147], v[76:79], v[32:35]
    ds_read_b128 v[236:239], v51 offset:57344
    v_mfma_f32_16x16x32_bf16 v[36:39], v[148:151], v[76:79], v[36:39]
    ds_read_b128 v[240:243], v51 offset:58368
    s_waitcnt vmcnt(7)
    s_waitcnt lgkmcnt(15)
    v_mfma_f32_16x16x32_bf16 v[20:23], v[152:155], v[80:83], v[20:23]
    buffer_load_dwordx4 v[112:115], v0, s[4:7], s51 offen offset:3072 sc1
    v_mfma_f32_16x16x32_bf16 v[24:27], v[156:159], v[80:83], v[24:27]
    ds_read_b128 v[244:247], v51 offset:59392
    v_mfma_f32_16x16x32_bf16 v[28:31], v[160:163], v[80:83], v[28:31]
    ds_read_b128 v[248:251], v51 offset:60416
    v_mfma_f32_16x16x32_bf16 v[32:35], v[164:167], v[80:83], v[32:35]
    ds_read_b128 v[132:135], v49 offset:0
    v_mfma_f32_16x16x32_bf16 v[36:39], v[168:171], v[80:83], v[36:39]
    ds_read_b128 v[136:139], v49 offset:1024
    s_waitcnt vmcnt(7)
    s_waitcnt lgkmcnt(15)
    v_mfma_f32_16x16x32_bf16 v[20:23], v[172:175], v[84:87], v[20:23]
    buffer_load_dwordx2 v[116:117], v2, s[4:7], s52 offen offset:0 sc1
    v_mfma_f32_16x16x32_bf16 v[24:27], v[176:179], v[84:87], v[24:27]
    ds_read_b128 v[140:143], v49 offset:2048
    v_mfma_f32_16x16x32_bf16 v[28:31], v[180:183], v[84:87], v[28:31]
    ds_read_b128 v[144:147], v49 offset:3072
    v_mfma_f32_16x16x32_bf16 v[32:35], v[184:187], v[84:87], v[32:35]
    ds_read_b128 v[148:151], v49 offset:4096
    v_mfma_f32_16x16x32_bf16 v[36:39], v[188:191], v[84:87], v[36:39]
    ds_read_b128 v[152:155], v49 offset:5120
    s_waitcnt vmcnt(7)
    s_waitcnt lgkmcnt(15)
    v_mfma_f32_16x16x32_bf16 v[20:23], v[192:195], v[88:91], v[20:23]
    buffer_load_dwordx2 v[118:119], v2, s[4:7], s52 offen offset:128 sc1
    v_mfma_f32_16x16x32_bf16 v[24:27], v[196:199], v[88:91], v[24:27]
    ds_read_b128 v[156:159], v49 offset:6144
    v_mfma_f32_16x16x32_bf16 v[28:31], v[200:203], v[88:91], v[28:31]
    ds_read_b128 v[160:163], v49 offset:7168
    v_mfma_f32_16x16x32_bf16 v[32:35], v[204:207], v[88:91], v[32:35]
    ds_read_b128 v[164:167], v49 offset:8192
    v_mfma_f32_16x16x32_bf16 v[36:39], v[208:211], v[88:91], v[36:39]
    ds_read_b128 v[168:171], v49 offset:9216
    s_waitcnt vmcnt(7)
    s_waitcnt lgkmcnt(15)
    v_mfma_f32_16x16x32_bf16 v[20:23], v[212:215], v[92:95], v[20:23]
    buffer_load_dwordx2 v[120:121], v2, s[4:7], s52 offen offset:1024 sc1
    v_mfma_f32_16x16x32_bf16 v[24:27], v[216:219], v[92:95], v[24:27]
    ds_read_b128 v[172:175], v49 offset:10240
    v_mfma_f32_16x16x32_bf16 v[28:31], v[220:223], v[92:95], v[28:31]
    ds_read_b128 v[176:179], v49 offset:11264
    v_mfma_f32_16x16x32_bf16 v[32:35], v[224:227], v[92:95], v[32:35]
    ds_read_b128 v[180:183], v49 offset:12288
    v_mfma_f32_16x16x32_bf16 v[36:39], v[228:231], v[92:95], v[36:39]
    ds_read_b128 v[184:187], v49 offset:13312
    s_waitcnt vmcnt(7)
    s_waitcnt lgkmcnt(14)
    v_mfma_f32_16x16x32_bf16 v[20:23], v[232:235], v[96:99], v[20:23]
    buffer_load_dwordx2 v[122:123], v2, s[4:7], s52 offen offset:1152 sc1
    v_mfma_f32_16x16x32_bf16 v[24:27], v[236:239], v[96:99], v[24:27]
    ds_read_b128 v[188:191], v49 offset:14336
    v_mfma_f32_16x16x32_bf16 v[28:31], v[240:243], v[96:99], v[28:31]
    ds_read_b128 v[192:195], v49 offset:15360
    v_mfma_f32_16x16x32_bf16 v[32:35], v[244:247], v[96:99], v[32:35]
    ds_read_b128 v[196:199], v49 offset:16384
    v_mfma_f32_16x16x32_bf16 v[36:39], v[248:251], v[96:99], v[36:39]
    ds_read_b128 v[200:203], v49 offset:17408
    s_waitcnt vmcnt(7)
    s_waitcnt lgkmcnt(13)
    v_mfma_f32_16x16x32_bf16 v[20:23], v[132:135], v[100:103], v[20:23]
    v_mfma_f32_16x16x32_bf16 v[24:27], v[136:139], v[100:103], v[24:27]
    ds_read_b128 v[204:207], v49 offset:18432
    v_mfma_f32_16x16x32_bf16 v[28:31], v[140:143], v[100:103], v[28:31]
    ds_read_b128 v[208:211], v49 offset:19456
    v_mfma_f32_16x16x32_bf16 v[32:35], v[144:147], v[100:103], v[32:35]
    ds_read_b128 v[212:215], v49 offset:20480
    v_mfma_f32_16x16x32_bf16 v[36:39], v[148:151], v[100:103], v[36:39]
    ds_read_b128 v[216:219], v49 offset:21504
    s_waitcnt vmcnt(6)
    s_waitcnt lgkmcnt(12)
    v_mfma_f32_16x16x32_bf16 v[20:23], v[152:155], v[104:107], v[20:23]
    v_mfma_f32_16x16x32_bf16 v[24:27], v[156:159], v[104:107], v[24:27]
    ds_read_b128 v[220:223], v49 offset:22528
    v_mfma_f32_16x16x32_bf16 v[28:31], v[160:163], v[104:107], v[28:31]
    ds_read_b128 v[224:227], v49 offset:23552
    v_mfma_f32_16x16x32_bf16 v[32:35], v[164:167], v[104:107], v[32:35]
    ds_read_b128 v[228:231], v49 offset:24576
    v_mfma_f32_16x16x32_bf16 v[36:39], v[168:171], v[104:107], v[36:39]
    ds_read_b128 v[232:235], v49 offset:25600
    s_waitcnt vmcnt(5)
    s_waitcnt lgkmcnt(11)
    v_mfma_f32_16x16x32_bf16 v[20:23], v[172:175], v[108:111], v[20:23]
    v_mfma_f32_16x16x32_bf16 v[24:27], v[176:179], v[108:111], v[24:27]
    ds_read_b128 v[236:239], v49 offset:26624
    v_mfma_f32_16x16x32_bf16 v[28:31], v[180:183], v[108:111], v[28:31]
    ds_read_b128 v[240:243], v49 offset:27648
    v_mfma_f32_16x16x32_bf16 v[32:35], v[184:187], v[108:111], v[32:35]
    ds_read_b128 v[244:247], v49 offset:28672
    v_mfma_f32_16x16x32_bf16 v[36:39], v[188:191], v[108:111], v[36:39]
    ds_read_b128 v[248:251], v49 offset:29696
    s_waitcnt vmcnt(4)
    s_waitcnt lgkmcnt(10)
    v_mfma_f32_16x16x32_bf16 v[20:23], v[192:195], v[112:115], v[20:23]
    v_mfma_f32_16x16x32_bf16 v[24:27], v[196:199], v[112:115], v[24:27]
    v_mfma_f32_16x16x32_bf16 v[28:31], v[200:203], v[112:115], v[28:31]
    v_mfma_f32_16x16x32_bf16 v[32:35], v[204:207], v[112:115], v[32:35]
    v_mfma_f32_16x16x32_bf16 v[36:39], v[208:211], v[112:115], v[36:39]
    s_waitcnt vmcnt(2)
    s_waitcnt lgkmcnt(5)
    v_mfma_f32_16x16x32_bf16 v[20:23], v[212:215], v[116:119], v[20:23]
    v_mfma_f32_16x16x32_bf16 v[24:27], v[216:219], v[116:119], v[24:27]
    v_mfma_f32_16x16x32_bf16 v[28:31], v[220:223], v[116:119], v[28:31]
    v_mfma_f32_16x16x32_bf16 v[32:35], v[224:227], v[116:119], v[32:35]
    v_mfma_f32_16x16x32_bf16 v[36:39], v[228:231], v[116:119], v[36:39]
    s_waitcnt vmcnt(0)
    s_waitcnt lgkmcnt(0)
    s_barrier
    v_mfma_f32_16x16x32_bf16 v[20:23], v[232:235], v[120:123], v[20:23]
    v_mfma_f32_16x16x32_bf16 v[24:27], v[236:239], v[120:123], v[24:27]
    v_mfma_f32_16x16x32_bf16 v[28:31], v[240:243], v[120:123], v[28:31]
    v_mfma_f32_16x16x32_bf16 v[32:35], v[244:247], v[120:123], v[32:35]
    v_mfma_f32_16x16x32_bf16 v[36:39], v[248:251], v[120:123], v[36:39]
    s_nop 3
    v_cvt_pk_bf16_f32 v4, v20, v21
    v_cvt_pk_bf16_f32 v5, v22, v23
    v_cvt_pk_bf16_f32 v6, v24, v25
    v_cvt_pk_bf16_f32 v7, v26, v27
    v_cvt_pk_bf16_f32 v8, v28, v29
    v_cvt_pk_bf16_f32 v9, v30, v31
    v_cvt_pk_bf16_f32 v10, v32, v33
    v_cvt_pk_bf16_f32 v11, v34, v35
    v_cvt_pk_bf16_f32 v12, v36, v37
    v_cvt_pk_bf16_f32 v13, v38, v39
    s_cmp_eq_u32 s19, 1
    s_cbranch_scc1 L_FINAL
    v_mfma_f32_16x16x32_bf16 v[40:43], v[4:7], v[4:7], 0
    v_mfma_f32_16x16x32_bf16 v[44:47], v[16:19], v[4:7], 0
    v_mfma_f32_16x16x32_bf16 v[40:43], v[8:11], v[8:11], v[40:43]
    v_mfma_f32_16x16x32_bf16 v[44:47], v[16:19], v[8:11], v[44:47]
    v_mfma_f32_16x16x16_bf16 v[40:43], v[12:13], v[12:13], v[40:43]
    v_mfma_f32_16x16x16_bf16 v[44:47], v[16:17], v[12:13], v[44:47]
    s_cmp_eq_u32 s68, 0
    s_cbranch_scc1 LOC_63
    buffer_store_dwordx4 v[4:7], v0, s[4:7], s34 offen
    buffer_store_dwordx4 v[8:11], v0, s[4:7], s34 offen offset:1024
    s_mov_b32 exec_hi, 0
    buffer_store_dwordx2 v[12:13], v1, s[4:7], s35 offen
    s_mov_b64 exec, -1
    s_nop 2
    v_cndmask_b32 v40, v40, v41, s[42:43]
    v_cndmask_b32 v42, v42, v43, s[42:43]
    v_cndmask_b32 v45, v40, v42, s[44:45]
    s_mov_b64 exec, s[40:41]
    buffer_store_dwordx2 v[44:45], v48, s[4:7], s36 offen
    s_mov_b64 exec, -1
LOCE_64:
    s_add_u32 s31, s26, 3
    s_and_b32 s37, s20, 1
    s_lshl_b32 s37, s37, 2
    s_add_u32 s37, s37, s17
    s_cmp_eq_u32 s37, 7
    s_cbranch_scc1 HCP_65
    s_waitcnt vmcnt(0)
HCP_66:
    v_mov_b32 v254, s31
    v_mov_b32 v255, s31
    s_mov_b64 exec, 0xffff
    s_cmp_eq_u32 s68, 0
    s_cbranch_scc1 LOC_69
    buffer_store_dwordx2 v[254:255], v1, s[4:7], s81 offen
LOCE_70:
    s_mov_b64 exec, -1
    s_cmp_eq_u32 s37, 7
    s_cbranch_scc1 HCP_67
HCP_68:
    s_mov_b32 s19, 1
    s_add_u32 s85, s26, 3
    s_add_u32 s26, s26, 4
    s_add_u32 s24, s24, 0
    s_add_u32 s25, s25, 0
    s_lshl_b32 s82, s22, 1
    s_lshr_b32 s28, s17, 1
    s_add_u32 s82, s82, s28
    s_lshl_b32 s82, s82, 12
    s_and_b32 s28, s17, 1
    s_lshl_b32 s28, s28, 8
    s_add_u32 s82, s82, s28
    s_add_u32 s82, s82, 25165824
    v_bfe_u32 v14, v3, 1, 3
    v_lshlrev_b32 v14, 9, v14
    v_and_b32 v15, 1, v3
    v_lshl_add_u32 v14, v15, 7, v14
    s_branch L_LAYER
L_FINAL:
    v_and_b32 v20, 15, v3
    v_lshrrev_b32 v21, 4, v3
    v_mul_u32_u24 v20, 1152, v20
    v_lshl_add_u32 v22, v21, 4, v20
    v_lshl_add_u32 v23, v21, 3, v20
    s_mul_i32 s28, s21, 144
    s_add_u32 s28, s28, s88
    buffer_store_dwordx4 v[4:7], v22, s[12:15], s28 offen
    buffer_store_dwordx4 v[8:11], v22, s[12:15], s28 offen offset:64
    s_mov_b32 exec_hi, 0
    buffer_store_dwordx2 v[12:13], v23, s[12:15], s28 offen offset:128
    s_mov_b64 exec, -1
L_EXIT:
    s_endpgm
L_HELPER:
    s_sub_u32 s39, s23, 9
    s_mul_i32 s38, s22, 7
    s_add_u32 s39, s39, s38
    s_xor_b32 s38, s17, 3
    s_mul_i32 s38, s38, 112
    s_add_u32 s39, s39, s38
    s_lshl_b32 s38, s17, 13
    s_cmp_lt_u32 s23, 9
    s_cbranch_scc1 PJ_72
    s_cmp_ge_u32 s39, 441
    s_cbranch_scc1 PJ_72
    s_cmp_ge_u32 s39, 432
    s_cbranch_scc1 PKV_71
    s_cmp_ge_u32 s39, 144
    s_cselect_b32 s71, 1, 0
    s_cmp_ge_u32 s39, 288
    s_cselect_b32 s71, 2, s71
    s_mul_i32 s72, s71, 144
    s_sub_u32 s72, s39, s72
    s_lshr_b32 s73, s72, 3
    s_and_b32 s72, s72, 7
    s_cmp_eq_u32 s71, 0
    s_cselect_b32 s8, s52, s62
    s_cselect_b32 s9, s53, s63
    s_cmp_eq_u32 s71, 1
    s_cselect_b32 s8, s56, s8
    s_cselect_b32 s9, s57, s9
    s_mov_b32 s10, 663552
    s_mul_i32 s74, s73, 36
    s_cmp_eq_u32 s71, 0
    s_cselect_b32 s75, 18, 8
    s_cselect_b32 s76, 4, 18
    s_cselect_b32 s77, 8, 4
    s_lshr_b32 s78, s73, 1
    s_mul_i32 s78, s78, 72
    s_and_b32 s79, s73, 1
    s_lshl_b32 s80, s79, 5
    s_add_u32 s78, s78, s80
    s_cmp_eq_u32 s71, 1
    s_cselect_b32 s74, s78, s74
    s_cselect_b32 s75, 4, s75
    s_cselect_b32 s76, 8, s76
    s_cselect_b32 s77, 16, s77
    s_cselect_b32 s78, 64, 16
    s_cselect_b32 s80, 4, 36
    s_cselect_b32 s81, 2, 18
    s_mul_i32 s79, s79, 288
    s_add_u32 s78, s78, s79
    s_cmp_ge_u32 s73, 16
    s_cselect_b32 s74, s78, s74
    s_cselect_b32 s75, s80, s75
    s_cselect_b32 s76, 72, s76
    s_cselect_b32 s77, 144, s77
    s_cselect_b32 s81, s81, 2
    s_mul_i32 s74, s74, 1152
    s_mul_i32 s75, s75, 1152
    s_mul_i32 s76, s76, 1152
    s_mul_i32 s77, s77, 1152
    s_lshl_b32 s78, s72, 7
    s_add_u32 s74, s74, s78
    v_lshrrev_b32 v28, 1, v21
    v_mul_u32_u24 v28, s81, v28
    v_and_b32 v29, 1, v21
    v_add_u32 v28, v28, v29
    v_mul_u32_u24 v28, 1152, v28
    v_lshl_add_u32 v28, v20, 4, v28
    s_mov_b32 s79, s38
    s_mov_b32 s78, s74
    s_add_u32 m0, s79, 0
    s_nop 0
    buffer_load_dwordx4 v28, s[8:11], s78 offen lds
    s_mov_b32 s78, s74
    s_add_u32 s78, s78, s75
    s_add_u32 m0, s79, 1024
    s_nop 0
    buffer_load_dwordx4 v28, s[8:11], s78 offen lds
    s_mov_b32 s78, s74
    s_add_u32 s78, s78, s76
    s_add_u32 m0, s79, 2048
    s_nop 0
    buffer_load_dwordx4 v28, s[8:11], s78 offen lds
    s_mov_b32 s78, s74
    s_add_u32 s78, s78, s75
    s_add_u32 s78, s78, s76
    s_add_u32 m0, s79, 3072
    s_nop 0
    buffer_load_dwordx4 v28, s[8:11], s78 offen lds
    s_mov_b32 s78, s74
    s_add_u32 s78, s78, s77
    s_add_u32 m0, s79, 4096
    s_nop 0
    buffer_load_dwordx4 v28, s[8:11], s78 offen lds
    s_mov_b32 s78, s74
    s_add_u32 s78, s78, s75
    s_add_u32 s78, s78, s77
    s_add_u32 m0, s79, 5120
    s_nop 0
    buffer_load_dwordx4 v28, s[8:11], s78 offen lds
    s_mov_b32 s78, s74
    s_add_u32 s78, s78, s76
    s_add_u32 s78, s78, s77
    s_add_u32 m0, s79, 6144
    s_nop 0
    buffer_load_dwordx4 v28, s[8:11], s78 offen lds
    s_mov_b32 s78, s74
    s_add_u32 s78, s78, s75
    s_add_u32 s78, s78, s76
    s_add_u32 s78, s78, s77
    s_add_u32 m0, s79, 7168
    s_nop 0
    buffer_load_dwordx4 v28, s[8:11], s78 offen lds
    v_lshrrev_b32 v30, 2, v20
    v_lshlrev_b32 v30, 4, v30
    v_and_b32 v31, 3, v20
    v_lshl_add_u32 v30, v31, 1, v30
    v_lshlrev_b32 v31, 1, v20
    v_add_u32 v132, 128, v31
    v_bfe_u32 v133, v20, 1, 1
    v_bfe_u32 v134, v20, 2, 1
    v_lshl_add_u32 v133, v133, 1, v134
    v_mul_u32_u24 v133, 36, v133
    v_and_b32 v134, 1, v20
    v_lshl_add_u32 v133, v134, 1, v133
    v_add_u32 v133, 32, v133
    s_cmp_eq_u32 s71, 1
    s_cselect_b64 vcc, -1, 0
    s_cselect_b32 s74, 36, 8
    s_cselect_b32 s75, 72, 64
    s_add_u32 s76, s74, s75
    v_cndmask_b32 v30, v30, v31, vcc
    v_cndmask_b32 v132, v132, v133, vcc
    s_lshl_b32 s78, s72, 4
    s_add_u32 s78, s78, s79
    v_lshlrev_b32 v24, 11, v21
    v_add_u32 v24, s78, v24
    v_add_u32 v30, v30, v24
    v_add_u32 v132, v132, v24
    v_add_u32 v133, s74, v30
    v_add_u32 v134, s75, v30
    v_add_u32 v135, s76, v30
    s_mul_i32 s77, s72, 18
    s_add_u32 s77, s77, s73
    s_mul_i32 s77, s77, 5120
    s_mul_i32 s78, s71, 737280
    s_add_u32 s77, s77, s78
    s_add_u32 s77, s77, 3145728
    s_add_u32 s78, s77, 4096
    v_cmp_le_u32 vcc, 8, v20
    s_branch PJ_72
PKV_71:
    s_sub_u32 s72, s39, 432
    s_mul_i32 s74, s72, 2592
    s_cmp_lt_u32 s72, 8
    s_cselect_b32 s74, s74, 2304
    s_cselect_b32 s75, 32, 288
    s_cselect_b32 s76, 8, 72
    s_mul_i32 s75, s75, 36
    s_mul_i32 s76, s76, 36
    v_lshrrev_b32 v28, 5, v3
    v_mul_u32_u24 v28, s76, v28
    v_and_b32 v29, 31, v3
    v_lshl_add_u32 v28, v29, 4, v28
    s_lshl_b32 s76, s76, 1
    s_mov_b32 s10, 20736
    s_mov_b32 exec_lo, 0x3ffff
    s_mov_b32 exec_hi, 0x3ffff
    s_mov_b32 s8, s58
    s_mov_b32 s9, s59
    s_mov_b32 s78, s74
    s_add_u32 m0, s38, 0
    s_nop 0
    buffer_load_dwordx4 v28, s[8:11], s78 offen lds
    s_mov_b32 s78, s74
    s_add_u32 s78, s78, s76
    s_add_u32 m0, s38, 1024
    s_nop 0
    buffer_load_dwordx4 v28, s[8:11], s78 offen lds
    s_mov_b32 s78, s74
    s_add_u32 s78, s78, s75
    s_add_u32 m0, s38, 4096
    s_nop 0
    buffer_load_dwordx4 v28, s[8:11], s78 offen lds
    s_mov_b32 s78, s74
    s_add_u32 s78, s78, s75
    s_add_u32 s78, s78, s76
    s_add_u32 m0, s38, 5120
    s_nop 0
    buffer_load_dwordx4 v28, s[8:11], s78 offen lds
    s_mov_b32 s8, s60
    s_mov_b32 s9, s61
    s_mov_b32 s78, s74
    s_add_u32 m0, s38, 2048
    s_nop 0
    buffer_load_dwordx4 v28, s[8:11], s78 offen lds
    s_mov_b32 s78, s74
    s_add_u32 s78, s78, s76
    s_add_u32 m0, s38, 3072
    s_nop 0
    buffer_load_dwordx4 v28, s[8:11], s78 offen lds
    s_mov_b32 s78, s74
    s_add_u32 s78, s78, s75
    s_add_u32 m0, s38, 6144
    s_nop 0
    buffer_load_dwordx4 v28, s[8:11], s78 offen lds
    s_mov_b32 s78, s74
    s_add_u32 s78, s78, s75
    s_add_u32 s78, s78, s76
    s_add_u32 m0, s38, 7168
    s_nop 0
    buffer_load_dwordx4 v28, s[8:11], s78 offen lds
    s_mov_b64 exec, -1
PJ_72:
    s_lshr_b32 s30, s23, 1
    s_lshl_b32 s30, s30, 8
    s_add_u32 s30, s30, 458752
    v_min_u32 v13, 17, v3
    v_lshl_add_u32 v13, v13, 11, s30
    s_cmp_eq_u32 s17, 3
    s_cselect_b32 s30, 0, 0x7f000000
    buffer_load_dword v249, v13, s[4:7], s30 offen sc1
    v_mov_b32 v8, 163600
    v_mov_b32 v4, 0
    v_mov_b32 v5, 0
    v_mov_b32 v6, 0
    v_mov_b32 v7, 0
    ds_write_b128 v8, v[4:7]
    ds_write_b128 v8, v[4:7] offset:32
    ds_write_b128 v8, v[4:7] offset:48
    s_lshl_b32 s82, s17, 10
    s_and_b32 s83, s17, 1
    s_lshl_b32 s83, s83, 10
    s_add_u32 s83, s83, 16384
    s_mul_i32 s98, s23, 129024
    s_add_u32 s98, s98, 1048576
    s_waitcnt lgkmcnt(0)
    s_waitcnt vmcnt(1)
    v_readfirstlane_b32 s18, v23
    s_nop 0
    s_add_u32 s18, s18, 16
    s_add_u32 s26, s18, 3
    s_add_u32 s85, s18, 1
    s_barrier
    s_cmp_ge_u32 s23, 9
    s_cbranch_scc1 NOWA2_73
    s_mul_i32 s32, s17, 36
    s_lshl_b32 s33, s81, 4
    s_add_u32 s32, s32, s33
    v_lshlrev_b32 v24, 11, v21
    v_lshl_add_u32 v30, v20, 1, v24
    v_add_u32 v30, s32, v30
    s_lshl_b32 s34, s81, 1
    s_lshr_b32 s32, s17, 1
    s_add_u32 s34, s34, s32
    s_mul_i32 s34, s34, 18
    s_add_u32 s34, s34, s80
    s_mul_i32 s34, s34, 7
    s_and_b32 s32, s17, 1
    s_add_u32 s34, s34, s32
    s_lshl_b32 s34, s34, 10
    s_add_u32 s34, s34, 1048576
    s_add_u32 s32, s34, 4096
    ds_read_u16 v96, v30 offset:0
    ds_read_u16 v97, v30 offset:256
    ds_read_u16 v98, v30 offset:512
    ds_read_u16 v99, v30 offset:768
    ds_read_u16 v100, v30 offset:1024
    ds_read_u16 v101, v30 offset:1280
    ds_read_u16 v102, v30 offset:1536
    ds_read_u16 v103, v30 offset:1792
    ds_read_u16 v104, v30 offset:8192
    ds_read_u16 v105, v30 offset:8448
    ds_read_u16 v106, v30 offset:8704
    ds_read_u16 v107, v30 offset:8960
    ds_read_u16 v108, v30 offset:9216
    ds_read_u16 v109, v30 offset:9472
    ds_read_u16 v110, v30 offset:9728
    ds_read_u16 v111, v30 offset:9984
    ds_read_u16 v112, v30 offset:16384
    ds_read_u16 v113, v30 offset:16640
    ds_read_u16 v114, v30 offset:16896
    ds_read_u16 v115, v30 offset:17152
    ds_read_u16 v116, v30 offset:17408
    ds_read_u16 v117, v30 offset:17664
    ds_read_u16 v118, v30 offset:17920
    ds_read_u16 v119, v30 offset:18176
    s_waitcnt lgkmcnt(15)
    v_lshl_or_b32 v120, v97, 16, v96
    v_lshl_or_b32 v121, v99, 16, v98
    v_lshl_or_b32 v122, v101, 16, v100
    v_lshl_or_b32 v123, v103, 16, v102
    buffer_store_dwordx4 v[120:123], v0, s[4:7], s34 offen offset:0 sc1
    s_waitcnt lgkmcnt(8)
    v_lshl_or_b32 v124, v105, 16, v104
    v_lshl_or_b32 v125, v107, 16, v106
    v_lshl_or_b32 v126, v109, 16, v108
    v_lshl_or_b32 v127, v111, 16, v110
    buffer_store_dwordx4 v[124:127], v0, s[4:7], s34 offen offset:2048 sc1
    s_waitcnt lgkmcnt(0)
    v_lshl_or_b32 v128, v113, 16, v112
    v_lshl_or_b32 v129, v115, 16, v114
    v_lshl_or_b32 v130, v117, 16, v116
    v_lshl_or_b32 v131, v119, 16, v118
    buffer_store_dwordx4 v[128:131], v0, s[4:7], s32 offen sc1
    s_cmp_ge_u32 s17, 2
    s_cbranch_scc1 NOWAT_74
    v_bfe_u32 v31, v20, 1, 1
    v_bfe_u32 v132, v20, 2, 1
    v_cmp_le_u32 vcc, 8, v20
    s_nop 1
    v_cndmask_b32 v133, v132, v31, vcc
    v_cndmask_b32 v31, v31, 2, vcc
    v_lshlrev_b32 v31, 13, v31
    v_mad_u32_u24 v31, v133, 36, v31
    v_and_b32 v132, 1, v20
    v_lshl_add_u32 v31, v132, 1, v31
    v_add_u32 v31, v31, v24
    s_mul_i32 s32, s17, 72
    s_add_u32 s32, s32, s33
    s_add_u32 s32, s32, 32
    v_add_u32 v31, s32, v31
    s_lshl_b32 s34, s81, 1
    s_add_u32 s34, s34, s17
    s_mul_i32 s34, s34, 18
    s_add_u32 s34, s34, s80
    s_mul_i32 s34, s34, 7
    s_add_u32 s34, s34, 6
    s_lshl_b32 s34, s34, 10
    s_add_u32 s34, s34, 1048576
    ds_read_u16 v136, v31 offset:0
    ds_read_u16 v137, v31 offset:256
    ds_read_u16 v138, v31 offset:512
    ds_read_u16 v139, v31 offset:768
    ds_read_u16 v140, v31 offset:1024
    ds_read_u16 v141, v31 offset:1280
    ds_read_u16 v142, v31 offset:1536
    ds_read_u16 v143, v31 offset:1792
    s_waitcnt lgkmcnt(0)
    v_lshl_or_b32 v144, v137, 16, v136
    v_lshl_or_b32 v145, v139, 16, v138
    v_lshl_or_b32 v146, v141, 16, v140
    v_lshl_or_b32 v147, v143, 16, v142
    v_cmp_le_u32 vcc, 12, v20
    s_nop 1
    v_cndmask_b32 v144, v144, 0, vcc
    v_cndmask_b32 v145, v145, 0, vcc
    v_cndmask_b32 v146, v146, 0, vcc
    v_cndmask_b32 v147, v147, 0, vcc
    buffer_store_dwordx4 v[144:147], v0, s[4:7], s34 offen sc1
NOWAT_74:
    s_barrier
    s_lshl_b32 s32, s80, 3
    s_add_u32 s32, s32, s81
    s_lshl_b32 s32, s32, 8
    s_add_u32 s32, s32, 458752
    v_mov_b32 v254, s85
    v_mov_b32 v255, s85
    v_mov_b32 v252, 163608
    v_mov_b32 v253, 1
    s_mov_b64 exec, 1
    s_waitcnt vmcnt(0)
    ds_add_rtn_u32 v253, v252, v253
    s_waitcnt lgkmcnt(0)
    v_readfirstlane_b32 s28, v253
    s_mov_b64 exec, -1
    s_and_b32 s28, s28, 3
    s_cmp_lg_u32 s28, 3
    s_cbranch_scc1 SIG_75
    s_mov_b64 exec, 0xffff
    buffer_store_dwordx2 v[254:255], v1, s[4:7], s32 offen offset:0 sc1
    s_mov_b64 exec, -1
SIG_75:
    s_branch WAE_76
NOWA2_73:
    s_cmp_ge_u32 s39, 441
    s_cbranch_scc1 PJ_78
    s_cmp_ge_u32 s39, 432
    s_cbranch_scc1 PKV_77
    ds_read_u16 v64, v30 offset:0
    ds_read_u16 v65, v30 offset:256
    ds_read_u16 v66, v30 offset:512
    ds_read_u16 v67, v30 offset:768
    ds_read_u16 v68, v30 offset:1024
    ds_read_u16 v69, v30 offset:1280
    ds_read_u16 v70, v30 offset:1536
    ds_read_u16 v71, v30 offset:1792
    ds_read_u16 v72, v133 offset:0
    ds_read_u16 v73, v133 offset:256
    ds_read_u16 v74, v133 offset:512
    ds_read_u16 v75, v133 offset:768
    ds_read_u16 v76, v133 offset:1024
    ds_read_u16 v77, v133 offset:1280
    ds_read_u16 v78, v133 offset:1536
    ds_read_u16 v79, v133 offset:1792
    ds_read_u16 v80, v134 offset:0
    ds_read_u16 v81, v134 offset:256
    ds_read_u16 v82, v134 offset:512
    ds_read_u16 v83, v134 offset:768
    ds_read_u16 v84, v134 offset:1024
    ds_read_u16 v85, v134 offset:1280
    ds_read_u16 v86, v134 offset:1536
    ds_read_u16 v87, v134 offset:1792
    ds_read_u16 v88, v135 offset:0
    ds_read_u16 v89, v135 offset:256
    ds_read_u16 v90, v135 offset:512
    ds_read_u16 v91, v135 offset:768
    ds_read_u16 v92, v135 offset:1024
    ds_read_u16 v93, v135 offset:1280
    ds_read_u16 v94, v135 offset:1536
    ds_read_u16 v95, v135 offset:1792
    ds_read_u16 v96, v132 offset:0
    ds_read_u16 v97, v132 offset:256
    ds_read_u16 v98, v132 offset:512
    ds_read_u16 v99, v132 offset:768
    ds_read_u16 v100, v132 offset:1024
    ds_read_u16 v101, v132 offset:1280
    ds_read_u16 v102, v132 offset:1536
    ds_read_u16 v103, v132 offset:1792
    s_waitcnt lgkmcnt(0)
    v_lshl_or_b32 v104, v65, 16, v64
    v_lshl_or_b32 v105, v67, 16, v66
    v_lshl_or_b32 v106, v69, 16, v68
    v_lshl_or_b32 v107, v71, 16, v70
    buffer_store_dwordx4 v[104:107], v0, s[4:7], s77 offen offset:0 sc1
    v_lshl_or_b32 v108, v73, 16, v72
    v_lshl_or_b32 v109, v75, 16, v74
    v_lshl_or_b32 v110, v77, 16, v76
    v_lshl_or_b32 v111, v79, 16, v78
    buffer_store_dwordx4 v[108:111], v0, s[4:7], s77 offen offset:1024 sc1
    v_lshl_or_b32 v112, v81, 16, v80
    v_lshl_or_b32 v113, v83, 16, v82
    v_lshl_or_b32 v114, v85, 16, v84
    v_lshl_or_b32 v115, v87, 16, v86
    buffer_store_dwordx4 v[112:115], v0, s[4:7], s77 offen offset:2048 sc1
    v_lshl_or_b32 v116, v89, 16, v88
    v_lshl_or_b32 v117, v91, 16, v90
    v_lshl_or_b32 v118, v93, 16, v92
    v_lshl_or_b32 v119, v95, 16, v94
    buffer_store_dwordx4 v[116:119], v0, s[4:7], s77 offen offset:3072 sc1
    v_lshl_or_b32 v120, v97, 16, v96
    v_lshl_or_b32 v121, v99, 16, v98
    v_lshl_or_b32 v122, v101, 16, v100
    v_lshl_or_b32 v123, v103, 16, v102
    v_cndmask_b32 v120, v120, 0, vcc
    v_cndmask_b32 v121, v121, 0, vcc
    v_cndmask_b32 v122, v122, 0, vcc
    v_cndmask_b32 v123, v123, 0, vcc
    buffer_store_dwordx4 v[120:123], v0, s[4:7], s78 offen sc1
    s_cmp_lg_u32 s71, 1
    s_cbranch_scc1 PJ_78
    s_mul_i32 s77, s72, 5760
    s_add_u32 s77, s77, 5505024
    s_lshl_b32 s78, s73, 6
    s_add_u32 s77, s77, s78
    v_lshlrev_b32 v30, 2, v3
    v_mfma_f32_16x16x32_bf16 v[64:67], v[16:19], v[104:107], 0
    v_mfma_f32_16x16x32_bf16 v[68:71], v[16:19], v[108:111], 0
    v_mfma_f32_16x16x32_bf16 v[72:75], v[16:19], v[112:115], 0
    v_mfma_f32_16x16x32_bf16 v[76:79], v[16:19], v[116:119], 0
    v_mfma_f32_16x16x32_bf16 v[80:83], v[16:19], v[120:123], 0
    s_mov_b64 exec, 0xffff
    s_nop 2
    buffer_store_dword v64, v30, s[4:7], s77 offen sc1
    s_add_u32 s77, s77, 1152
    buffer_store_dword v68, v30, s[4:7], s77 offen sc1
    s_add_u32 s77, s77, 1152
    buffer_store_dword v72, v30, s[4:7], s77 offen sc1
    s_add_u32 s77, s77, 1152
    buffer_store_dword v76, v30, s[4:7], s77 offen sc1
    s_add_u32 s77, s77, 1152
    buffer_store_dword v80, v30, s[4:7], s77 offen sc1
    s_add_u32 s77, s77, 1152
    s_mov_b64 exec, -1
    s_branch PJ_78
PKV_77:
    v_lshl_add_u32 v28, v21, 9, s38
    v_bfe_u32 v29, v20, 1, 1
    v_lshl_add_u32 v29, v29, 11, v28
    v_and_b32 v31, 1, v20
    v_lshl_add_u32 v29, v31, 1, v29
    v_lshl_add_u32 v28, v20, 1, v28
    v_cmp_le_u32 vcc, 4, v20
    ds_read_u16 v140, v28 offset:0
    ds_read_u16 v141, v28 offset:36
    ds_read_u16 v142, v28 offset:72
    ds_read_u16 v143, v28 offset:108
    ds_read_u16 v144, v28 offset:144
    ds_read_u16 v145, v28 offset:180
    ds_read_u16 v146, v28 offset:216
    ds_read_u16 v147, v28 offset:252
    ds_read_u16 v148, v28 offset:2048
    ds_read_u16 v149, v28 offset:2084
    ds_read_u16 v150, v28 offset:2120
    ds_read_u16 v151, v28 offset:2156
    ds_read_u16 v152, v28 offset:2192
    ds_read_u16 v153, v28 offset:2228
    ds_read_u16 v154, v28 offset:2264
    ds_read_u16 v155, v28 offset:2300
    ds_read_u16 v156, v29 offset:32
    ds_read_u16 v157, v29 offset:68
    ds_read_u16 v158, v29 offset:104
    ds_read_u16 v159, v29 offset:140
    ds_read_u16 v160, v29 offset:176
    ds_read_u16 v161, v29 offset:212
    ds_read_u16 v162, v29 offset:248
    ds_read_u16 v163, v29 offset:284
    ds_read_u16 v164, v28 offset:4096
    ds_read_u16 v165, v28 offset:4132
    ds_read_u16 v166, v28 offset:4168
    ds_read_u16 v167, v28 offset:4204
    ds_read_u16 v168, v28 offset:4240
    ds_read_u16 v169, v28 offset:4276
    ds_read_u16 v170, v28 offset:4312
    ds_read_u16 v171, v28 offset:4348
    ds_read_u16 v172, v28 offset:6144
    ds_read_u16 v173, v28 offset:6180
    ds_read_u16 v174, v28 offset:6216
    ds_read_u16 v175, v28 offset:6252
    ds_read_u16 v176, v28 offset:6288
    ds_read_u16 v177, v28 offset:6324
    ds_read_u16 v178, v28 offset:6360
    ds_read_u16 v179, v28 offset:6396
    ds_read_u16 v180, v29 offset:4128
    ds_read_u16 v181, v29 offset:4164
    ds_read_u16 v182, v29 offset:4200
    ds_read_u16 v183, v29 offset:4236
    ds_read_u16 v184, v29 offset:4272
    ds_read_u16 v185, v29 offset:4308
    ds_read_u16 v186, v29 offset:4344
    ds_read_u16 v187, v29 offset:4380
    s_waitcnt lgkmcnt(0)
    s_lshl_b32 s73, s72, 1
    s_add_u32 s73, s73, 0
    s_lshl_b32 s77, s73, 11
    s_add_u32 s77, s77, 5373952
    s_add_u32 s78, s77, 36864
    v_lshl_or_b32 v104, v141, 16, v140
    v_lshl_or_b32 v105, v143, 16, v142
    v_lshl_or_b32 v106, v145, 16, v144
    v_lshl_or_b32 v107, v147, 16, v146
    v_lshl_or_b32 v108, v149, 16, v148
    v_lshl_or_b32 v109, v151, 16, v150
    v_lshl_or_b32 v110, v153, 16, v152
    v_lshl_or_b32 v111, v155, 16, v154
    v_lshl_or_b32 v112, v157, 16, v156
    v_lshl_or_b32 v113, v159, 16, v158
    v_lshl_or_b32 v114, v161, 16, v160
    v_lshl_or_b32 v115, v163, 16, v162
    v_cndmask_b32 v112, v112, 0, vcc
    v_cndmask_b32 v113, v113, 0, vcc
    v_cndmask_b32 v114, v114, 0, vcc
    v_cndmask_b32 v115, v115, 0, vcc
    buffer_store_dwordx4 v[104:107], v0, s[4:7], s77 offen sc1
    buffer_store_dwordx4 v[112:115], v0, s[4:7], s77 offen offset:1024 sc1
    buffer_store_dwordx4 v[108:111], v0, s[4:7], s78 offen sc1
    buffer_store_dwordx4 v[112:115], v0, s[4:7], s78 offen offset:1024 sc1
    s_mov_b32 s77, 5551104
    s_lshl_b32 s78, s73, 6
    s_add_u32 s77, s77, s78
    v_lshlrev_b32 v30, 2, v3
    v_mfma_f32_16x16x32_bf16 v[64:67], v[16:19], v[104:107], 0
    v_mfma_f32_16x16x32_bf16 v[68:71], v[16:19], v[108:111], 0
    v_mfma_f32_16x16x32_bf16 v[72:75], v[16:19], v[112:115], 0
    s_mov_b64 exec, 0xffff
    s_nop 4
    buffer_store_dword v64, v30, s[4:7], s77 offen sc1
    s_add_u32 s77, s77, 1152
    buffer_store_dword v68, v30, s[4:7], s77 offen sc1
    s_add_u32 s77, s77, 1152
    buffer_store_dword v72, v30, s[4:7], s77 offen sc1
    s_add_u32 s77, s77, 1152
    s_mov_b64 exec, -1
    s_lshl_b32 s73, s72, 1
    s_add_u32 s73, s73, 1
    s_lshl_b32 s77, s73, 11
    s_add_u32 s77, s77, 5373952
    s_add_u32 s78, s77, 36864
    v_lshl_or_b32 v120, v165, 16, v164
    v_lshl_or_b32 v121, v167, 16, v166
    v_lshl_or_b32 v122, v169, 16, v168
    v_lshl_or_b32 v123, v171, 16, v170
    v_lshl_or_b32 v124, v173, 16, v172
    v_lshl_or_b32 v125, v175, 16, v174
    v_lshl_or_b32 v126, v177, 16, v176
    v_lshl_or_b32 v127, v179, 16, v178
    v_lshl_or_b32 v128, v181, 16, v180
    v_lshl_or_b32 v129, v183, 16, v182
    v_lshl_or_b32 v130, v185, 16, v184
    v_lshl_or_b32 v131, v187, 16, v186
    v_cndmask_b32 v128, v128, 0, vcc
    v_cndmask_b32 v129, v129, 0, vcc
    v_cndmask_b32 v130, v130, 0, vcc
    v_cndmask_b32 v131, v131, 0, vcc
    buffer_store_dwordx4 v[120:123], v0, s[4:7], s77 offen sc1
    buffer_store_dwordx4 v[128:131], v0, s[4:7], s77 offen offset:1024 sc1
    buffer_store_dwordx4 v[124:127], v0, s[4:7], s78 offen sc1
    buffer_store_dwordx4 v[128:131], v0, s[4:7], s78 offen offset:1024 sc1
    s_mov_b32 s77, 5551104
    s_lshl_b32 s78, s73, 6
    s_add_u32 s77, s77, s78
    v_lshlrev_b32 v30, 2, v3
    v_mfma_f32_16x16x32_bf16 v[80:83], v[16:19], v[120:123], 0
    v_mfma_f32_16x16x32_bf16 v[84:87], v[16:19], v[124:127], 0
    v_mfma_f32_16x16x32_bf16 v[88:91], v[16:19], v[128:131], 0
    s_mov_b64 exec, 0xffff
    s_nop 4
    buffer_store_dword v80, v30, s[4:7], s77 offen sc1
    s_add_u32 s77, s77, 1152
    buffer_store_dword v84, v30, s[4:7], s77 offen sc1
    s_add_u32 s77, s77, 1152
    buffer_store_dword v88, v30, s[4:7], s77 offen sc1
    s_add_u32 s77, s77, 1152
    s_mov_b64 exec, -1
PJ_78:
    s_barrier
WAE_76:
    s_lshl_b32 s28, s17, 8
    s_add_u32 s28, s28, s16
    s_lshl_b32 s29, s28, 10
    s_add_u32 s29, s29, 131072
    s_cmp_lt_u32 s28, 320
    s_cselect_b32 s29, s29, 0x7f000000
    buffer_store_dwordx4 v[16:19], v0, s[4:7], s29 offen sc1
    v_and_b32 v34, 7, v3
    v_lshlrev_b32 v34, 7, v34
    s_lshl_b32 s28, s23, 10
    v_add_u32 v34, s28, v34
    s_lshl_b32 s28, s23, 7
    s_add_u32 s28, s28, 16384
    v_mov_b32 v35, s28
    v_cmp_gt_u32 vcc, 8, v20
    s_nop 1
    v_cndmask_b32 v32, v35, v34, vcc
    v_and_b32 v34, 1, v21
    s_lshl_b32 s28, s22, 3
    s_lshl_b32 s29, s17, 1
    s_add_u32 s28, s28, s29
    v_add_u32 v34, s28, v34
    v_mul_u32_u24 v34, 18432, v34
    v_add_u32 v32, v32, v34
    v_lshlrev_b32 v34, 7, v20
    s_lshl_b32 s28, s21, 11
    v_add_u32 v34, s28, v34
    v_and_b32 v35, 1, v3
    v_lshlrev_b32 v35, 7, v35
    s_lshl_b32 s28, s21, 8
    s_add_u32 s28, s28, 16384
    v_add_u32 v35, s28, v35
    v_cmp_gt_u32 vcc, 16, v3
    s_nop 1
    v_cndmask_b32 v33, v35, v34, vcc
    s_lshl_b32 s28, s20, 2
    s_add_u32 s28, s28, s17
    s_lshl_b32 s89, s28, 10
    s_mul_i32 s28, s28, 18432
    v_add_u32 v33, s28, v33
    s_lshl_b32 s28, s21, 7
    s_add_u32 s89, s89, s28
    v_mov_b32 v254, s85
    v_mov_b32 v255, s84
    v_mov_b32 v252, 163604
    v_mov_b32 v253, 1
    s_mov_b64 exec, 1
    s_waitcnt vmcnt(0)
    ds_add_rtn_u32 v253, v252, v253
    s_waitcnt lgkmcnt(0)
    v_readfirstlane_b32 s28, v253
    s_mov_b64 exec, -1
    s_and_b32 s28, s28, 3
    s_cmp_lg_u32 s28, 3
    s_cbranch_scc1 SIG_79
    s_mov_b64 exec, 0xffff
    buffer_store_dwordx2 v[254:255], v1, s[4:7], s27 offen offset:128 sc1
    s_mov_b64 exec, -1
SIG_79:
    v_mov_b32 v38, 163632
    s_cmp_ge_u32 s17, 2
    s_cbranch_scc1 HW_80
    s_cmp_eq_u32 s17, 0
    s_cbranch_scc1 HZ_82
    s_mov_b32 s64, s48
    s_mov_b32 s65, s49
    s_mov_b32 s66, 2359296
    v_lshrrev_b32 v24, 2, v3
    v_and_b32 v25, 2, v21
    v_and_b32 v26, 3, v3
    v_xor_b32 v25, v25, v26
    v_mul_u32_u24 v24, 1152, v24
    v_lshl_add_u32 v24, v25, 4, v24
    s_lshl_b32 s36, s22, 3
    s_sub_u32 s36, s36, 1
    s_max_i32 s36, s36, 0
    s_mul_i32 s36, s36, 18432
    s_add_u32 s37, s36, 0
    s_mov_b32 m0, 129024
    s_nop 0
    buffer_load_dwordx4 v24, s[64:67], s37 offen lds
    s_add_u32 s37, s36, 64
    s_mov_b32 m0, 130048
    s_nop 0
    buffer_load_dwordx4 v24, s[64:67], s37 offen lds
    s_add_u32 s37, s36, 128
    s_mov_b32 m0, 131072
    s_nop 0
    buffer_load_dwordx4 v24, s[64:67], s37 offen lds
    s_add_u32 s37, s36, 192
    s_mov_b32 m0, 132096
    s_nop 0
    buffer_load_dwordx4 v24, s[64:67], s37 offen lds
    s_add_u32 s37, s36, 256
    s_mov_b32 m0, 133120
    s_nop 0
    buffer_load_dwordx4 v24, s[64:67], s37 offen lds
    s_add_u32 s37, s36, 320
    s_mov_b32 m0, 134144
    s_nop 0
    buffer_load_dwordx4 v24, s[64:67], s37 offen lds
    s_add_u32 s37, s36, 384
    s_mov_b32 m0, 135168
    s_nop 0
    buffer_load_dwordx4 v24, s[64:67], s37 offen lds
    s_add_u32 s37, s36, 448
    s_mov_b32 m0, 136192
    s_nop 0
    buffer_load_dwordx4 v24, s[64:67], s37 offen lds
    s_add_u32 s37, s36, 512
    s_mov_b32 m0, 137216
    s_nop 0
    buffer_load_dwordx4 v24, s[64:67], s37 offen lds
    s_add_u32 s37, s36, 576
    s_mov_b32 m0, 138240
    s_nop 0
    buffer_load_dwordx4 v24, s[64:67], s37 offen lds
    s_add_u32 s37, s36, 640
    s_mov_b32 m0, 139264
    s_nop 0
    buffer_load_dwordx4 v24, s[64:67], s37 offen lds
    s_add_u32 s37, s36, 704
    s_mov_b32 m0, 140288
    s_nop 0
    buffer_load_dwordx4 v24, s[64:67], s37 offen lds
    s_add_u32 s37, s36, 768
    s_mov_b32 m0, 141312
    s_nop 0
    buffer_load_dwordx4 v24, s[64:67], s37 offen lds
    s_add_u32 s37, s36, 832
    s_mov_b32 m0, 142336
    s_nop 0
    buffer_load_dwordx4 v24, s[64:67], s37 offen lds
    s_add_u32 s37, s36, 896
    s_mov_b32 m0, 143360
    s_nop 0
    buffer_load_dwordx4 v24, s[64:67], s37 offen lds
    s_add_u32 s37, s36, 960
    s_mov_b32 m0, 144384
    s_nop 0
    buffer_load_dwordx4 v24, s[64:67], s37 offen lds
    s_add_u32 s37, s36, 1024
    s_mov_b32 m0, 145408
    s_nop 0
    buffer_load_dwordx4 v24, s[64:67], s37 offen lds
    s_add_u32 s37, s36, 1088
    s_mov_b32 m0, 146432
    s_nop 0
    buffer_load_dwordx4 v24, s[64:67], s37 offen lds
    v_lshrrev_b32 v25, 2, v20
    v_and_b32 v25, 2, v25
    v_lshlrev_b32 v26, 6, v20
    v_add_u32 v26, 129024, v26
    v_add_u32 v27, 0, v21
    v_lshrrev_b32 v28, 2, v27
    v_and_b32 v27, 3, v27
    v_xor_b32 v27, v27, v25
    v_lshl_add_u32 v27, v27, 4, v26
    v_lshl_add_u32 v50, v28, 10, v27
    v_add_u32 v27, 1, v21
    v_lshrrev_b32 v28, 2, v27
    v_and_b32 v27, 3, v27
    v_xor_b32 v27, v27, v25
    v_lshl_add_u32 v27, v27, 4, v26
    v_lshl_add_u32 v51, v28, 10, v27
    v_add_u32 v27, 2, v21
    v_lshrrev_b32 v28, 2, v27
    v_and_b32 v27, 3, v27
    v_xor_b32 v27, v27, v25
    v_lshl_add_u32 v27, v27, 4, v26
    v_lshl_add_u32 v52, v28, 10, v27
    v_add_u32 v27, 3, v21
    v_lshrrev_b32 v28, 2, v27
    v_and_b32 v27, 3, v27
    v_xor_b32 v27, v27, v25
    v_lshl_add_u32 v27, v27, 4, v26
    v_lshl_add_u32 v53, v28, 10, v27
    v_lshl_add_u32 v54, v21, 11, v50
    v_add_u32 v55, 129024, v0
    v_lshlrev_b32 v56, 8, v3
    v_add_u32 v56, 129024, v56
    s_waitcnt vmcnt(0)
    ds_read_b128 v[140:143], v50 offset:0
    ds_read_b128 v[144:147], v50 offset:1024
    ds_read_b128 v[148:151], v51 offset:2048
    ds_read_b128 v[152:155], v51 offset:3072
    ds_read_b128 v[156:159], v52 offset:4096
    ds_read_b128 v[160:163], v52 offset:5120
    ds_read_b128 v[164:167], v53 offset:6144
    ds_read_b128 v[168:171], v53 offset:7168
    ds_read_b128 v[172:175], v50 offset:9216
    ds_read_b128 v[176:179], v50 offset:10240
    ds_read_b128 v[180:183], v51 offset:11264
    ds_read_b128 v[184:187], v51 offset:12288
    ds_read_b128 v[188:191], v52 offset:13312
    ds_read_b128 v[192:195], v52 offset:14336
    ds_read_b128 v[196:199], v53 offset:15360
    ds_read_b128 v[200:203], v53 offset:16384
    ds_read_b128 v[204:207], v54 offset:2048
    ds_read_b128 v[208:211], v54 offset:11264
    s_waitcnt lgkmcnt(0)
    ds_write_b128 v55, v[140:143] offset:0
    ds_write_b128 v55, v[144:147] offset:1024
    ds_write_b128 v55, v[148:151] offset:2048
    ds_write_b128 v55, v[152:155] offset:3072
    ds_write_b128 v55, v[156:159] offset:4096
    ds_write_b128 v55, v[160:163] offset:5120
    ds_write_b128 v55, v[164:167] offset:6144
    ds_write_b128 v55, v[168:171] offset:7168
    ds_write_b128 v55, v[172:175] offset:8192
    ds_write_b128 v55, v[176:179] offset:9216
    ds_write_b128 v55, v[180:183] offset:10240
    ds_write_b128 v55, v[184:187] offset:11264
    ds_write_b128 v55, v[188:191] offset:12288
    ds_write_b128 v55, v[192:195] offset:13312
    ds_write_b128 v55, v[196:199] offset:14336
    ds_write_b128 v55, v[200:203] offset:15360
    ds_write_b128 v55, v[204:207] offset:16384
    ds_write_b128 v55, v[208:211] offset:17408
    ds_write_b128 v56, v[16:19]
    s_mov_b64 exec, 0xff
    ds_write_b128 v56, v[16:19] offset:16384
    s_mov_b64 exec, -1
    v_mfma_f32_16x16x32_bf16 v[40:43], v[140:143], v[140:143], 0
    v_mfma_f32_16x16x32_bf16 v[44:47], v[16:19], v[140:143], 0
    v_mfma_f32_16x16x32_bf16 v[40:43], v[144:147], v[144:147], v[40:43]
    v_mfma_f32_16x16x32_bf16 v[44:47], v[16:19], v[144:147], v[44:47]
    v_mfma_f32_16x16x32_bf16 v[40:43], v[148:151], v[148:151], v[40:43]
    v_mfma_f32_16x16x32_bf16 v[44:47], v[16:19], v[148:151], v[44:47]
    v_mfma_f32_16x16x32_bf16 v[40:43], v[152:155], v[152:155], v[40:43]
    v_mfma_f32_16x16x32_bf16 v[44:47], v[16:19], v[152:155], v[44:47]
    v_mfma_f32_16x16x32_bf16 v[40:43], v[156:159], v[156:159], v[40:43]
    v_mfma_f32_16x16x32_bf16 v[44:47], v[16:19], v[156:159], v[44:47]
    v_mfma_f32_16x16x32_bf16 v[40:43], v[160:163], v[160:163], v[40:43]
    v_mfma_f32_16x16x32_bf16 v[44:47], v[16:19], v[160:163], v[44:47]
    v_mfma_f32_16x16x32_bf16 v[40:43], v[164:167], v[164:167], v[40:43]
    v_mfma_f32_16x16x32_bf16 v[44:47], v[16:19], v[164:167], v[44:47]
    v_mfma_f32_16x16x32_bf16 v[40:43], v[168:171], v[168:171], v[40:43]
    v_mfma_f32_16x16x32_bf16 v[44:47], v[16:19], v[168:171], v[44:47]
    v_mfma_f32_16x16x32_bf16 v[40:43], v[172:175], v[172:175], v[40:43]
    v_mfma_f32_16x16x32_bf16 v[44:47], v[16:19], v[172:175], v[44:47]
    v_mfma_f32_16x16x32_bf16 v[40:43], v[176:179], v[176:179], v[40:43]
    v_mfma_f32_16x16x32_bf16 v[44:47], v[16:19], v[176:179], v[44:47]
    v_mfma_f32_16x16x32_bf16 v[40:43], v[180:183], v[180:183], v[40:43]
    v_mfma_f32_16x16x32_bf16 v[44:47], v[16:19], v[180:183], v[44:47]
    v_mfma_f32_16x16x32_bf16 v[40:43], v[184:187], v[184:187], v[40:43]
    v_mfma_f32_16x16x32_bf16 v[44:47], v[16:19], v[184:187], v[44:47]
    v_mfma_f32_16x16x32_bf16 v[40:43], v[188:191], v[188:191], v[40:43]
    v_mfma_f32_16x16x32_bf16 v[44:47], v[16:19], v[188:191], v[44:47]
    v_mfma_f32_16x16x32_bf16 v[40:43], v[192:195], v[192:195], v[40:43]
    v_mfma_f32_16x16x32_bf16 v[44:47], v[16:19], v[192:195], v[44:47]
    v_mfma_f32_16x16x32_bf16 v[40:43], v[196:199], v[196:199], v[40:43]
    v_mfma_f32_16x16x32_bf16 v[44:47], v[16:19], v[196:199], v[44:47]
    v_mfma_f32_16x16x32_bf16 v[40:43], v[200:203], v[200:203], v[40:43]
    v_mfma_f32_16x16x32_bf16 v[44:47], v[16:19], v[200:203], v[44:47]
    v_mfma_f32_16x16x32_bf16 v[40:43], v[204:207], v[204:207], v[40:43]
    v_mfma_f32_16x16x32_bf16 v[44:47], v[16:19], v[204:207], v[44:47]
    v_mfma_f32_16x16x32_bf16 v[40:43], v[208:211], v[208:211], v[40:43]
    v_mfma_f32_16x16x32_bf16 v[44:47], v[16:19], v[208:211], v[44:47]
    v_lshlrev_b32 v24, 2, v20
    v_add_u32 v24, 161792, v24
    v_mov_b32 v6, 0
    v_mov_b32 v7, 0
    s_nop 2
    v_cndmask_b32 v40, v40, v41, s[42:43]
    v_cndmask_b32 v42, v42, v43, s[42:43]
    v_cndmask_b32 v40, v40, v42, s[44:45]
    v_cndmask_b32 v5, 0, v40, s[40:41]
    v_cndmask_b32 v4, 0, v44, s[40:41]
    v_add_f32 v4, v4, v6
    v_add_f32 v5, v5, v7
    v_mov_b32 v6, v4
    v_mov_b32 v7, v5
    s_nop 0
    v_permlane32_swap_b32 v4, v6
    v_permlane32_swap_b32 v5, v7
    v_add_f32 v4, v4, v6
    v_add_f32 v5, v5, v7
    v_mov_b32 v6, v4
    v_mov_b32 v7, v5
    s_nop 0
    v_permlane16_swap_b32 v4, v6
    v_permlane16_swap_b32 v5, v7
    v_add_f32 v4, v4, v6
    v_add_f32 v5, v5, v7
    v_mul_f32 v6, 0xbae38e39, v4
    v_mul_f32 v5, 0x3ae38e39, v5
    v_fma_f32 v5, -v6, v6, v5
    v_max_f32 v5, 0, v5
    v_add_f32 v5, 0x3727c5ac, v5
    v_rsq_f32 v7, v5
    ds_write_b32 v24, v6 offset:0
    ds_write_b32 v24, v7 offset:64
    ds_write_b32 v24, v6 offset:512
    ds_write_b32 v24, v7 offset:576
    ds_write_b32 v24, v6 offset:1024
    ds_write_b32 v24, v7 offset:1088
    ds_write_b32 v24, v6 offset:1536
    ds_write_b32 v24, v7 offset:1600
    s_waitcnt lgkmcnt(0)
    v_mov_b32 v38, 163632
    v_mov_b32 v39, 2
    s_mov_b64 exec, 1
    ds_add_u32 v38, v39 offset:8
    s_mov_b64 exec, -1
    s_branch HC_81
HZ_82:
    ds_read_b32 v36, v38 offset:20
    s_waitcnt lgkmcnt(0)
    v_cmp_gt_u32 vcc, 2, v36
    s_nop 0
    s_cbranch_vccnz SPINC_85
SPIND_84:
    v_lshlrev_b32 v14, 8, v3
    s_mov_b32 s70, 0
PALL_86:
    s_mov_b32 s30, 4224
    buffer_load_dword v40, v14, s[4:7], s30 offen sc1
    s_mov_b32 s30, 20608
    buffer_load_dword v41, v14, s[4:7], s30 offen sc1
    s_mov_b32 s30, 36992
    buffer_load_dword v42, v14, s[4:7], s30 offen sc1
    s_mov_b32 s30, 53376
    buffer_load_dword v43, v14, s[4:7], s30 offen sc1
    s_waitcnt vmcnt(0)
    v_subrev_u32 v40, s85, v40
    v_subrev_u32 v41, s85, v41
    v_subrev_u32 v42, s85, v42
    v_subrev_u32 v43, s85, v43
    v_max3_u32 v40, v40, v41, v42
    v_max_u32 v40, v40, v43
    v_cmp_le_u32 vcc, 16, v40
    s_add_u32 s70, s70, 1
    s_cmp_gt_u32 s70, 200000
    s_cbranch_scc1 PALLD_87
    s_cbranch_vccnz PALL_86
PALLD_87:
    v_mov_b32 v38, 163632
    v_mov_b32 v39, 1
    s_mov_b64 exec, 1
    ds_add_u32 v38, v39 offset:24
    s_mov_b64 exec, -1
    s_branch HC_81
HW_80:
    v_mov_b32 v14, v13
    s_mov_b32 s70, 0
POLL_88:
    buffer_load_dword v15, v14, s[4:7], 0 offen sc1
    s_waitcnt vmcnt(0)
    v_subrev_u32 v15, s85, v15
    v_cmp_le_u32 vcc, 16, v15
    s_add_u32 s70, s70, 1
    s_cmp_gt_u32 s70, 200000
    s_cbranch_scc1 POLLD_89
    s_cbranch_vccnz POLL_88
POLLD_89:
    s_add_u32 s96, s100, 4294959104
    s_add_u32 s97, s96, s98
    s_add_u32 m0, s96, 0
    s_nop 0
    buffer_load_dwordx4 v0, s[4:7], s97 offen offset:0 sc1 lds
    buffer_load_dwordx4 v0, s[4:7], s97 offen offset:1024 sc1 lds
    buffer_load_dwordx4 v0, s[4:7], s97 offen offset:2048 sc1 lds
    buffer_load_dwordx4 v0, s[4:7], s97 offen offset:3072 sc1 lds
    s_add_u32 s96, s100, 0
    s_add_u32 s97, s96, s98
    s_add_u32 m0, s96, 0
    s_nop 0
    buffer_load_dwordx4 v0, s[4:7], s97 offen offset:0 sc1 lds
    buffer_load_dwordx4 v0, s[4:7], s97 offen offset:1024 sc1 lds
    buffer_load_dwordx4 v0, s[4:7], s97 offen offset:2048 sc1 lds
    buffer_load_dwordx4 v0, s[4:7], s97 offen offset:3072 sc1 lds
    s_add_u32 s96, s100, 8192
    s_add_u32 s97, s96, s98
    s_add_u32 m0, s96, 0
    s_nop 0
    buffer_load_dwordx4 v0, s[4:7], s97 offen offset:0 sc1 lds
    buffer_load_dwordx4 v0, s[4:7], s97 offen offset:1024 sc1 lds
    buffer_load_dwordx4 v0, s[4:7], s97 offen offset:2048 sc1 lds
    buffer_load_dwordx4 v0, s[4:7], s97 offen offset:3072 sc1 lds
    s_add_u32 s96, s100, 16384
    s_add_u32 s97, s96, s98
    s_add_u32 m0, s96, 0
    s_nop 0
    buffer_load_dwordx4 v0, s[4:7], s97 offen offset:0 sc1 lds
    buffer_load_dwordx4 v0, s[4:7], s97 offen offset:1024 sc1 lds
    buffer_load_dwordx4 v0, s[4:7], s97 offen offset:2048 sc1 lds
    buffer_load_dwordx4 v0, s[4:7], s97 offen offset:3072 sc1 lds
    s_add_u32 s96, s100, 24576
    s_add_u32 s97, s96, s98
    s_add_u32 m0, s96, 0
    s_nop 0
    buffer_load_dwordx4 v0, s[4:7], s97 offen offset:0 sc1 lds
    buffer_load_dwordx4 v0, s[4:7], s97 offen offset:1024 sc1 lds
    buffer_load_dwordx4 v0, s[4:7], s97 offen offset:2048 sc1 lds
    buffer_load_dwordx4 v0, s[4:7], s97 offen offset:3072 sc1 lds
    s_add_u32 s96, s100, 32768
    s_add_u32 s97, s96, s98
    s_add_u32 m0, s96, 0
    s_nop 0
    buffer_load_dwordx4 v0, s[4:7], s97 offen offset:0 sc1 lds
    buffer_load_dwordx4 v0, s[4:7], s97 offen offset:1024 sc1 lds
    buffer_load_dwordx4 v0, s[4:7], s97 offen offset:2048 sc1 lds
    buffer_load_dwordx4 v0, s[4:7], s97 offen offset:3072 sc1 lds
    s_waitcnt vmcnt(16)
    v_mov_b32 v38, 163632
    v_mov_b32 v39, 1
    s_mov_b64 exec, 1
    ds_add_u32 v38, v39 offset:20
    s_mov_b64 exec, -1
    ds_read_b32 v36, v38 offset:16
    s_waitcnt lgkmcnt(0)
    v_cmp_gt_u32 vcc, 4, v36
    s_nop 0
    s_cbranch_vccnz SPINC_92
SPIND_91:
    s_add_u32 s96, s100, 40960
    s_add_u32 s97, s96, s98
    s_add_u32 m0, s96, 0
    s_nop 0
    buffer_load_dwordx4 v0, s[4:7], s97 offen offset:0 sc1 lds
    buffer_load_dwordx4 v0, s[4:7], s97 offen offset:1024 sc1 lds
    buffer_load_dwordx4 v0, s[4:7], s97 offen offset:2048 sc1 lds
    buffer_load_dwordx4 v0, s[4:7], s97 offen offset:3072 sc1 lds
    s_add_u32 s96, s100, 49152
    s_add_u32 s97, s96, s98
    s_add_u32 m0, s96, 0
    s_nop 0
    buffer_load_dwordx4 v0, s[4:7], s97 offen offset:0 sc1 lds
    buffer_load_dwordx4 v0, s[4:7], s97 offen offset:1024 sc1 lds
    buffer_load_dwordx4 v0, s[4:7], s97 offen offset:2048 sc1 lds
    buffer_load_dwordx4 v0, s[4:7], s97 offen offset:3072 sc1 lds
    s_waitcnt vmcnt(16)
    v_mov_b32 v38, 163632
    v_mov_b32 v39, 2
    s_mov_b64 exec, 1
    ds_add_u32 v38, v39 offset:28
    s_mov_b64 exec, -1
    s_add_u32 s96, s100, 57344
    s_add_u32 s97, s96, s98
    s_add_u32 m0, s96, 0
    s_nop 0
    buffer_load_dwordx4 v0, s[4:7], s97 offen offset:0 sc1 lds
    buffer_load_dwordx4 v0, s[4:7], s97 offen offset:1024 sc1 lds
    buffer_load_dwordx4 v0, s[4:7], s97 offen offset:2048 sc1 lds
    buffer_load_dwordx4 v0, s[4:7], s97 offen offset:3072 sc1 lds
    s_add_u32 s96, s100, 65536
    s_add_u32 s97, s96, s98
    s_add_u32 m0, s96, 0
    s_nop 0
    buffer_load_dwordx4 v0, s[4:7], s97 offen offset:0 sc1 lds
    buffer_load_dwordx4 v0, s[4:7], s97 offen offset:1024 sc1 lds
    buffer_load_dwordx4 v0, s[4:7], s97 offen offset:2048 sc1 lds
    buffer_load_dwordx4 v0, s[4:7], s97 offen offset:3072 sc1 lds
    s_waitcnt vmcnt(16)
    v_mov_b32 v38, 163632
    v_mov_b32 v39, 2
    s_mov_b64 exec, 1
    ds_add_u32 v38, v39 offset:0
    s_mov_b64 exec, -1
    s_add_u32 s96, s100, 73728
    s_add_u32 s97, s96, s98
    s_add_u32 m0, s96, 0
    s_nop 0
    buffer_load_dwordx4 v0, s[4:7], s97 offen offset:0 sc1 lds
    buffer_load_dwordx4 v0, s[4:7], s97 offen offset:1024 sc1 lds
    buffer_load_dwordx4 v0, s[4:7], s97 offen offset:2048 sc1 lds
    buffer_load_dwordx4 v0, s[4:7], s97 offen offset:3072 sc1 lds
    s_add_u32 s96, s100, 81920
    s_add_u32 s97, s96, s98
    s_add_u32 m0, s96, 0
    s_nop 0
    buffer_load_dwordx4 v0, s[4:7], s97 offen offset:0 sc1 lds
    buffer_load_dwordx4 v0, s[4:7], s97 offen offset:1024 sc1 lds
    buffer_load_dwordx4 v0, s[4:7], s97 offen offset:2048 sc1 lds
    buffer_load_dwordx4 v0, s[4:7], s97 offen offset:3072 sc1 lds
    s_waitcnt vmcnt(16)
    v_mov_b32 v38, 163632
    v_mov_b32 v39, 2
    s_mov_b64 exec, 1
    ds_add_u32 v38, v39 offset:4
    s_mov_b64 exec, -1
    s_add_u32 s96, s100, 90112
    s_add_u32 s97, s96, s98
    s_add_u32 m0, s96, 0
    s_nop 0
    buffer_load_dwordx4 v0, s[4:7], s97 offen offset:0 sc1 lds
    buffer_load_dwordx4 v0, s[4:7], s97 offen offset:1024 sc1 lds
    buffer_load_dwordx4 v0, s[4:7], s97 offen offset:2048 sc1 lds
    buffer_load_dwordx4 v0, s[4:7], s97 offen offset:3072 sc1 lds
    s_add_u32 s96, s100, 98304
    s_add_u32 s97, s96, s98
    s_add_u32 m0, s96, 0
    s_nop 0
    buffer_load_dwordx4 v0, s[4:7], s97 offen offset:0 sc1 lds
    buffer_load_dwordx4 v0, s[4:7], s97 offen offset:1024 sc1 lds
    buffer_load_dwordx4 v0, s[4:7], s97 offen offset:2048 sc1 lds
    buffer_load_dwordx4 v0, s[4:7], s97 offen offset:3072 sc1 lds
    s_add_u32 s96, s100, 106496
    s_add_u32 s97, s96, s98
    s_add_u32 m0, s96, 0
    s_nop 0
    buffer_load_dwordx4 v0, s[4:7], s97 offen offset:0 sc1 lds
    buffer_load_dwordx4 v0, s[4:7], s97 offen offset:1024 sc1 lds
    buffer_load_dwordx4 v0, s[4:7], s97 offen offset:2048 sc1 lds
    buffer_load_dwordx4 v0, s[4:7], s97 offen offset:3072 sc1 lds
    s_add_u32 s96, s100, 114688
    s_min_u32 s96, s96, 124928
    s_add_u32 s97, s96, s98
    s_add_u32 m0, s96, 0
    s_nop 0
    buffer_load_dwordx4 v0, s[4:7], s97 offen offset:0 sc1 lds
    buffer_load_dwordx4 v0, s[4:7], s97 offen offset:1024 sc1 lds
    buffer_load_dwordx4 v0, s[4:7], s97 offen offset:2048 sc1 lds
    buffer_load_dwordx4 v0, s[4:7], s97 offen offset:3072 sc1 lds
    v_mov_b32 v38, 163632
    v_mov_b32 v39, 1
    s_mov_b64 exec, 1
    ds_add_u32 v38, v39 offset:24
    s_mov_b64 exec, -1
    s_waitcnt vmcnt(16)
    v_mov_b32 v38, 163632
    v_mov_b32 v39, 1
    s_mov_b64 exec, 1
    ds_add_u32 v38, v39 offset:8
    s_mov_b64 exec, -1
HC_81:
    s_mul_i32 s34, s21, 5
    s_add_u32 s35, s34, 4
    s_add_u32 s34, s34, s17
    s_add_u32 s36, s17, 39
    s_cmp_eq_u32 s17, 0
    s_cselect_b32 s35, s35, s36
    s_mul_i32 s34, s34, 1152
    s_mul_i32 s35, s35, 1152
    s_add_u32 s34, s34, 5505024
    s_add_u32 s35, s35, 5505024
    v_lshlrev_b32 v24, 2, v3
    s_mul_i32 s99, s21, 92160
    s_add_u32 s99, s99, 3145728
    s_add_u32 s98, s99, 737280
    ds_read_b32 v36, v38 offset:24
    s_waitcnt lgkmcnt(0)
    v_cmp_gt_u32 vcc, 3, v36
    s_nop 0
    s_cbranch_vccnz SPINC_95
SPIND_94:
    s_add_u32 s28, s24, 2359296
    buffer_load_dword v36, v33, s[4:7], s28 offen
    s_add_u32 s28, s24, 0
    buffer_load_dword v36, v33, s[4:7], s28 offen
    s_add_u32 s28, s89, s25
    s_add_u32 s28, s28, 0
    buffer_load_dword v37, v22, s[4:7], s28 offen
    s_lshl_b32 s28, s16, 2
    s_add_u32 s28, s28, s17
    s_lshl_b32 s28, s28, 7
    s_add_u32 s28, s28, 25165824
    s_lshl_b32 s29, s16, 7
    s_lshl_b32 s31, s17, 15
    s_add_u32 s29, s29, s31
    s_add_u32 s29, s29, 25296896
    s_sub_u32 s29, s29, s28
    v_and_b32 v15, 1, v3
    v_mul_lo_u32 v15, v15, s29
    buffer_load_dword v35, v15, s[4:7], s28 offen
    s_waitcnt vmcnt(4)
    s_barrier
L_HCHAIN:
    s_add_u32 s96, s100, 0
    s_add_u32 s97, s96, s98
    buffer_load_dwordx4 v[40:43], v0, s[4:7], s97 offen offset:0 sc1
    buffer_load_dwordx4 v[44:47], v0, s[4:7], s97 offen offset:1024 sc1
    buffer_load_dwordx4 v[48:51], v0, s[4:7], s97 offen offset:2048 sc1
    buffer_load_dwordx4 v[52:55], v0, s[4:7], s97 offen offset:3072 sc1
    s_add_u32 s96, s100, 16384
    s_add_u32 s97, s96, s98
    buffer_load_dwordx4 v[56:59], v0, s[4:7], s97 offen offset:0 sc1
    buffer_load_dwordx4 v[60:63], v0, s[4:7], s97 offen offset:1024 sc1
    buffer_load_dwordx4 v[64:67], v0, s[4:7], s97 offen offset:2048 sc1
    buffer_load_dwordx4 v[68:71], v0, s[4:7], s97 offen offset:3072 sc1
    s_add_u32 s96, s100, 32768
    s_add_u32 s97, s96, s98
    buffer_load_dwordx4 v[72:75], v0, s[4:7], s97 offen offset:0 sc1
    buffer_load_dwordx4 v[76:79], v0, s[4:7], s97 offen offset:1024 sc1
    buffer_load_dwordx4 v[80:83], v0, s[4:7], s97 offen offset:2048 sc1
    buffer_load_dwordx4 v[84:87], v0, s[4:7], s97 offen offset:3072 sc1
    s_add_u32 s96, s100, 49152
    s_add_u32 s97, s96, s98
    buffer_load_dwordx4 v[88:91], v0, s[4:7], s97 offen offset:0 sc1
    buffer_load_dwordx4 v[92:95], v0, s[4:7], s97 offen offset:1024 sc1
    buffer_load_dwordx4 v[96:99], v0, s[4:7], s97 offen offset:2048 sc1
    buffer_load_dwordx4 v[100:103], v0, s[4:7], s97 offen offset:3072 sc1
    s_add_u32 s96, s100, 65536
    s_add_u32 s97, s96, s98
    buffer_load_dwordx4 v[104:107], v0, s[4:7], s97 offen offset:0 sc1
    buffer_load_dwordx4 v[108:111], v0, s[4:7], s97 offen offset:1024 sc1
    buffer_load_dwordx4 v[112:115], v0, s[4:7], s97 offen offset:2048 sc1
    buffer_load_dwordx4 v[116:119], v0, s[4:7], s97 offen offset:3072 sc1
    s_add_u32 s96, s100, 81920
    s_min_u32 s96, s96, 88064
    s_add_u32 s97, s96, s98
    buffer_load_dwordx4 v[120:123], v0, s[4:7], s97 offen offset:0 sc1
    buffer_load_dwordx4 v[124:127], v0, s[4:7], s97 offen offset:1024 sc1
    buffer_load_dwordx4 v[128:131], v0, s[4:7], s97 offen offset:2048 sc1
    buffer_load_dwordx4 v[132:135], v0, s[4:7], s97 offen offset:3072 sc1
    s_waitcnt lgkmcnt(0)
    s_barrier
    s_add_u32 s96, s100, 0
    s_add_u32 s97, s96, s99
    s_add_u32 m0, s96, 0
    s_nop 0
    buffer_load_dwordx4 v0, s[4:7], s97 offen offset:0 sc1 lds
    buffer_load_dwordx4 v0, s[4:7], s97 offen offset:1024 sc1 lds
    buffer_load_dwordx4 v0, s[4:7], s97 offen offset:2048 sc1 lds
    buffer_load_dwordx4 v0, s[4:7], s97 offen offset:3072 sc1 lds
    s_add_u32 s96, s100, 16384
    s_add_u32 s97, s96, s99
    s_add_u32 m0, s96, 0
    s_nop 0
    buffer_load_dwordx4 v0, s[4:7], s97 offen offset:0 sc1 lds
    buffer_load_dwordx4 v0, s[4:7], s97 offen offset:1024 sc1 lds
    buffer_load_dwordx4 v0, s[4:7], s97 offen offset:2048 sc1 lds
    buffer_load_dwordx4 v0, s[4:7], s97 offen offset:3072 sc1 lds
    s_barrier
    s_add_u32 s96, s100, 32768
    s_add_u32 s97, s96, s99
    s_add_u32 m0, s96, 0
    s_nop 0
    buffer_load_dwordx4 v0, s[4:7], s97 offen offset:0 sc1 lds
    buffer_load_dwordx4 v0, s[4:7], s97 offen offset:1024 sc1 lds
    buffer_load_dwordx4 v0, s[4:7], s97 offen offset:2048 sc1 lds
    buffer_load_dwordx4 v0, s[4:7], s97 offen offset:3072 sc1 lds
    s_add_u32 s96, s100, 49152
    s_add_u32 s97, s96, s99
    s_add_u32 m0, s96, 0
    s_nop 0
    buffer_load_dwordx4 v0, s[4:7], s97 offen offset:0 sc1 lds
    buffer_load_dwordx4 v0, s[4:7], s97 offen offset:1024 sc1 lds
    buffer_load_dwordx4 v0, s[4:7], s97 offen offset:2048 sc1 lds
    buffer_load_dwordx4 v0, s[4:7], s97 offen offset:3072 sc1 lds
    s_add_u32 s96, s100, 65536
    s_add_u32 s97, s96, s99
    s_add_u32 m0, s96, 0
    s_nop 0
    buffer_load_dwordx4 v0, s[4:7], s97 offen offset:0 sc1 lds
    buffer_load_dwordx4 v0, s[4:7], s97 offen offset:1024 sc1 lds
    buffer_load_dwordx4 v0, s[4:7], s97 offen offset:2048 sc1 lds
    buffer_load_dwordx4 v0, s[4:7], s97 offen offset:3072 sc1 lds
    s_add_u32 s96, s100, 81920
    s_min_u32 s96, s96, 88064
    s_add_u32 s97, s96, s99
    s_add_u32 m0, s96, 0
    s_nop 0
    buffer_load_dwordx4 v0, s[4:7], s97 offen offset:0 sc1 lds
    buffer_load_dwordx4 v0, s[4:7], s97 offen offset:1024 sc1 lds
    buffer_load_dwordx4 v0, s[4:7], s97 offen offset:2048 sc1 lds
    buffer_load_dwordx4 v0, s[4:7], s97 offen offset:3072 sc1 lds
    s_cmp_eq_u32 s19, 0
    s_cbranch_scc1 FIRST_97
    s_waitcnt vmcnt(0)
    s_barrier
    s_branch HAVEQ_96
FIRST_97:
    s_lshr_b32 s31, s21, 2
    s_mul_i32 s31, s31, 36864
    s_add_u32 s31, s31, 5373952
    s_add_u32 s96, s100, 0
    s_add_u32 s97, s96, s31
    buffer_load_dwordx4 v[192:195], v0, s[4:7], s97 offen offset:0 sc1
    buffer_load_dwordx4 v[196:199], v0, s[4:7], s97 offen offset:1024 sc1
    buffer_load_dwordx4 v[200:203], v0, s[4:7], s97 offen offset:2048 sc1
    buffer_load_dwordx4 v[204:207], v0, s[4:7], s97 offen offset:3072 sc1
    s_add_u32 s96, s100, 16384
    s_add_u32 s97, s96, s31
    buffer_load_dwordx4 v[208:211], v0, s[4:7], s97 offen offset:0 sc1
    buffer_load_dwordx4 v[212:215], v0, s[4:7], s97 offen offset:1024 sc1
    buffer_load_dwordx4 v[216:219], v0, s[4:7], s97 offen offset:2048 sc1
    buffer_load_dwordx4 v[220:223], v0, s[4:7], s97 offen offset:3072 sc1
    s_add_u32 s97, s31, s82
    s_add_u32 s97, s97, 32768
    buffer_load_dwordx4 v[224:227], v0, s[4:7], s97 offen sc1
    buffer_load_dword v140, v24, s[4:7], s34 offen offset:0 sc1
    buffer_load_dword v141, v24, s[4:7], s34 offen offset:256 sc1
    buffer_load_dword v142, v24, s[4:7], s34 offen offset:512 sc1
    buffer_load_dword v143, v24, s[4:7], s34 offen offset:768 sc1
    buffer_load_dword v144, v24, s[4:7], s34 offen offset:1024 sc1
    buffer_load_dword v145, v24, s[4:7], s35 offen offset:0 sc1
    buffer_load_dword v146, v24, s[4:7], s35 offen offset:256 sc1
    buffer_load_dword v147, v24, s[4:7], s35 offen offset:512 sc1
    buffer_load_dword v148, v24, s[4:7], s35 offen offset:768 sc1
    buffer_load_dword v149, v24, s[4:7], s35 offen offset:1024 sc1
    s_waitcnt vmcnt(19)
    s_barrier
    s_waitcnt vmcnt(0)
    v_cmp_gt_u32 vcc, 32, v3
    s_nop 1
    v_cndmask_b32 v144, 0, v144, vcc
    v_add_f32 v140, v140, v141
    v_add_f32 v142, v142, v143
    v_add_f32 v140, v140, v144
    v_add_f32 v140, v140, v142
    v_mov_b32 v141, v140
    s_nop 1
    v_permlane32_swap_b32 v140, v141
    v_add_f32 v140, v140, v141
    v_mov_b32 v141, v140
    s_nop 1
    v_permlane16_swap_b32 v140, v141
    v_add_f32 v140, v140, v141
    v_cndmask_b32 v149, 0, v149, vcc
    v_add_f32 v145, v145, v146
    v_add_f32 v147, v147, v148
    v_add_f32 v145, v145, v149
    v_add_f32 v145, v145, v147
    v_mov_b32 v146, v145
    s_nop 1
    v_permlane32_swap_b32 v145, v146
    v_add_f32 v145, v145, v146
    v_mov_b32 v146, v145
    s_nop 1
    v_permlane16_swap_b32 v145, v146
    v_add_f32 v145, v145, v146
    s_lshl_b32 s28, s17, 6
    s_add_u32 s28, s28, 160960
    v_lshl_add_u32 v24, v20, 2, s28
    ds_write_b32 v24, v140
    ds_write_b32 v24, v145 offset:256
HAVEQ_96:
    s_add_u32 s96, s100, 0
    s_add_u32 s96, s96, 92160
    v_add_u32 v25, s96, v0
    ds_write_b128 v25, v[192:195] offset:0
    ds_write_b128 v25, v[196:199] offset:1024
    ds_write_b128 v25, v[200:203] offset:2048
    ds_write_b128 v25, v[204:207] offset:3072
    s_add_u32 s96, s100, 16384
    s_add_u32 s96, s96, 92160
    v_add_u32 v26, s96, v0
    ds_write_b128 v26, v[208:211] offset:0
    ds_write_b128 v26, v[212:215] offset:1024
    ds_write_b128 v26, v[216:219] offset:2048
    ds_write_b128 v26, v[220:223] offset:3072
    s_add_u32 s96, s82, 124928
    v_add_u32 v25, s96, v0
    ds_write_b128 v25, v[224:227]
    s_waitcnt vmcnt(0) lgkmcnt(0)
    s_barrier
    s_add_u32 s96, s100, 0
    v_add_u32 v25, s96, v0
    ds_write_b128 v25, v[40:43] offset:0
    ds_write_b128 v25, v[44:47] offset:1024
    ds_write_b128 v25, v[48:51] offset:2048
    ds_write_b128 v25, v[52:55] offset:3072
    s_add_u32 s96, s100, 16384
    v_add_u32 v26, s96, v0
    ds_write_b128 v26, v[56:59] offset:0
    ds_write_b128 v26, v[60:63] offset:1024
    ds_write_b128 v26, v[64:67] offset:2048
    ds_write_b128 v26, v[68:71] offset:3072
    s_add_u32 s96, s100, 32768
    v_add_u32 v25, s96, v0
    ds_write_b128 v25, v[72:75] offset:0
    ds_write_b128 v25, v[76:79] offset:1024
    ds_write_b128 v25, v[80:83] offset:2048
    ds_write_b128 v25, v[84:87] offset:3072
    s_add_u32 s96, s100, 49152
    v_add_u32 v26, s96, v0
    ds_write_b128 v26, v[88:91] offset:0
    ds_write_b128 v26, v[92:95] offset:1024
    ds_write_b128 v26, v[96:99] offset:2048
    ds_write_b128 v26, v[100:103] offset:3072
    s_add_u32 s96, s100, 65536
    v_add_u32 v25, s96, v0
    ds_write_b128 v25, v[104:107] offset:0
    ds_write_b128 v25, v[108:111] offset:1024
    ds_write_b128 v25, v[112:115] offset:2048
    ds_write_b128 v25, v[116:119] offset:3072
    s_add_u32 s96, s100, 81920
    s_min_u32 s96, s96, 88064
    v_add_u32 v26, s96, v0
    ds_write_b128 v26, v[120:123] offset:0
    ds_write_b128 v26, v[124:127] offset:1024
    ds_write_b128 v26, v[128:131] offset:2048
    ds_write_b128 v26, v[132:135] offset:3072
    v_lshlrev_b32 v14, 7, v3
    s_lshr_b32 s28, s16, 6
    s_add_u32 s28, s28, s17
    s_add_u32 s28, s28, 1
    s_and_b32 s28, s28, 3
    s_lshl_b32 s30, s19, 15
    s_lshl_b32 s31, s28, 13
    s_add_u32 s30, s30, s31
    s_add_u32 s30, s30, 25296896
    s_add_u32 s31, s18, 1
    s_mul_i32 s98, s19, 163840
    s_mul_i32 s28, s28, 37888
    s_add_u32 s98, s98, s28
    s_add_u32 s98, s98, 131072
    s_mul_i32 s32, s17, 37888
    s_add_u32 s99, s99, 1474560
    s_lshl_b32 s33, s19, 1
    s_add_u32 s33, s33, 1
    s_lshl_b32 s73, s19, 2
    s_add_u32 s73, s73, 11
    s_sub_u32 s73, s73, s17
    s_lshl_b32 s73, 1, s73
    s_bfe_u32 s81, s16, 0x10005
    s_lshl_b32 s79, s81, 12
    s_xor_b32 s80, s79, 0x1000
    s_add_u32 s79, s79, s30
    s_add_u32 s79, s79, 65536
    s_add_u32 s80, s80, s30
    s_mul_i32 s81, s81, 18944
    s_lshl_b32 s28, s17, 2
    s_add_u32 s28, s28, 163584
    v_mov_b32 v36, s28
    v_mov_b32 v37, 163632
    s_waitcnt lgkmcnt(0)
    s_barrier
    s_cmp_eq_u32 s17, 3
    s_cbranch_scc1 R3_98
    s_barrier
    s_mov_b32 s70, 0
POLL_101:
    buffer_load_dwordx2 v[34:35], v14, s[4:7], s30 offen sc1
    s_waitcnt vmcnt(0)
    v_subrev_u32 v15, s31, v34
    v_cmp_le_u32 vcc, 16, v15
    s_add_u32 s70, s70, 1
    s_cmp_gt_u32 s70, 200000
    s_cbranch_scc1 POLLD_102
    s_cbranch_vccnz POLL_101
POLLD_102:
    s_setprio 2
    v_mov_b32 v34, v35
    s_nop 1
    v_permlane32_swap_b32 v35, v34
    v_max_f32 v35, v35, v34
    v_mov_b32 v34, v35
    s_nop 1
    v_permlane16_swap_b32 v35, v34
    v_max_f32 v35, v35, v34
    s_nop 1
    v_max_f32_dpp v35, v35, v35 row_ror:8 row_mask:0xf bank_mask:0xf
    s_nop 1
    v_max_f32_dpp v35, v35, v35 row_ror:4 row_mask:0xf bank_mask:0xf
    s_nop 1
    v_max_f32_dpp v35, v35, v35 row_ror:2 row_mask:0xf bank_mask:0xf
    s_nop 1
    v_max_f32_dpp v35, v35, v35 row_ror:1 row_mask:0xf bank_mask:0xf
    ds_write_b32 v36, v35 offset:0
    s_setprio 0
    s_add_u32 s97, s98, 0
    s_add_u32 m0, s32, 0
    s_nop 0
    buffer_load_dwordx4 v0, s[4:7], s97 offen offset:0 sc1 lds
    buffer_load_dwordx4 v0, s[4:7], s97 offen offset:1024 sc1 lds
    buffer_load_dwordx4 v0, s[4:7], s97 offen offset:2048 sc1 lds
    buffer_load_dwordx4 v0, s[4:7], s97 offen offset:3072 sc1 lds
    s_add_u32 s97, s98, 4096
    s_add_u32 m0, s32, 4096
    s_nop 0
    buffer_load_dwordx4 v0, s[4:7], s97 offen offset:0 sc1 lds
    buffer_load_dwordx4 v0, s[4:7], s97 offen offset:1024 sc1 lds
    buffer_load_dwordx4 v0, s[4:7], s97 offen offset:2048 sc1 lds
    buffer_load_dwordx4 v0, s[4:7], s97 offen offset:3072 sc1 lds
    s_add_u32 s97, s98, 8192
    s_add_u32 m0, s32, 8192
    s_nop 0
    buffer_load_dwordx4 v0, s[4:7], s97 offen offset:0 sc1 lds
    buffer_load_dwordx4 v0, s[4:7], s97 offen offset:1024 sc1 lds
    buffer_load_dwordx4 v0, s[4:7], s97 offen offset:2048 sc1 lds
    buffer_load_dwordx4 v0, s[4:7], s97 offen offset:3072 sc1 lds
    s_add_u32 s97, s98, 12288
    s_add_u32 m0, s32, 12288
    s_nop 0
    buffer_load_dwordx4 v0, s[4:7], s97 offen offset:0 sc1 lds
    buffer_load_dwordx4 v0, s[4:7], s97 offen offset:1024 sc1 lds
    buffer_load_dwordx4 v0, s[4:7], s97 offen offset:2048 sc1 lds
    buffer_load_dwordx4 v0, s[4:7], s97 offen offset:3072 sc1 lds
    s_add_u32 s97, s98, 16384
    s_add_u32 m0, s32, 16384
    s_nop 0
    buffer_load_dwordx4 v0, s[4:7], s97 offen offset:0 sc1 lds
    buffer_load_dwordx4 v0, s[4:7], s97 offen offset:1024 sc1 lds
    buffer_load_dwordx4 v0, s[4:7], s97 offen offset:2048 sc1 lds
    buffer_load_dwordx4 v0, s[4:7], s97 offen offset:3072 sc1 lds
    s_add_u32 s97, s98, 20480
    s_add_u32 m0, s32, 20480
    s_nop 0
    buffer_load_dwordx4 v0, s[4:7], s97 offen offset:0 sc1 lds
    buffer_load_dwordx4 v0, s[4:7], s97 offen offset:1024 sc1 lds
    buffer_load_dwordx4 v0, s[4:7], s97 offen offset:2048 sc1 lds
    buffer_load_dwordx4 v0, s[4:7], s97 offen offset:3072 sc1 lds
    s_add_u32 s97, s98, 24576
    s_add_u32 m0, s32, 24576
    s_nop 0
    buffer_load_dwordx4 v0, s[4:7], s97 offen offset:0 sc1 lds
    buffer_load_dwordx4 v0, s[4:7], s97 offen offset:1024 sc1 lds
    buffer_load_dwordx4 v0, s[4:7], s97 offen offset:2048 sc1 lds
    buffer_load_dwordx4 v0, s[4:7], s97 offen offset:3072 sc1 lds
    s_add_u32 s97, s98, 28672
    s_add_u32 m0, s32, 28672
    s_nop 0
    buffer_load_dwordx4 v0, s[4:7], s97 offen offset:0 sc1 lds
    buffer_load_dwordx4 v0, s[4:7], s97 offen offset:1024 sc1 lds
    buffer_load_dwordx4 v0, s[4:7], s97 offen offset:2048 sc1 lds
    buffer_load_dwordx4 v0, s[4:7], s97 offen offset:3072 sc1 lds
    s_add_u32 s97, s98, 32768
    s_add_u32 m0, s32, 32768
    s_nop 0
    buffer_load_dwordx4 v0, s[4:7], s97 offen offset:0 sc1 lds
    buffer_load_dwordx4 v0, s[4:7], s97 offen offset:1024 sc1 lds
    buffer_load_dwordx4 v0, s[4:7], s97 offen offset:2048 sc1 lds
    buffer_load_dwordx4 v0, s[4:7], s97 offen offset:3072 sc1 lds
    s_add_u32 s97, s98, 36864
    s_add_u32 m0, s32, 36864
    s_nop 0
    buffer_load_dwordx4 v0, s[4:7], s97 offen offset:0 sc1 lds
    s_branch R3B_99
R3_98:
    v_and_b32 v14, 0xfff, v14
    s_add_u32 s71, s98, s81
    s_mov_b32 s72, 132608
    ds_read_b32 v35, v37 offset:12
    s_waitcnt lgkmcnt(0)
    v_cmp_gt_u32 vcc, s33, v35
    s_nop 0
    s_cbranch_vccnz SPINC_105
SPIND_104:
    s_mov_b32 s70, 0
POLL_106:
    buffer_load_dwordx2 v[34:35], v14, s[4:7], s79 offen sc1
    s_waitcnt vmcnt(0)
    v_subrev_u32 v15, s31, v34
    v_cmp_le_u32 vcc, 16, v15
    s_add_u32 s70, s70, 1
    s_cmp_gt_u32 s70, 200000
    s_cbranch_scc1 POLLD_107
    s_cbranch_vccnz POLL_106
POLLD_107:
    s_add_u32 s97, s71, 0
    s_add_u32 m0, s72, 0
    s_nop 0
    buffer_load_dwordx4 v0, s[4:7], s97 offen offset:0 sc1 lds
    buffer_load_dwordx4 v0, s[4:7], s97 offen offset:1024 sc1 lds
    buffer_load_dwordx4 v0, s[4:7], s97 offen offset:2048 sc1 lds
    buffer_load_dwordx4 v0, s[4:7], s97 offen offset:3072 sc1 lds
    s_add_u32 s97, s71, 4096
    s_add_u32 m0, s72, 4096
    s_nop 0
    buffer_load_dwordx4 v0, s[4:7], s97 offen offset:0 sc1 lds
    buffer_load_dwordx4 v0, s[4:7], s97 offen offset:1024 sc1 lds
    buffer_load_dwordx4 v0, s[4:7], s97 offen offset:2048 sc1 lds
    buffer_load_dwordx4 v0, s[4:7], s97 offen offset:3072 sc1 lds
    s_add_u32 s97, s71, 8192
    s_add_u32 m0, s72, 8192
    s_nop 0
    buffer_load_dwordx4 v0, s[4:7], s97 offen offset:0 sc1 lds
    buffer_load_dwordx4 v0, s[4:7], s97 offen offset:1024 sc1 lds
    buffer_load_dwordx4 v0, s[4:7], s97 offen offset:2048 sc1 lds
    buffer_load_dwordx4 v0, s[4:7], s97 offen offset:3072 sc1 lds
    s_add_u32 s97, s71, 12288
    s_add_u32 m0, s72, 12288
    s_nop 0
    buffer_load_dwordx4 v0, s[4:7], s97 offen offset:0 sc1 lds
    buffer_load_dwordx4 v0, s[4:7], s97 offen offset:1024 sc1 lds
    buffer_load_dwordx4 v0, s[4:7], s97 offen offset:2048 sc1 lds
    buffer_load_dwordx4 v0, s[4:7], s97 offen offset:3072 sc1 lds
    s_add_u32 s97, s71, 16384
    s_add_u32 m0, s72, 16384
    s_nop 0
    buffer_load_dwordx4 v0, s[4:7], s97 offen offset:0 sc1 lds
    buffer_load_dwordx4 v0, s[4:7], s97 offen offset:1024 sc1 lds
    s_mov_b32 exec_hi, 0
    buffer_load_dwordx4 v0, s[4:7], s97 offen offset:2048 sc1 lds
    s_mov_b64 exec, -1
    s_setprio 2
    v_mov_b32 v34, v35
    s_nop 1
    v_permlane32_swap_b32 v35, v34
    v_max_f32 v35, v35, v34
    v_mov_b32 v34, v35
    s_nop 1
    v_permlane16_swap_b32 v35, v34
    v_max_f32 v35, v35, v34
    s_nop 1
    v_max_f32_dpp v35, v35, v35 row_ror:8 row_mask:0xf bank_mask:0xf
    s_nop 1
    v_max_f32_dpp v35, v35, v35 row_ror:4 row_mask:0xf bank_mask:0xf
    s_nop 1
    v_max_f32_dpp v35, v35, v35 row_ror:2 row_mask:0xf bank_mask:0xf
    s_nop 1
    v_max_f32_dpp v35, v35, v35 row_ror:1 row_mask:0xf bank_mask:0xf
    ds_write_b32 v36, v35 offset:20
    s_setprio 0
    v_mov_b32 v38, 163632
    v_mov_b32 v39, 1
    s_mov_b64 exec, 1
    ds_add_u32 v38, v39 offset:12
    s_mov_b64 exec, -1
    s_sub_u32 s71, s98, s81
    s_add_u32 s71, s71, 18944
    buffer_load_dwordx2 v[34:35], v14, s[4:7], s80 offen sc1
    s_waitcnt vmcnt(0)
    v_subrev_u32 v15, s31, v34
    v_cmp_le_u32 vcc, 16, v15
    s_barrier
    s_cbranch_vccz PART_108
    s_setprio 2
    s_mov_b32 s70, 0
POLL_109:
    buffer_load_dwordx2 v[34:35], v14, s[4:7], s80 offen sc1
    s_waitcnt vmcnt(0)
    v_subrev_u32 v15, s31, v34
    v_cmp_le_u32 vcc, 16, v15
    s_add_u32 s70, s70, 1
    s_cmp_gt_u32 s70, 200000
    s_cbranch_scc1 POLLD_110
    s_cbranch_vccnz POLL_109
POLLD_110:
    s_setprio 0
PART_108:
    s_add_u32 s97, s71, 0
    s_add_u32 m0, s32, 0
    s_nop 0
    buffer_load_dwordx4 v0, s[4:7], s97 offen offset:0 sc1 lds
    buffer_load_dwordx4 v0, s[4:7], s97 offen offset:1024 sc1 lds
    buffer_load_dwordx4 v0, s[4:7], s97 offen offset:2048 sc1 lds
    buffer_load_dwordx4 v0, s[4:7], s97 offen offset:3072 sc1 lds
    s_add_u32 s97, s71, 4096
    s_add_u32 m0, s32, 4096
    s_nop 0
    buffer_load_dwordx4 v0, s[4:7], s97 offen offset:0 sc1 lds
    buffer_load_dwordx4 v0, s[4:7], s97 offen offset:1024 sc1 lds
    buffer_load_dwordx4 v0, s[4:7], s97 offen offset:2048 sc1 lds
    buffer_load_dwordx4 v0, s[4:7], s97 offen offset:3072 sc1 lds
    s_add_u32 s97, s71, 8192
    s_add_u32 m0, s32, 8192
    s_nop 0
    buffer_load_dwordx4 v0, s[4:7], s97 offen offset:0 sc1 lds
    buffer_load_dwordx4 v0, s[4:7], s97 offen offset:1024 sc1 lds
    buffer_load_dwordx4 v0, s[4:7], s97 offen offset:2048 sc1 lds
    buffer_load_dwordx4 v0, s[4:7], s97 offen offset:3072 sc1 lds
    s_add_u32 s97, s71, 12288
    s_add_u32 m0, s32, 12288
    s_nop 0
    buffer_load_dwordx4 v0, s[4:7], s97 offen offset:0 sc1 lds
    buffer_load_dwordx4 v0, s[4:7], s97 offen offset:1024 sc1 lds
    buffer_load_dwordx4 v0, s[4:7], s97 offen offset:2048 sc1 lds
    buffer_load_dwordx4 v0, s[4:7], s97 offen offset:3072 sc1 lds
    s_add_u32 s97, s71, 16384
    s_add_u32 m0, s32, 16384
    s_nop 0
    buffer_load_dwordx4 v0, s[4:7], s97 offen offset:0 sc1 lds
    buffer_load_dwordx4 v0, s[4:7], s97 offen offset:1024 sc1 lds
    s_mov_b32 exec_hi, 0
    buffer_load_dwordx4 v0, s[4:7], s97 offen offset:2048 sc1 lds
    s_mov_b64 exec, -1
    s_setprio 2
    v_mov_b32 v34, v35
    s_nop 1
    v_permlane32_swap_b32 v35, v34
    v_max_f32 v35, v35, v34
    v_mov_b32 v34, v35
    s_nop 1
    v_permlane16_swap_b32 v35, v34
    v_max_f32 v35, v35, v34
    s_nop 1
    v_max_f32_dpp v35, v35, v35 row_ror:8 row_mask:0xf bank_mask:0xf
    s_nop 1
    v_max_f32_dpp v35, v35, v35 row_ror:4 row_mask:0xf bank_mask:0xf
    s_nop 1
    v_max_f32_dpp v35, v35, v35 row_ror:2 row_mask:0xf bank_mask:0xf
    s_nop 1
    v_max_f32_dpp v35, v35, v35 row_ror:1 row_mask:0xf bank_mask:0xf
    ds_write_b32 v36, v35 offset:0
    s_setprio 0
R3B_99:
    s_waitcnt vmcnt(0)
    v_mov_b32 v38, 163632
    v_mov_b32 v39, s73
    s_mov_b64 exec, 1
    ds_add_u32 v38, v39 offset:16
    s_mov_b64 exec, -1
    s_mul_i32 s98, s23, 129024
    s_add_u32 s98, s98, 1048576
    s_cmp_eq_u32 s19, 1
    s_cbranch_scc1 NOWA_111
    s_add_u32 s96, s100, 0
    s_add_u32 s97, s96, s98
    buffer_load_dwordx4 v[64:67], v0, s[4:7], s97 offen offset:0 sc1
    buffer_load_dwordx4 v[68:71], v0, s[4:7], s97 offen offset:1024 sc1
    buffer_load_dwordx4 v[72:75], v0, s[4:7], s97 offen offset:2048 sc1
    buffer_load_dwordx4 v[76:79], v0, s[4:7], s97 offen offset:3072 sc1
    s_add_u32 s96, s100, 16384
    s_add_u32 s97, s96, s98
    buffer_load_dwordx4 v[80:83], v0, s[4:7], s97 offen offset:0 sc1
    buffer_load_dwordx4 v[84:87], v0, s[4:7], s97 offen offset:1024 sc1
    buffer_load_dwordx4 v[88:91], v0, s[4:7], s97 offen offset:2048 sc1
    buffer_load_dwordx4 v[92:95], v0, s[4:7], s97 offen offset:3072 sc1
    s_add_u32 s96, s100, 32768
    s_add_u32 s97, s96, s98
    buffer_load_dwordx4 v[96:99], v0, s[4:7], s97 offen offset:0 sc1
    buffer_load_dwordx4 v[100:103], v0, s[4:7], s97 offen offset:1024 sc1
    buffer_load_dwordx4 v[104:107], v0, s[4:7], s97 offen offset:2048 sc1
    buffer_load_dwordx4 v[108:111], v0, s[4:7], s97 offen offset:3072 sc1
    s_add_u32 s96, s100, 49152
    s_add_u32 s97, s96, s98
    buffer_load_dwordx4 v[112:115], v0, s[4:7], s97 offen offset:0 sc1
    buffer_load_dwordx4 v[116:119], v0, s[4:7], s97 offen offset:1024 sc1
    buffer_load_dwordx4 v[120:123], v0, s[4:7], s97 offen offset:2048 sc1
    buffer_load_dwordx4 v[124:127], v0, s[4:7], s97 offen offset:3072 sc1
    s_add_u32 s96, s100, 65536
    s_add_u32 s97, s96, s98
    buffer_load_dwordx4 v[128:131], v0, s[4:7], s97 offen offset:0 sc1
    buffer_load_dwordx4 v[132:135], v0, s[4:7], s97 offen offset:1024 sc1
    buffer_load_dwordx4 v[136:139], v0, s[4:7], s97 offen offset:2048 sc1
    buffer_load_dwordx4 v[140:143], v0, s[4:7], s97 offen offset:3072 sc1
    s_add_u32 s96, s100, 81920
    s_add_u32 s97, s96, s98
    buffer_load_dwordx4 v[144:147], v0, s[4:7], s97 offen offset:0 sc1
    buffer_load_dwordx4 v[148:151], v0, s[4:7], s97 offen offset:1024 sc1
    buffer_load_dwordx4 v[152:155], v0, s[4:7], s97 offen offset:2048 sc1
    buffer_load_dwordx4 v[156:159], v0, s[4:7], s97 offen offset:3072 sc1
    s_add_u32 s96, s100, 98304
    s_add_u32 s97, s96, s98
    buffer_load_dwordx4 v[160:163], v0, s[4:7], s97 offen offset:0 sc1
    buffer_load_dwordx4 v[164:167], v0, s[4:7], s97 offen offset:1024 sc1
    buffer_load_dwordx4 v[168:171], v0, s[4:7], s97 offen offset:2048 sc1
    buffer_load_dwordx4 v[172:175], v0, s[4:7], s97 offen offset:3072 sc1
    s_add_u32 s96, s100, 114688
    s_min_u32 s96, s96, 124928
    s_add_u32 s97, s96, s98
    buffer_load_dwordx4 v[176:179], v0, s[4:7], s97 offen offset:0 sc1
    buffer_load_dwordx4 v[180:183], v0, s[4:7], s97 offen offset:1024 sc1
    buffer_load_dwordx4 v[184:187], v0, s[4:7], s97 offen offset:2048 sc1
    buffer_load_dwordx4 v[188:191], v0, s[4:7], s97 offen offset:3072 sc1
    v_and_b32 v14, 7, v3
    v_lshlrev_b32 v14, 8, v14
    s_lshl_b32 s30, s22, 11
    s_add_u32 s30, s30, 90112
    buffer_load_dword v36, v14, s[4:7], s30 offen sc1
NOWA_111:
    s_barrier
    s_or_b32 s28, s16, s17
    s_cmp_eq_u32 s28, 0
    s_cselect_b32 s28, 0, 0x7f000000
    v_mov_b32 v34, s18
    s_mov_b64 exec, 1
    buffer_store_dword v34, v22, s[4:7], s28 offen sc1
    s_mov_b64 exec, -1
    s_add_u32 s28, s24, 2359296
    buffer_load_dword v36, v33, s[4:7], s28 offen
    s_add_u32 s28, s24, 0
    buffer_load_dword v36, v33, s[4:7], s28 offen
    s_add_u32 s28, s89, s25
    s_add_u32 s28, s28, 0
    buffer_load_dword v37, v22, s[4:7], s28 offen
    s_add_u32 s96, s100, 0
    s_add_u32 s97, s96, s99
    s_add_u32 m0, s96, 59392
    s_nop 0
    buffer_load_dwordx4 v0, s[4:7], s97 offen offset:0 sc1 lds
    buffer_load_dwordx4 v0, s[4:7], s97 offen offset:1024 sc1 lds
    buffer_load_dwordx4 v0, s[4:7], s97 offen offset:2048 sc1 lds
    buffer_load_dwordx4 v0, s[4:7], s97 offen offset:3072 sc1 lds
    s_add_u32 s96, s100, 16384
    s_add_u32 s97, s96, s99
    s_add_u32 m0, s96, 59392
    s_nop 0
    buffer_load_dwordx4 v0, s[4:7], s97 offen offset:0 sc1 lds
    buffer_load_dwordx4 v0, s[4:7], s97 offen offset:1024 sc1 lds
    buffer_load_dwordx4 v0, s[4:7], s97 offen offset:2048 sc1 lds
    buffer_load_dwordx4 v0, s[4:7], s97 offen offset:3072 sc1 lds
    s_add_u32 s96, s100, 32768
    s_add_u32 s97, s96, s99
    s_add_u32 m0, s96, 59392
    s_nop 0
    buffer_load_dwordx4 v0, s[4:7], s97 offen offset:0 sc1 lds
    buffer_load_dwordx4 v0, s[4:7], s97 offen offset:1024 sc1 lds
    buffer_load_dwordx4 v0, s[4:7], s97 offen offset:2048 sc1 lds
    buffer_load_dwordx4 v0, s[4:7], s97 offen offset:3072 sc1 lds
    s_add_u32 s96, s100, 49152
    s_add_u32 s97, s96, s99
    s_add_u32 m0, s96, 59392
    s_nop 0
    buffer_load_dwordx4 v0, s[4:7], s97 offen offset:0 sc1 lds
    buffer_load_dwordx4 v0, s[4:7], s97 offen offset:1024 sc1 lds
    buffer_load_dwordx4 v0, s[4:7], s97 offen offset:2048 sc1 lds
    buffer_load_dwordx4 v0, s[4:7], s97 offen offset:3072 sc1 lds
    s_add_u32 s96, s100, 65536
    s_add_u32 s97, s96, s99
    s_add_u32 m0, s96, 59392
    s_nop 0
    buffer_load_dwordx4 v0, s[4:7], s97 offen offset:0 sc1 lds
    buffer_load_dwordx4 v0, s[4:7], s97 offen offset:1024 sc1 lds
    buffer_load_dwordx4 v0, s[4:7], s97 offen offset:2048 sc1 lds
    buffer_load_dwordx4 v0, s[4:7], s97 offen offset:3072 sc1 lds
    s_add_u32 s96, s100, 81920
    s_min_u32 s96, s96, 88064
    s_add_u32 s97, s96, s99
    s_add_u32 m0, s96, 59392
    s_nop 0
    buffer_load_dwordx4 v0, s[4:7], s97 offen offset:0 sc1 lds
    buffer_load_dwordx4 v0, s[4:7], s97 offen offset:1024 sc1 lds
    buffer_load_dwordx4 v0, s[4:7], s97 offen offset:2048 sc1 lds
    buffer_load_dwordx4 v0, s[4:7], s97 offen offset:3072 sc1 lds
    s_waitcnt vmcnt(0)
    s_barrier
    s_cmp_eq_u32 s19, 1
    s_cbranch_scc1 HLAST_112
    s_mov_b32 s19, 1
    s_add_u32 s85, s26, 3
    s_add_u32 s26, s26, 4
    s_add_u32 s24, s24, 0
    s_add_u32 s25, s25, 0
    s_add_u32 s96, s100, 0
    v_add_u32 v25, s96, v0
    ds_write_b128 v25, v[64:67] offset:0
    ds_write_b128 v25, v[68:71] offset:1024
    ds_write_b128 v25, v[72:75] offset:2048
    ds_write_b128 v25, v[76:79] offset:3072
    s_add_u32 s96, s100, 16384
    v_add_u32 v26, s96, v0
    ds_write_b128 v26, v[80:83] offset:0
    ds_write_b128 v26, v[84:87] offset:1024
    ds_write_b128 v26, v[88:91] offset:2048
    ds_write_b128 v26, v[92:95] offset:3072
    s_add_u32 s96, s100, 32768
    v_add_u32 v25, s96, v0
    ds_write_b128 v25, v[96:99] offset:0
    ds_write_b128 v25, v[100:103] offset:1024
    ds_write_b128 v25, v[104:107] offset:2048
    ds_write_b128 v25, v[108:111] offset:3072
    v_and_b32 v14, 7, v3
    v_lshlrev_b32 v14, 8, v14
    s_lshl_b32 s30, s22, 11
    s_add_u32 s30, s30, 90112
    s_sub_u32 s98, s99, 737280
    s_barrier
    s_add_u32 s96, s100, 49152
    v_add_u32 v26, s96, v0
    ds_write_b128 v26, v[112:115] offset:0
    ds_write_b128 v26, v[116:119] offset:1024
    ds_write_b128 v26, v[120:123] offset:2048
    ds_write_b128 v26, v[124:127] offset:3072
    s_add_u32 s96, s100, 65536
    v_add_u32 v25, s96, v0
    ds_write_b128 v25, v[128:131] offset:0
    ds_write_b128 v25, v[132:135] offset:1024
    ds_write_b128 v25, v[136:139] offset:2048
    ds_write_b128 v25, v[140:143] offset:3072
    s_add_u32 s96, s100, 81920
    v_add_u32 v26, s96, v0
    ds_write_b128 v26, v[144:147] offset:0
    ds_write_b128 v26, v[148:151] offset:1024
    ds_write_b128 v26, v[152:155] offset:2048
    ds_write_b128 v26, v[156:159] offset:3072
    s_add_u32 s96, s100, 98304
    v_add_u32 v25, s96, v0
    ds_write_b128 v25, v[160:163] offset:0
    ds_write_b128 v25, v[164:167] offset:1024
    ds_write_b128 v25, v[168:171] offset:2048
    ds_write_b128 v25, v[172:175] offset:3072
    s_add_u32 s96, s100, 114688
    s_min_u32 s96, s96, 124928
    v_add_u32 v26, s96, v0
    ds_write_b128 v26, v[176:179] offset:0
    ds_write_b128 v26, v[180:183] offset:1024
    ds_write_b128 v26, v[184:187] offset:2048
    ds_write_b128 v26, v[188:191] offset:3072
    s_mul_i32 s47, s22, 20480
    s_add_u32 s47, s47, 5570560
    v_lshlrev_b32 v24, 8, v3
    v_add_u32 v24, 129024, v24
    ds_write_b128 v24, v[16:19]
    v_lshlrev_b32 v24, 7, v20
    v_add_u32 v24, 145408, v24
    ds_write_b128 v24, v[16:19]
    s_waitcnt lgkmcnt(0)
    s_barrier
    s_mov_b32 s70, 0
POLL_113:
    buffer_load_dword v15, v14, s[4:7], s30 offen sc1
    s_waitcnt vmcnt(0)
    v_subrev_u32 v15, s85, v15
    v_cmp_le_u32 vcc, 16, v15
    s_add_u32 s70, s70, 1
    s_cmp_gt_u32 s70, 200000
    s_cbranch_scc1 POLLD_114
    s_cbranch_vccnz POLL_113
POLLD_114:
    s_add_u32 s96, s82, 0
    s_add_u32 s97, s47, s96
    s_add_u32 m0, s96, 129024
    s_mov_b32 exec_lo, 0xfffefffe
    s_mov_b32 exec_hi, 0xfffefffe
    buffer_load_dwordx4 v0, s[4:7], s97 offen sc1 lds
    s_mov_b64 exec, -1
    s_add_u32 s96, s82, 4096
    s_add_u32 s97, s47, s96
    s_add_u32 m0, s96, 129024
    s_mov_b32 exec_lo, 0xfffefffe
    s_mov_b32 exec_hi, 0xfffefffe
    buffer_load_dwordx4 v0, s[4:7], s97 offen sc1 lds
    s_mov_b64 exec, -1
    s_add_u32 s96, s82, 8192
    s_add_u32 s97, s47, s96
    s_add_u32 m0, s96, 129024
    s_mov_b32 exec_lo, 0xfffefffe
    s_mov_b32 exec_hi, 0xfffefffe
    buffer_load_dwordx4 v0, s[4:7], s97 offen sc1 lds
    s_mov_b64 exec, -1
    s_add_u32 s96, s82, 12288
    s_add_u32 s97, s47, s96
    s_add_u32 m0, s96, 129024
    s_mov_b32 exec_lo, 0xfffefffe
    s_mov_b32 exec_hi, 0xfffefffe
    buffer_load_dwordx4 v0, s[4:7], s97 offen sc1 lds
    s_mov_b64 exec, -1
    s_add_u32 s97, s47, s83
    s_add_u32 m0, s83, 129024
    s_mov_b32 exec_lo, 0xfefefefe
    s_mov_b32 exec_hi, 0xfefefefe
    buffer_load_dwordx4 v0, s[4:7], s97 offen sc1 lds
    s_mov_b64 exec, -1
    s_sub_u32 s99, s98, 737280
    s_waitcnt vmcnt(0)
    v_mov_b32 v38, 163632
    v_mov_b32 v39, 1
    s_mov_b64 exec, 1
    ds_add_u32 v38, v39 offset:8
    s_mov_b64 exec, -1
    s_barrier
    s_branch L_HCHAIN
HLAST_112:
    s_barrier
    s_endpgm
SPINC_6:
    s_mov_b32 s70, 0
SPIN_4:
    s_sleep 1
    ds_read_b32 v243, v242 offset:20
    s_add_u32 s70, s70, 1
    s_waitcnt lgkmcnt(0)
    v_cmp_gt_u32 vcc, 2, v243
    s_cmp_gt_u32 s70, 800000
    s_cbranch_scc1 SPIND_5
    s_cbranch_vccnz SPIN_4
    s_branch SPIND_5
SPINC_9:
    s_mov_b32 s70, 0
SPIN_7:
    s_sleep 1
    ds_read_b32 v243, v242 offset:28
    s_add_u32 s70, s70, 1
    s_waitcnt lgkmcnt(0)
    v_cmp_gt_u32 vcc, 4, v243
    s_cmp_gt_u32 s70, 800000
    s_cbranch_scc1 SPIND_8
    s_cbranch_vccnz SPIN_7
    s_branch SPIND_8
SPINC_12:
    s_mov_b32 s70, 0
SPIN_10:
    s_sleep 1
    ds_read_b32 v243, v242 offset:0
    s_add_u32 s70, s70, 1
    s_waitcnt lgkmcnt(0)
    v_cmp_gt_u32 vcc, 4, v243
    s_cmp_gt_u32 s70, 800000
    s_cbranch_scc1 SPIND_11
    s_cbranch_vccnz SPIN_10
    s_branch SPIND_11
SPINC_15:
    s_mov_b32 s70, 0
SPIN_13:
    s_sleep 1
    ds_read_b32 v243, v242 offset:4
    s_add_u32 s70, s70, 1
    s_waitcnt lgkmcnt(0)
    v_cmp_gt_u32 vcc, 4, v243
    s_cmp_gt_u32 s70, 800000
    s_cbranch_scc1 SPIND_14
    s_cbranch_vccnz SPIN_13
    s_branch SPIND_14
SPINC_18:
    s_mov_b32 s70, 0
SPIN_16:
    s_sleep 1
    ds_read_b32 v243, v242 offset:8
    s_add_u32 s70, s70, 1
    s_waitcnt lgkmcnt(0)
    v_cmp_gt_u32 vcc, 4, v243
    s_cmp_gt_u32 s70, 800000
    s_cbranch_scc1 SPIND_17
    s_cbranch_vccnz SPIN_16
    s_branch SPIND_17
POLLC_20:
    s_mov_b32 s70, 0
POLL_115:
    buffer_load_dword v15, v14, s[4:7], s82 offen sc1
    s_waitcnt vmcnt(0)
    v_subrev_u32 v15, s85, v15
    v_cmp_le_u32 vcc, 16, v15
    s_add_u32 s70, s70, 1
    s_cmp_gt_u32 s70, 200000
    s_cbranch_scc1 POLLD_116
    s_cbranch_vccnz POLL_115
POLLD_116:
    s_branch POLLE_19
SPINC_23:
    s_mov_b32 s70, 0
SPIN_21:
    s_sleep 1
    ds_read_b32 v243, v242 offset:8
    s_add_u32 s70, s70, 1
    s_waitcnt lgkmcnt(0)
    v_cmp_gt_u32 vcc, 8, v243
    s_cmp_gt_u32 s70, 800000
    s_cbranch_scc1 SPIND_22
    s_cbranch_vccnz SPIN_21
    s_branch SPIND_22
LOC_24:
    buffer_store_dwordx4 v[84:87], v0, s[4:7], s34 offen sc1
    buffer_store_dwordx4 v[92:95], v0, s[4:7], s35 offen sc1
    s_mov_b64 exec, 0xffff
    buffer_store_dwordx2 v[88:89], v1, s[4:7], s36 offen sc1
    buffer_store_dwordx2 v[96:97], v1, s[4:7], s37 offen sc1
    s_mov_b64 exec, -1
    s_branch LOCE_25
LOC_26:
    buffer_store_dwordx2 v[254:255], v1, s[4:7], s81 offen sc1
    s_branch LOCE_27
POLLC_29:
    s_mov_b32 s70, 0
POLL_117:
    buffer_load_dword v15, v14, s[4:7], s30 offen sc1
    s_waitcnt vmcnt(0)
    v_subrev_u32 v15, s31, v15
    v_cmp_le_u32 vcc, 16, v15
    s_add_u32 s70, s70, 1
    s_cmp_gt_u32 s70, 200000
    s_cbranch_scc1 POLLD_118
    s_cbranch_vccnz POLL_117
POLLD_118:
    s_branch POLLE_28
LOC_30:
    buffer_store_dwordx4 v[4:7], v0, s[4:7], s34 offen sc1
    buffer_store_dwordx4 v[8:11], v0, s[4:7], s34 offen offset:1024 sc1
    s_mov_b32 exec_hi, 0
    buffer_store_dwordx2 v[12:13], v1, s[4:7], s35 offen sc1
    s_mov_b64 exec, -1
    s_nop 2
    v_cndmask_b32 v40, v40, v41, s[42:43]
    v_cndmask_b32 v42, v42, v43, s[42:43]
    v_cndmask_b32 v45, v40, v42, s[44:45]
    s_mov_b64 exec, s[40:41]
    buffer_store_dwordx2 v[44:45], v48, s[4:7], s36 offen sc1
    s_mov_b64 exec, -1
    s_branch LOCE_31
LOC_35:
    buffer_store_dwordx2 v[254:255], v1, s[4:7], s81 offen sc1
    s_branch LOCE_36
POLLC_38:
    s_mov_b32 s70, 0
POLL_119:
    buffer_load_dword v15, v14, s[4:7], s83 offen sc1
    s_waitcnt vmcnt(0)
    v_subrev_u32 v15, s33, v15
    v_cmp_le_u32 vcc, 16, v15
    s_add_u32 s70, s70, 1
    s_cmp_gt_u32 s70, 200000
    s_cbranch_scc1 POLLD_120
    s_cbranch_vccnz POLL_119
POLLD_120:
    s_branch POLLE_37
LOC_39:
    buffer_store_dwordx2 v[254:255], v1, s[4:7], s81 offen sc1
    s_branch LOCE_40
KVSIG_43:
    s_add_u32 s28, s34, 65536
    s_mov_b64 exec, 0xffff
    s_waitcnt vmcnt(0)
    s_cmp_eq_u32 s68, 0
    s_cbranch_scc1 LOC_121
    buffer_store_dwordx2 v[138:139], v1, s[4:7], s28 offen
LOCE_122:
    buffer_store_dwordx2 v[138:139], v1, s[4:7], s34 offen sc1
    s_mov_b64 exec, 1
    ds_add_u32 v148, v149 offset:12
    s_mov_b64 exec, -1
    s_branch KVRET_44
SPINC_47:
    s_mov_b32 s70, 0
SPIN_45:
    s_sleep 1
    ds_read_b32 v47, v45 offset:12
    s_add_u32 s70, s70, 1
    s_waitcnt lgkmcnt(0)
    v_cmp_gt_u32 vcc, s37, v47
    s_cmp_gt_u32 s70, 800000
    s_cbranch_scc1 SPIND_46
    s_cbranch_vccnz SPIN_45
    s_branch SPIND_46
MASKC_52:
    s_mov_b32 s70, 0
MASK_53:
    s_sleep 1
    ds_read_b32 v199, v163 offset:64
    s_add_u32 s70, s70, 1
    s_waitcnt lgkmcnt(0)
    v_and_b32 v199, s39, v199
    v_cmp_ne_u32 vcc, s39, v199
    s_cmp_gt_u32 s70, 800000
    s_cbranch_scc1 MASKD_54
    s_cbranch_vccnz MASK_53
    s_branch MASKD_54
LOC_57:
    buffer_store_dwordx4 v[116:119], v0, s[4:7], s32 offen offset:0 sc1
    buffer_store_dwordx4 v[120:123], v0, s[4:7], s32 offen offset:1024 sc1
    s_mov_b32 exec_hi, 0
    buffer_store_dwordx2 v[124:125], v1, s[4:7], s33 offen sc1
    s_mov_b64 exec, -1
    s_branch LOCE_58
LOC_59:
    buffer_store_dwordx2 v[254:255], v1, s[4:7], s81 offen sc1
    s_branch LOCE_60
POLLC_62:
    s_mov_b32 s70, 0
POLL_123:
    buffer_load_dword v15, v14, s[4:7], s83 offen sc1
    s_waitcnt vmcnt(0)
    v_subrev_u32 v15, s31, v15
    v_cmp_le_u32 vcc, 16, v15
    s_add_u32 s70, s70, 1
    s_cmp_gt_u32 s70, 200000
    s_cbranch_scc1 POLLD_124
    s_cbranch_vccnz POLL_123
POLLD_124:
    s_branch POLLE_61
LOC_63:
    buffer_store_dwordx4 v[4:7], v0, s[4:7], s34 offen sc1
    buffer_store_dwordx4 v[8:11], v0, s[4:7], s34 offen offset:1024 sc1
    s_mov_b32 exec_hi, 0
    buffer_store_dwordx2 v[12:13], v1, s[4:7], s35 offen sc1
    s_mov_b64 exec, -1
    s_nop 2
    v_cndmask_b32 v40, v40, v41, s[42:43]
    v_cndmask_b32 v42, v42, v43, s[42:43]
    v_cndmask_b32 v45, v40, v42, s[44:45]
    s_mov_b64 exec, s[40:41]
    buffer_store_dwordx2 v[44:45], v48, s[4:7], s36 offen sc1
    s_mov_b64 exec, -1
    s_branch LOCE_64
LOC_69:
    buffer_store_dwordx2 v[254:255], v1, s[4:7], s81 offen sc1
    s_branch LOCE_70
HCP_65:
    s_add_u32 s38, s22, 1
    s_and_b32 s38, s38, 15
    s_mul_i32 s34, s38, 20480
    s_add_u32 s34, s34, 5570560
    s_lshl_b32 s35, s21, 8
    s_add_u32 s35, s35, s34
    s_add_u32 s35, s35, 16384
    s_lshl_b32 s36, s21, 7
    s_add_u32 s36, s36, s34
    s_add_u32 s36, s36, 18432
    s_lshl_b32 s28, s21, 11
    s_add_u32 s34, s34, s28
    buffer_store_dwordx4 v[4:7], v0, s[4:7], s34 offen sc1
    buffer_store_dwordx4 v[8:11], v0, s[4:7], s34 offen offset:1024 sc1
    s_mov_b32 exec_hi, 0
    buffer_store_dwordx2 v[12:13], v1, s[4:7], s35 offen sc1
    s_mov_b64 exec, s[40:41]
    buffer_store_dwordx2 v[44:45], v48, s[4:7], s36 offen sc1
    s_mov_b64 exec, -1
    s_waitcnt vmcnt(4)
    s_branch HCP_66
HCP_67:
    s_lshl_b32 s38, s38, 3
    s_add_u32 s38, s38, s21
    s_lshl_b32 s38, s38, 8
    s_add_u32 s38, s38, 90112
    s_waitcnt vmcnt(0)
    s_mov_b64 exec, 0xffff
    buffer_store_dwordx2 v[254:255], v1, s[4:7], s38 offen sc1
    s_mov_b64 exec, -1
    s_branch HCP_68
SPINC_85:
    s_mov_b32 s70, 0
SPIN_83:
    s_sleep 1
    ds_read_b32 v36, v38 offset:20
    s_add_u32 s70, s70, 1
    s_waitcnt lgkmcnt(0)
    v_cmp_gt_u32 vcc, 2, v36
    s_cmp_gt_u32 s70, 800000
    s_cbranch_scc1 SPIND_84
    s_cbranch_vccnz SPIN_83
    s_branch SPIND_84
SPINC_92:
    s_mov_b32 s70, 0
SPIN_90:
    s_sleep 1
    ds_read_b32 v36, v38 offset:16
    s_add_u32 s70, s70, 1
    s_waitcnt lgkmcnt(0)
    v_cmp_gt_u32 vcc, 4, v36
    s_cmp_gt_u32 s70, 800000
    s_cbranch_scc1 SPIND_91
    s_cbranch_vccnz SPIN_90
    s_branch SPIND_91
SPINC_95:
    s_mov_b32 s70, 0
SPIN_93:
    s_sleep 1
    ds_read_b32 v36, v38 offset:24
    s_add_u32 s70, s70, 1
    s_waitcnt lgkmcnt(0)
    v_cmp_gt_u32 vcc, 3, v36
    s_cmp_gt_u32 s70, 800000
    s_cbranch_scc1 SPIND_94
    s_cbranch_vccnz SPIN_93
    s_branch SPIND_94
SPINC_105:
    s_mov_b32 s70, 0
SPIN_103:
    s_sleep 1
    ds_read_b32 v35, v37 offset:12
    s_add_u32 s70, s70, 1
    s_waitcnt lgkmcnt(0)
    v_cmp_gt_u32 vcc, s33, v35
    s_cmp_gt_u32 s70, 800000
    s_cbranch_scc1 SPIND_104
    s_cbranch_vccnz SPIN_103
    s_branch SPIND_104
LOC_121:
    buffer_store_dwordx2 v[138:139], v1, s[4:7], s28 offen sc1
    s_branch LOCE_122
L_CODE_END:
.section .rodata,"a"
.p2align 6
.amdhsa_kernel interleave_layers__sliding_local_dilated__grouped_kv_mqa__prompt_kernel
  .amdhsa_next_free_vgpr 256
  .amdhsa_next_free_sgpr 102
  .amdhsa_accum_offset 256
  .amdhsa_group_segment_fixed_size 0
  .amdhsa_kernarg_size 88
  .amdhsa_user_sgpr_count 2
  .amdhsa_user_sgpr_kernarg_segment_ptr 1
  .amdhsa_system_sgpr_workgroup_id_x 1
.end_amdhsa_kernel
```
